```python
import torch

def _softmax(x, axis=-1):
    return torch.softmax(x, dim=axis)
def _gelu(x):
    return torch.nn.functional.gelu(x, approximate="tanh")
def _silu(x):
    return torch.nn.functional.silu(x)
def _sigmoid(x):
    return torch.sigmoid(x)
def _layernorm(x, axis=-1, eps=1e-5):
    m = x.mean(dim=axis, keepdim=True)
    v = x.var(dim=axis, keepdim=True, unbiased=False)
    return (x - m) / torch.sqrt(v + eps)
def _scatter_add(tgt, idx, src, axis=0):
    return tgt.clone().index_add_(axis, idx, src)
def _segment_sum(src, seg, n):
    out = torch.zeros((n,) + src.shape[1:], dtype=src.dtype)
    return out.index_add_(0, seg, src)
def _pad(x, pw):
    flat = tuple(v for pair in reversed(pw) for v in pair)
    return torch.nn.functional.pad(x, flat)

kernel_name = 'recurrent_scan__spectral_gfnet__dense_activation_relu__prompt'

def setup_inputs():

    _w = (lambda a: (lambda t: t.to(torch.bfloat16) if t.is_floating_point() else t)(torch.as_tensor(a)))
    def _A_setup():
        B, S, D = 1, 2048, 640
        Df = D // 2 + 1
        return {
            "x": _w((lambda *s: torch.randn(*s, dtype=torch.bfloat16) * 0.05)(B, S, D)),
            "w_r": _w((lambda *s: torch.randn(*s, dtype=torch.bfloat16) * 0.05)(S, Df) * 0.02),
            "w_i": _w((lambda *s: torch.randn(*s, dtype=torch.bfloat16) * 0.1)(S, Df) * 0.02),
        }
    _A_in = _A_setup()

    def _B_setup():
        B, S, D, Dff = 1, 2048, 640, 1728
        return {
            "x": _w((lambda *s: torch.randn(*s, dtype=torch.bfloat16) * 0.05)(B, S, D)),
            "w1": _w((lambda *s: torch.randn(*s, dtype=torch.bfloat16) * 0.05)(D, Dff)),
            "w2": _w((lambda *s: torch.randn(*s, dtype=torch.bfloat16) * 0.05)(Dff, D)),
        }
    _B_in = _B_setup()

    return {
        "A_x": _A_in["x"],
        "A_w_r": _A_in["w_r"],
        "A_w_i": _A_in["w_i"],
        "B_x": _B_in["x"],
        "B_w1": _B_in["w1"],
        "B_w2": _B_in["w2"],
    }

def reference(A_x, A_w_r, A_w_i, B_x, B_w1, B_w2):
    def _A_ref(x, w_r, w_i):
        B, S, D = x.shape
        X = (lambda x, axes=(-2,-1): torch.fft.rfft2(x.float(), dim=axes))(x, axes=(-2, -1))
        W = w_r + 1j * w_i
        X = X * W
        y = (lambda x, s, axes=(-2,-1): torch.fft.irfft2(x, s=s, dim=axes).to(torch.bfloat16))(X, (S, D), axes=(-2, -1))
        return y

    def _B_ref(x, w1, w2):
        h = torch.einsum("bsd,df->bsf", x, w1)
        zero = torch.zeros_like(h)
        h = torch.maximum(h, zero)
        return torch.einsum("bsf,fd->bsd", h, w2)

    x = A_x
    xn = _layernorm(x, axis=-1)
    s = _A_ref(xn, A_w_r, A_w_i)
    g = _silu(_B_ref(xn, B_w1, B_w2))
    return x + s * g
```

```asm
; @launch grid=(256,1,1) block=(256,1,1) lds=163840
.amdgcn_target "amdgcn-amd-amdhsa--gfx950"
.text
.globl recurrent_scan__spectral_gfnet__dense_activation_relu__prompt_kernel
.p2align 8
.type recurrent_scan__spectral_gfnet__dense_activation_relu__prompt_kernel,@function
recurrent_scan__spectral_gfnet__dense_activation_relu__prompt_kernel:
    s_load_dwordx8 s[32:39], s[0:1], 0
    s_load_dwordx8 s[40:47], s[0:1], 32
    s_load_dwordx2 s[48:49], s[0:1], 64
    s_cmp_ge_u32 s2, 256
    s_cbranch_scc1 L_exit
    s_getpc_b64 s[94:95]
L_pc:
    v_lshrrev_b32 v1, 6, v0
    v_and_b32 v0, 63, v0
    s_and_b32 s57, s2, 7
    v_readfirstlane_b32 s50, v1
    s_lshr_b32 s58, s2, 3
    s_and_b32 s53, s57, 1
    s_lshr_b32 s57, s57, 1
    s_and_b32 s59, s58, 3
    s_lshl_b32 s51, s57, 2
    s_add_u32 s51, s51, s59
    s_lshr_b32 s52, s58, 2
    s_lshl_b32 s58, s58, 2
    s_add_u32 s58, s58, s50
    s_lshl_b32 s58, s58, 2
    v_add_u32 v2, s58, v0
    v_and_b32 v2, 0x1ff, v2
    v_lshlrev_b32 v2, 7, v2
    s_mov_b64 exec, 0xff
    global_load_dword v3, v2, s[94:95]
    s_mov_b64 exec, -1
    s_mul_i32 s56, s50, 28672
    s_add_u32 s56, s56, 40960
    s_cmp_ge_u32 s52, 5
    s_cbranch_scc1 L_gpath
    s_and_b32 s59, s51, 3
    s_lshl_b32 s57, s52, 1
    s_mul_i32 s58, s59, 3
    s_add_u32 s57, s57, s58
    s_mul_i32 s58, s57, 26
    s_lshr_b32 s58, s58, 8
    s_mul_i32 s58, s58, 10
    s_sub_u32 s96, s57, s58
    s_lshl_b32 s60, s96, 7
    s_lshr_b32 s57, s51, 1
    s_lshl_b32 s57, s57, 7
    s_and_b32 s58, s51, 1
    s_lshl_b32 s58, s58, 4
    s_add_u32 s97, s57, s58
    s_lshr_b32 s57, s50, 1
    s_lshl_b32 s57, s57, 6
    s_and_b32 s58, s50, 1
    s_lshl_b32 s58, s58, 3
    s_add_u32 s57, s57, s58
    s_add_u32 s57, s57, s97
    v_bfe_u32 v1, v0, 3, 1
    v_lshlrev_b32 v1, 10, v1
    v_bfe_u32 v2, v0, 4, 1
    v_lshl_add_u32 v1, v2, 5, v1
    v_lshrrev_b32 v2, 5, v0
    v_add3_u32 v1, v1, v2, s57
    v_mul_u32_u24 v1, 1280, v1
    v_and_b32 v2, 7, v0
    v_lshrrev_b32 v4, 4, v0
    v_xor_b32 v2, v2, v4
    v_lshl_add_u32 v8, v2, 4, v1
    v_xor_b32 v9, 64, v8
    v_add_u32 v10, 3072, v8
    v_add_u32 v11, 4608, v9
    v_add_u32 v9, 1536, v9
    s_add_u32 s61, s60, 128
    s_cmp_eq_u32 s61, 1280
    s_cselect_b32 s61, 0, s61
    s_waitcnt lgkmcnt(0)
    s_mov_b32 s4, s32
    s_mov_b32 s5, s33
    s_mov_b32 s6, 2621440
    s_mov_b32 s7, 0x20000
    s_add_u32 m0, s56, 0
    s_nop 0
    buffer_load_dwordx4 v8, s[4:7], s60 offen offset:0 lds
    s_mov_b32 s8, s48
    s_mov_b32 s9, s49
    s_mov_b32 s10, 18874368
    s_mov_b32 s11, 0x20000
    s_mov_b32 s12, s40
    s_mov_b32 s13, s41
    buffer_load_dwordx4 v9, s[4:7], s60 offen offset:1024 lds
    s_mov_b32 s14, 2211840
    s_mov_b32 s15, 0x20000
    buffer_load_dwordx4 v10, s[4:7], s60 offen offset:2048 lds
    s_mov_b32 s28, s44
    s_mov_b32 s29, s45
    buffer_load_dwordx4 v11, s[4:7], s60 offen offset:3072 lds
    s_mov_b32 s30, 2621440
    s_add_u32 m0, s56, 4096
    s_mov_b32 s31, 0x20000
    buffer_load_dwordx4 v8, s[4:7], s61 offen offset:0 lds
    s_mov_b32 s16, s34
    s_mov_b32 s17, s35
    buffer_load_dwordx4 v9, s[4:7], s61 offen offset:1024 lds
    s_mov_b32 s18, 1314816
    s_mov_b32 s19, 0x20000
    buffer_load_dwordx4 v10, s[4:7], s61 offen offset:2048 lds
    s_add_u32 s62, s61, 128
    s_cmp_eq_u32 s62, 1280
    s_cselect_b32 s62, 0, s62
    buffer_load_dwordx4 v11, s[4:7], s61 offen offset:3072 lds
    s_add_u32 s63, s62, 128
    s_cmp_eq_u32 s63, 1280
    s_cselect_b32 s63, 0, s63
    s_add_u32 s64, s63, 128
    s_cmp_eq_u32 s64, 1280
    s_cselect_b32 s64, 0, s64
    s_add_u32 s65, s64, 128
    s_cmp_eq_u32 s65, 1280
    s_cselect_b32 s65, 0, s65
    s_add_u32 s66, s65, 128
    s_cmp_eq_u32 s66, 1280
    s_cselect_b32 s66, 0, s66
    s_add_u32 s67, s66, 128
    s_cmp_eq_u32 s67, 1280
    s_cselect_b32 s67, 0, s67
    s_add_u32 s68, s67, 128
    s_cmp_eq_u32 s68, 1280
    s_cselect_b32 s68, 0, s68
    s_add_u32 s69, s68, 128
    s_cmp_eq_u32 s69, 1280
    s_cselect_b32 s69, 0, s69
    s_add_u32 s40, s94, L_tab-L_pc
    s_addc_u32 s41, s95, 0
    v_mov_b32 v35, 0
    s_mov_b32 s99, 17825792
    s_and_b32 s84, s52, 1
    buffer_load_dword v35, v35, s[8:11], s99 offen sc1
    s_lshr_b32 s83, s52, 1
    s_lshl_b32 s57, s53, 2
    s_add_u32 s83, s83, s57
    s_lshl_b32 s82, s51, 1
    s_add_u32 s82, s82, s84
    s_cmp_eq_u32 s50, 0
    s_cselect_b32 s80, 1, 0
    s_cselect_b64 s[0:1], -1, 0
    s_mov_b32 s81, 0
    s_mov_b32 s85, 0x05040100
    s_mov_b32 s86, 0x07060302
    s_mov_b32 s87, 0x3f803f80
    v_and_b32 v1, 31, v0
    v_lshrrev_b32 v2, 5, v0
    s_lshr_b32 s57, s50, 1
    s_lshl_b32 s57, s57, 2
    v_add_u32 v2, s57, v2
    v_bfe_u32 v7, v0, 1, 3
    v_xor_b32 v2, v2, v7
    v_lshlrev_b32 v2, 4, v2
    v_lshl_add_u32 v2, v1, 7, v2
    v_add_u32 v12, s56, v2
    v_xor_b32 v13, 32, v12
    v_xor_b32 v14, 64, v12
    v_xor_b32 v15, 0x60, v12
    v_mov_b32 v29, 0
    v_mov_b32 v30, 0
    v_mov_b32 v31, 0
    v_mov_b32 v32, 0
    s_mul_i32 s70, s60, 1728
    s_mul_i32 s71, s61, 1728
    s_mul_i32 s72, s62, 1728
    s_mul_i32 s73, s63, 1728
    s_mul_i32 s74, s64, 1728
    s_mul_i32 s75, s65, 1728
    s_mul_i32 s76, s66, 1728
    s_mul_i32 s77, s67, 1728
    s_mul_i32 s78, s68, 1728
    s_mul_i32 s79, s69, 1728
    s_mul_i32 s54, s53, 5
    s_add_u32 s54, s54, s52
    v_and_b32 v1, 31, v0
    v_lshrrev_b32 v2, 1, v1
    s_lshl_b32 s57, s54, 4
    v_add_u32 v2, s57, v2
    v_cvt_f32_u32 v40, v2
    v_and_b32 v2, 1, v0
    v_cvt_f32_u32 v41, v2
    v_mul_f32 v41, 0x3e800000, v41
    s_cmp_eq_u32 s54, 0
    s_cselect_b32 s88, 2, 0
    s_mov_b32 s89, s88
    s_and_b32 s58, s50, 1
    s_mul_i32 s59, s58, 0x3e800000
    s_mov_b64 exec, s[88:89]
    v_mov_b32 v40, 0x43200000
    v_mov_b32 v41, s59
    s_mov_b64 exec, -1
    s_lshl_b32 s57, s96, 6
    s_add_u32 s57, s57, s58
    s_lshr_b32 s58, s50, 1
    s_lshl_b32 s58, s58, 5
    s_add_u32 s57, s57, s58
    v_lshrrev_b32 v2, 5, v0
    v_lshl_add_u32 v2, v2, 3, s57
    v_cvt_f32_u32 v42, v2
    v_mul_f32 v43, 0x3acccccd, v40
    v_fma_f32 v42, v42, v43, v41
    v_mul_f32 v44, 0x3dcccccd, v40
    v_fract_f32 v44, v44
    v_cos_f32 v44, v44
    s_lshl_b32 s57, s50, 10
    v_lshl_add_u32 v45, v0, 4, s57
    v_add_f32 v44, v44, v44
    v_fmamk_f32 v64, v43, 0x00000000, v42
    v_fmamk_f32 v65, v43, 0x40000000, v42
    v_fmamk_f32 v66, v43, 0x40800000, v42
    v_fmamk_f32 v67, v43, 0x40c00000, v42
    v_fmamk_f32 v68, v43, 0x41800000, v42
    v_fmamk_f32 v69, v43, 0x41900000, v42
    v_fmamk_f32 v70, v43, 0x41a00000, v42
    v_fmamk_f32 v71, v43, 0x41b00000, v42
    v_fract_f32 v64, v64
    v_fract_f32 v65, v65
    v_fract_f32 v66, v66
    v_fract_f32 v67, v67
    v_fract_f32 v68, v68
    v_fract_f32 v69, v69
    v_fract_f32 v70, v70
    v_fract_f32 v71, v71
    v_cos_f32 v64, v64
    v_cos_f32 v65, v65
    v_cos_f32 v66, v66
    v_cos_f32 v67, v67
    v_cos_f32 v68, v68
    v_cos_f32 v69, v69
    v_cos_f32 v70, v70
    v_cos_f32 v71, v71
    v_fmamk_f32 v72, v43, 0x42800000, v42
    v_fmamk_f32 v73, v43, 0x42840000, v42
    v_fmamk_f32 v74, v43, 0x42880000, v42
    v_fmamk_f32 v75, v43, 0x428c0000, v42
    v_fmamk_f32 v76, v43, 0x42a00000, v42
    v_fmamk_f32 v77, v43, 0x42a40000, v42
    v_fmamk_f32 v78, v43, 0x42a80000, v42
    v_fmamk_f32 v79, v43, 0x42ac0000, v42
    v_fract_f32 v72, v72
    v_fract_f32 v73, v73
    v_fract_f32 v74, v74
    v_fract_f32 v75, v75
    v_fract_f32 v76, v76
    v_fract_f32 v77, v77
    v_fract_f32 v78, v78
    v_fract_f32 v79, v79
    v_cos_f32 v72, v72
    v_cos_f32 v73, v73
    v_cos_f32 v74, v74
    v_cos_f32 v75, v75
    v_cos_f32 v76, v76
    v_cos_f32 v77, v77
    v_cos_f32 v78, v78
    v_cos_f32 v79, v79
    v_cvt_pk_bf16_f32 v80, v64, v65
    v_cvt_pk_bf16_f32 v81, v66, v67
    v_cvt_pk_bf16_f32 v82, v68, v69
    v_cvt_pk_bf16_f32 v83, v70, v71
    ds_write_b128 v45, v[80:83] offset:0
    v_cvt_pk_bf16_f32 v84, v72, v73
    v_cvt_pk_bf16_f32 v85, v74, v75
    v_cvt_pk_bf16_f32 v86, v76, v77
    v_cvt_pk_bf16_f32 v87, v78, v79
    ds_write_b128 v45, v[84:87] offset:4096
    v_fma_f32 v64, v44, v72, -v64
    v_fma_f32 v65, v44, v73, -v65
    v_fma_f32 v66, v44, v74, -v66
    v_fma_f32 v67, v44, v75, -v67
    v_fma_f32 v68, v44, v76, -v68
    v_fma_f32 v69, v44, v77, -v69
    v_fma_f32 v70, v44, v78, -v70
    v_fma_f32 v71, v44, v79, -v71
    v_cvt_pk_bf16_f32 v80, v64, v65
    v_cvt_pk_bf16_f32 v81, v66, v67
    v_cvt_pk_bf16_f32 v82, v68, v69
    v_cvt_pk_bf16_f32 v83, v70, v71
    ds_write_b128 v45, v[80:83] offset:8192
    v_fma_f32 v72, v44, v64, -v72
    v_fma_f32 v73, v44, v65, -v73
    v_fma_f32 v74, v44, v66, -v74
    v_fma_f32 v75, v44, v67, -v75
    v_fma_f32 v76, v44, v68, -v76
    v_fma_f32 v77, v44, v69, -v77
    v_fma_f32 v78, v44, v70, -v78
    v_fma_f32 v79, v44, v71, -v79
    v_cvt_pk_bf16_f32 v84, v72, v73
    v_cvt_pk_bf16_f32 v85, v74, v75
    v_cvt_pk_bf16_f32 v86, v76, v77
    v_cvt_pk_bf16_f32 v87, v78, v79
    ds_write_b128 v45, v[84:87] offset:12288
    v_fma_f32 v64, v44, v72, -v64
    v_fma_f32 v65, v44, v73, -v65
    v_fma_f32 v66, v44, v74, -v66
    v_fma_f32 v67, v44, v75, -v67
    v_fma_f32 v68, v44, v76, -v68
    v_fma_f32 v69, v44, v77, -v69
    v_fma_f32 v70, v44, v78, -v70
    v_fma_f32 v71, v44, v79, -v71
    v_cvt_pk_bf16_f32 v80, v64, v65
    v_cvt_pk_bf16_f32 v81, v66, v67
    v_cvt_pk_bf16_f32 v82, v68, v69
    v_cvt_pk_bf16_f32 v83, v70, v71
    ds_write_b128 v45, v[80:83] offset:16384
    v_fma_f32 v72, v44, v64, -v72
    v_fma_f32 v73, v44, v65, -v73
    v_fma_f32 v74, v44, v66, -v74
    v_fma_f32 v75, v44, v67, -v75
    v_fma_f32 v76, v44, v68, -v76
    v_fma_f32 v77, v44, v69, -v77
    v_fma_f32 v78, v44, v70, -v78
    v_fma_f32 v79, v44, v71, -v79
    v_cvt_pk_bf16_f32 v84, v72, v73
    v_cvt_pk_bf16_f32 v85, v74, v75
    v_cvt_pk_bf16_f32 v86, v76, v77
    v_cvt_pk_bf16_f32 v87, v78, v79
    ds_write_b128 v45, v[84:87] offset:20480
    v_fma_f32 v64, v44, v72, -v64
    v_fma_f32 v65, v44, v73, -v65
    v_fma_f32 v66, v44, v74, -v66
    v_fma_f32 v67, v44, v75, -v67
    v_fma_f32 v68, v44, v76, -v68
    v_fma_f32 v69, v44, v77, -v69
    v_fma_f32 v70, v44, v78, -v70
    v_fma_f32 v71, v44, v79, -v71
    v_cvt_pk_bf16_f32 v80, v64, v65
    v_cvt_pk_bf16_f32 v81, v66, v67
    v_cvt_pk_bf16_f32 v82, v68, v69
    v_cvt_pk_bf16_f32 v83, v70, v71
    ds_write_b128 v45, v[80:83] offset:24576
    v_fma_f32 v72, v44, v64, -v72
    v_fma_f32 v73, v44, v65, -v73
    v_fma_f32 v74, v44, v66, -v74
    v_fma_f32 v75, v44, v67, -v75
    v_fma_f32 v76, v44, v68, -v76
    v_fma_f32 v77, v44, v69, -v77
    v_fma_f32 v78, v44, v70, -v78
    v_fma_f32 v79, v44, v71, -v79
    v_cvt_pk_bf16_f32 v84, v72, v73
    v_cvt_pk_bf16_f32 v85, v74, v75
    v_cvt_pk_bf16_f32 v86, v76, v77
    v_cvt_pk_bf16_f32 v87, v78, v79
    ds_write_b128 v45, v[84:87] offset:28672
    v_fma_f32 v64, v44, v72, -v64
    v_fma_f32 v65, v44, v73, -v65
    v_fma_f32 v66, v44, v74, -v66
    v_fma_f32 v67, v44, v75, -v67
    v_fma_f32 v68, v44, v76, -v68
    v_fma_f32 v69, v44, v77, -v69
    v_fma_f32 v70, v44, v78, -v70
    v_fma_f32 v71, v44, v79, -v71
    v_cvt_pk_bf16_f32 v80, v64, v65
    v_cvt_pk_bf16_f32 v81, v66, v67
    v_cvt_pk_bf16_f32 v82, v68, v69
    v_cvt_pk_bf16_f32 v83, v70, v71
    ds_write_b128 v45, v[80:83] offset:32768
    v_fma_f32 v72, v44, v64, -v72
    v_fma_f32 v73, v44, v65, -v73
    v_fma_f32 v74, v44, v66, -v74
    v_fma_f32 v75, v44, v67, -v75
    v_fma_f32 v76, v44, v68, -v76
    v_fma_f32 v77, v44, v69, -v77
    v_fma_f32 v78, v44, v70, -v78
    v_fma_f32 v79, v44, v71, -v79
    v_cvt_pk_bf16_f32 v84, v72, v73
    v_cvt_pk_bf16_f32 v85, v74, v75
    v_cvt_pk_bf16_f32 v86, v76, v77
    v_cvt_pk_bf16_f32 v87, v78, v79
    ds_write_b128 v45, v[84:87] offset:36864
    v_lshrrev_b32 v1, 3, v0
    v_lshrrev_b32 v2, 2, v1
    v_lshlrev_b32 v2, 4, v2
    v_and_b32 v4, 3, v1
    v_lshl_add_u32 v2, v4, 1, v2
    s_lshr_b32 s57, s50, 1
    s_lshl_b32 s57, s57, 5
    s_and_b32 s58, s50, 1
    s_add_u32 s57, s57, s58
    s_add_u32 s58, s54, 6
    s_lshl_b32 s58, s58, 7
    v_add_u32 v2, s57, v2
    v_mul_u32_u24 v2, 3456, v2
    v_bfe_u32 v4, v1, 1, 1
    v_lshlrev_b32 v4, 2, v4
    v_and_b32 v7, 7, v0
    v_xor_b32 v4, v4, v7
    v_lshl_add_u32 v16, v4, 4, v2
    v_add_u32 v16, s58, v16
    v_add_u32 v17, 26624, v16
    v_bfe_u32 v1, v0, 2, 3
    v_lshrrev_b32 v2, 2, v1
    v_lshlrev_b32 v2, 4, v2
    v_and_b32 v4, 3, v1
    v_lshl_add_u32 v2, v4, 1, v2
    v_lshrrev_b32 v4, 5, v0
    v_lshl_add_u32 v2, v4, 3, v2
    v_add_u32 v2, s57, v2
    v_mul_u32_u24 v2, 3456, v2
    v_and_b32 v4, 3, v0
    v_lshl_add_u32 v2, v4, 4, v2
    s_add_u32 s58, s54, 44
    s_lshl_b32 s58, s58, 6
    v_add_u32 v18, s58, v2
    v_lshrrev_b32 v1, 5, v0
    v_lshlrev_b32 v1, 3, v1
    v_bfe_u32 v2, v0, 2, 2
    v_add_u32 v1, v1, v2
    v_bfe_u32 v4, v0, 4, 1
    v_lshlrev_b32 v4, 5, v4
    v_and_b32 v7, 3, v0
    v_lshl_add_u32 v4, v7, 3, v4
    v_bfe_u32 v2, v0, 3, 1
    s_and_b32 s58, s50, 1
    v_xor_b32 v2, s58, v2
    v_lshl_add_u32 v2, v2, 6, v4
    v_lshl_add_u32 v2, v1, 7, v2
    s_lshr_b32 s57, s50, 1
    s_mul_i32 s58, s57, 57344
    s_add_u32 s57, s58, 40960
    s_sub_u32 s58, 98304, s58
    v_add_u32 v20, s57, v2
    v_xor_b32 v21, 64, v20
    v_add_u32 v22, s58, v2
    v_xor_b32 v23, 64, v22
    v_lshl_add_u32 v2, v1, 6, v4
    v_add_u32 v24, s57, v2
    v_add_u32 v25, s58, v2
    v_bfe_u32 v1, v0, 4, 1
    v_lshlrev_b32 v1, 10, v1
    v_lshrrev_b32 v2, 5, v0
    v_lshl_add_u32 v1, v2, 8, v1
    v_and_b32 v4, 15, v0
    v_lshl_add_u32 v1, v4, 4, v1
    s_and_b32 s58, s50, 1
    s_lshl_b32 s57, s58, 11
    v_add_u32 v19, s57, v1
    s_lshl_b32 s57, s58, 7
    s_add_u32 s57, s57, 155648
    v_and_b32 v4, 31, v0
    v_lshl_add_u32 v27, v4, 2, s57
    v_xor_b32 v28, 0x80, v27
    v_and_b32 v1, 1, v0
    v_lshlrev_b32 v1, 6, v1
    v_lshrrev_b32 v2, 4, v0
    v_lshl_add_u32 v1, v2, 4, v1
    s_lshl_b32 s57, s50, 7
    s_add_u32 s57, s57, 155648
    v_add_u32 v26, s57, v1
    s_lshr_b32 s57, s50, 1
    s_lshl_b32 s57, s57, 11
    s_xor_b32 s58, s57, 2048
    v_lshl_add_u32 v36, v0, 4, s57
    v_lshl_add_u32 v37, v0, 4, s58
    v_and_b32 v1, 31, v0
    v_bfe_u32 v2, v0, 1, 1
    v_lshlrev_b32 v4, 5, v2
    v_lshrrev_b32 v7, 2, v1
    s_lshr_b32 s57, s50, 1
    s_and_b32 s58, s50, 1
    s_lshl_b32 s90, s57, 6
    s_lshl_b32 s91, s58, 3
    s_add_u32 s90, s90, s91
    s_add_u32 s90, s90, s97
    v_add3_u32 v4, v4, v7, s90
    v_cvt_f32_u32 v4, v4
    v_mul_f32 v4, 0x3a000000, v4
    v_cos_f32 v56, v4
    v_sin_f32 v57, v4
    v_and_b32 v62, 1, v0
    v_cmp_eq_u32 vcc, 1, v62
    v_sub_f32 v56, 0, v56
    v_mov_b32 v4, -1.0
    v_cndmask_b32 v56, 1.0, v56, vcc
    v_cndmask_b32 v57, 0, v57, vcc
    v_cndmask_b32 v58, 1.0, v4, vcc
    v_add_u32 v7, s91, v7
    v_lshl_add_u32 v7, v7, 2, v2
    s_lshl_b32 s57, s57, 1
    v_add_u32 v7, s57, v7
    v_lshlrev_b32 v7, 2, v7
    v_lshl_add_u32 v7, v62, 8, v7
    v_lshrrev_b32 v4, 5, v0
    v_lshl_add_u32 v59, v4, 11, v7
    s_lshl_b32 s57, s50, 10
    v_lshl_add_u32 v60, v0, 4, s57
    v_lshrrev_b32 v2, 4, v0
    v_lshlrev_b32 v2, 12, v2
    v_and_b32 v4, 15, v0
    v_lshl_add_u32 v61, v4, 4, v2
    s_lshl_b32 s57, s54, 4
    s_add_u32 s57, s57, s50
    s_lshl_b32 s57, s57, 14
    s_lshl_b32 s58, s51, 8
    s_add_u32 s90, s57, s58
    s_add_u32 s91, s90, 0x10000
    s_add_u32 s92, s90, 0x20000
    s_add_u32 s93, s90, 0x30000
    s_lshl_b32 s57, s54, 7
    s_lshl_b32 s58, s51, 2
    s_add_u32 s57, s57, s58
    v_mov_b32 v38, s57
    v_lshrrev_b32 v1, 4, v0
    v_xor_b32 v1, v1, v0
    v_and_b32 v1, 1, v1
    v_cmp_eq_u32 vcc, 0, v1
    v_mov_b32 v2, s87
    s_nop 0
    v_cndmask_b32 v4, 0, v2, vcc
    v_mov_b32 v5, v4
    v_mov_b32 v6, v4
    v_mov_b32 v7, v4
    s_waitcnt lgkmcnt(0)
    s_barrier
    s_waitcnt vmcnt(0)
    v_readfirstlane_b32 s55, v35
    s_nop 0
    s_mul_i32 s55, s55, 0x9E3779B1
    s_add_u32 s55, s55, 0x7F4A7C15
    ds_read_b128 v[112:115], v12 offset:0
    ds_read_b128 v[116:119], v13 offset:0
    ds_read_b128 v[120:123], v14 offset:0
    ds_read_b128 v[124:127], v15 offset:0
    ds_read_b128 a[0:3], v36 offset:0
    ds_read_b128 a[4:7], v36 offset:1024
    ds_read_b128 a[8:11], v37 offset:0
    ds_read_b128 a[12:15], v37 offset:1024
    s_waitcnt lgkmcnt(4)
    v_perm_b32 v96, v113, v112, s85
    s_add_u32 m0, s56, 8192
    v_perm_b32 v97, v115, v114, s85
    buffer_load_dwordx4 v8, s[4:7], s62 offen offset:0 lds
    v_perm_b32 v98, v117, v116, s85
    v_perm_b32 v99, v119, v118, s85
    v_perm_b32 v100, v113, v112, s86
    v_perm_b32 v101, v115, v114, s86
    v_perm_b32 v102, v117, v116, s86
    v_perm_b32 v103, v119, v118, s86
    v_perm_b32 v104, v121, v120, s85
    v_perm_b32 v105, v123, v122, s85
    v_perm_b32 v106, v125, v124, s85
    v_perm_b32 v107, v127, v126, s85
    v_perm_b32 v108, v121, v120, s86
    buffer_load_dwordx4 v9, s[4:7], s62 offen offset:1024 lds
    v_perm_b32 v109, v123, v122, s86
    v_perm_b32 v110, v125, v124, s86
    v_perm_b32 v111, v127, v126, s86
    ds_read_b128 v[128:131], v12 offset:4096
    ds_read_b128 v[132:135], v13 offset:4096
    ds_read_b128 v[136:139], v14 offset:4096
    ds_read_b128 v[140:143], v15 offset:4096
    buffer_load_dwordx4 v10, s[4:7], s62 offen offset:2048 lds
    v_dot2c_f32_bf16 v31, v96, v96
    v_dot2c_f32_bf16 v32, v97, v97
    v_dot2c_f32_bf16 v31, v98, v98
    v_dot2c_f32_bf16 v32, v99, v99
    v_dot2c_f32_bf16 v31, v100, v100
    v_dot2c_f32_bf16 v32, v101, v101
    buffer_load_dwordx4 v11, s[4:7], s62 offen offset:3072 lds
    v_dot2c_f32_bf16 v31, v102, v102
    v_dot2c_f32_bf16 v32, v103, v103
    v_dot2c_f32_bf16 v31, v104, v104
    v_dot2c_f32_bf16 v32, v105, v105
    v_dot2c_f32_bf16 v31, v106, v106
    v_dot2c_f32_bf16 v32, v107, v107
    v_dot2c_f32_bf16 v31, v108, v108
    v_dot2c_f32_bf16 v32, v109, v109
    v_dot2c_f32_bf16 v31, v110, v110
    v_dot2c_f32_bf16 v32, v111, v111
    s_waitcnt lgkmcnt(0)
    v_mfma_f32_32x32x16_bf16 v[64:79], a[0:3], v[96:99], 0
    s_add_u32 m0, s56, 0
    s_nop 0
    buffer_load_dwordx4 v8, s[4:7], s63 offen offset:0 lds
    v_perm_b32 v112, v129, v128, s85
    v_mfma_f32_16x16x32_bf16 a[204:207], v[4:7], v[96:99], 0
    ds_read_b128 a[16:19], v36 offset:4096
    v_perm_b32 v113, v131, v130, s85
    v_mfma_f32_32x32x16_bf16 v[80:95], a[4:7], v[100:103], 0
    buffer_load_dwordx4 v9, s[4:7], s63 offen offset:1024 lds
    v_perm_b32 v114, v133, v132, s85
    v_perm_b32 v115, v135, v134, s85
    v_mfma_f32_16x16x32_bf16 a[204:207], v[4:7], v[100:103], a[204:207]
    ds_read_b128 a[20:23], v36 offset:5120
    v_perm_b32 v116, v129, v128, s86
    v_mfma_f32_32x32x16_bf16 v[64:79], a[8:11], v[104:107], v[64:79]
    buffer_load_dwordx4 v10, s[4:7], s63 offen offset:2048 lds
    v_perm_b32 v117, v131, v130, s86
    v_perm_b32 v118, v133, v132, s86
    v_mfma_f32_16x16x32_bf16 a[204:207], v[4:7], v[104:107], a[204:207]
    ds_read_b128 a[24:27], v37 offset:4096
    v_perm_b32 v119, v135, v134, s86
    v_mfma_f32_32x32x16_bf16 v[80:95], a[12:15], v[108:111], v[80:95]
    buffer_load_dwordx4 v11, s[4:7], s63 offen offset:3072 lds
    v_perm_b32 v120, v137, v136, s85
    v_perm_b32 v121, v139, v138, s85
    v_mfma_f32_16x16x32_bf16 a[204:207], v[4:7], v[108:111], a[204:207]
    ds_read_b128 a[28:31], v37 offset:5120
    v_perm_b32 v122, v141, v140, s85
    v_perm_b32 v123, v143, v142, s85
    v_perm_b32 v124, v137, v136, s86
    v_perm_b32 v125, v139, v138, s86
    v_perm_b32 v126, v141, v140, s86
    v_perm_b32 v127, v143, v142, s86
    s_waitcnt vmcnt(4)
    ds_read_b128 v[144:147], v12 offset:8192
    ds_read_b128 v[148:151], v13 offset:8192
    ds_read_b128 v[152:155], v14 offset:8192
    ds_read_b128 v[156:159], v15 offset:8192
    v_dot2c_f32_bf16 v31, v112, v112
    v_dot2c_f32_bf16 v32, v113, v113
    v_dot2c_f32_bf16 v31, v114, v114
    v_dot2c_f32_bf16 v32, v115, v115
    v_dot2c_f32_bf16 v31, v116, v116
    v_dot2c_f32_bf16 v32, v117, v117
    v_dot2c_f32_bf16 v31, v118, v118
    v_dot2c_f32_bf16 v32, v119, v119
    v_dot2c_f32_bf16 v31, v120, v120
    v_dot2c_f32_bf16 v32, v121, v121
    v_dot2c_f32_bf16 v31, v122, v122
    v_dot2c_f32_bf16 v32, v123, v123
    v_dot2c_f32_bf16 v31, v124, v124
    v_dot2c_f32_bf16 v32, v125, v125
    v_dot2c_f32_bf16 v31, v126, v126
    v_dot2c_f32_bf16 v32, v127, v127
    s_waitcnt lgkmcnt(0)
    v_mfma_f32_32x32x16_bf16 v[64:79], a[16:19], v[112:115], v[64:79]
    s_add_u32 m0, s56, 4096
    s_nop 0
    buffer_load_dwordx4 v8, s[4:7], s64 offen offset:0 lds
    v_perm_b32 v128, v145, v144, s85
    v_mfma_f32_16x16x32_bf16 a[204:207], v[4:7], v[112:115], a[204:207]
    ds_read_b128 a[0:3], v36 offset:8192
    v_perm_b32 v129, v147, v146, s85
    v_mfma_f32_32x32x16_bf16 v[80:95], a[20:23], v[116:119], v[80:95]
    buffer_load_dwordx4 v9, s[4:7], s64 offen offset:1024 lds
    v_perm_b32 v130, v149, v148, s85
    v_perm_b32 v131, v151, v150, s85
    v_mfma_f32_16x16x32_bf16 a[204:207], v[4:7], v[116:119], a[204:207]
    ds_read_b128 a[4:7], v36 offset:9216
    v_perm_b32 v132, v145, v144, s86
    v_mfma_f32_32x32x16_bf16 v[64:79], a[24:27], v[120:123], v[64:79]
    buffer_load_dwordx4 v10, s[4:7], s64 offen offset:2048 lds
    v_perm_b32 v133, v147, v146, s86
    v_perm_b32 v134, v149, v148, s86
    v_mfma_f32_16x16x32_bf16 a[204:207], v[4:7], v[120:123], a[204:207]
    ds_read_b128 a[8:11], v37 offset:8192
    v_perm_b32 v135, v151, v150, s86
    v_mfma_f32_32x32x16_bf16 v[80:95], a[28:31], v[124:127], v[80:95]
    buffer_load_dwordx4 v11, s[4:7], s64 offen offset:3072 lds
    v_perm_b32 v136, v153, v152, s85
    v_perm_b32 v137, v155, v154, s85
    v_mfma_f32_16x16x32_bf16 a[204:207], v[4:7], v[124:127], a[204:207]
    ds_read_b128 a[12:15], v37 offset:9216
    v_perm_b32 v138, v157, v156, s85
    v_perm_b32 v139, v159, v158, s85
    v_perm_b32 v140, v153, v152, s86
    v_perm_b32 v141, v155, v154, s86
    v_perm_b32 v142, v157, v156, s86
    v_perm_b32 v143, v159, v158, s86
    s_waitcnt vmcnt(4)
    ds_read_b128 v[160:163], v12 offset:0
    ds_read_b128 v[164:167], v13 offset:0
    ds_read_b128 v[168:171], v14 offset:0
    ds_read_b128 v[172:175], v15 offset:0
    v_dot2c_f32_bf16 v31, v128, v128
    v_dot2c_f32_bf16 v32, v129, v129
    v_dot2c_f32_bf16 v31, v130, v130
    v_dot2c_f32_bf16 v32, v131, v131
    v_dot2c_f32_bf16 v31, v132, v132
    v_dot2c_f32_bf16 v32, v133, v133
    v_dot2c_f32_bf16 v31, v134, v134
    v_dot2c_f32_bf16 v32, v135, v135
    v_dot2c_f32_bf16 v31, v136, v136
    v_dot2c_f32_bf16 v32, v137, v137
    v_dot2c_f32_bf16 v31, v138, v138
    v_dot2c_f32_bf16 v32, v139, v139
    v_dot2c_f32_bf16 v31, v140, v140
    v_dot2c_f32_bf16 v32, v141, v141
    v_dot2c_f32_bf16 v31, v142, v142
    v_dot2c_f32_bf16 v32, v143, v143
    s_waitcnt lgkmcnt(0)
    v_mfma_f32_32x32x16_bf16 v[64:79], a[0:3], v[128:131], v[64:79]
    s_add_u32 m0, s56, 8192
    s_nop 0
    buffer_load_dwordx4 v8, s[4:7], s65 offen offset:0 lds
    v_perm_b32 v144, v161, v160, s85
    v_mfma_f32_16x16x32_bf16 a[204:207], v[4:7], v[128:131], a[204:207]
    ds_read_b128 a[16:19], v36 offset:12288
    v_perm_b32 v145, v163, v162, s85
    v_mfma_f32_32x32x16_bf16 v[80:95], a[4:7], v[132:135], v[80:95]
    buffer_load_dwordx4 v9, s[4:7], s65 offen offset:1024 lds
    v_perm_b32 v146, v165, v164, s85
    v_perm_b32 v147, v167, v166, s85
    v_mfma_f32_16x16x32_bf16 a[204:207], v[4:7], v[132:135], a[204:207]
    ds_read_b128 a[20:23], v36 offset:13312
    v_perm_b32 v148, v161, v160, s86
    v_mfma_f32_32x32x16_bf16 v[64:79], a[8:11], v[136:139], v[64:79]
    buffer_load_dwordx4 v10, s[4:7], s65 offen offset:2048 lds
    v_perm_b32 v149, v163, v162, s86
    v_perm_b32 v150, v165, v164, s86
    v_mfma_f32_16x16x32_bf16 a[204:207], v[4:7], v[136:139], a[204:207]
    ds_read_b128 a[24:27], v37 offset:12288
    v_perm_b32 v151, v167, v166, s86
    v_mfma_f32_32x32x16_bf16 v[80:95], a[12:15], v[140:143], v[80:95]
    buffer_load_dwordx4 v11, s[4:7], s65 offen offset:3072 lds
    v_perm_b32 v152, v169, v168, s85
    v_perm_b32 v153, v171, v170, s85
    v_mfma_f32_16x16x32_bf16 a[204:207], v[4:7], v[140:143], a[204:207]
    ds_read_b128 a[28:31], v37 offset:13312
    v_perm_b32 v154, v173, v172, s85
    v_perm_b32 v155, v175, v174, s85
    v_perm_b32 v156, v169, v168, s86
    v_perm_b32 v157, v171, v170, s86
    v_perm_b32 v158, v173, v172, s86
    v_perm_b32 v159, v175, v174, s86
    s_waitcnt vmcnt(4)
    ds_read_b128 v[176:179], v12 offset:4096
    ds_read_b128 v[180:183], v13 offset:4096
    ds_read_b128 v[184:187], v14 offset:4096
    ds_read_b128 v[188:191], v15 offset:4096
    v_dot2c_f32_bf16 v31, v144, v144
    v_dot2c_f32_bf16 v32, v145, v145
    v_dot2c_f32_bf16 v31, v146, v146
    v_dot2c_f32_bf16 v32, v147, v147
    v_dot2c_f32_bf16 v31, v148, v148
    v_dot2c_f32_bf16 v32, v149, v149
    v_dot2c_f32_bf16 v31, v150, v150
    v_dot2c_f32_bf16 v32, v151, v151
    v_dot2c_f32_bf16 v31, v152, v152
    v_dot2c_f32_bf16 v32, v153, v153
    v_dot2c_f32_bf16 v31, v154, v154
    v_dot2c_f32_bf16 v32, v155, v155
    v_dot2c_f32_bf16 v31, v156, v156
    v_dot2c_f32_bf16 v32, v157, v157
    v_dot2c_f32_bf16 v31, v158, v158
    v_dot2c_f32_bf16 v32, v159, v159
    s_waitcnt lgkmcnt(0)
    v_mfma_f32_32x32x16_bf16 v[64:79], a[16:19], v[144:147], v[64:79]
    s_add_u32 m0, s56, 0
    s_nop 0
    buffer_load_dwordx4 v8, s[4:7], s66 offen offset:0 lds
    v_perm_b32 v160, v177, v176, s85
    v_mfma_f32_16x16x32_bf16 a[204:207], v[4:7], v[144:147], a[204:207]
    ds_read_b128 a[0:3], v36 offset:16384
    v_perm_b32 v161, v179, v178, s85
    v_mfma_f32_32x32x16_bf16 v[80:95], a[20:23], v[148:151], v[80:95]
    buffer_load_dwordx4 v9, s[4:7], s66 offen offset:1024 lds
    v_perm_b32 v162, v181, v180, s85
    v_perm_b32 v163, v183, v182, s85
    v_mfma_f32_16x16x32_bf16 a[204:207], v[4:7], v[148:151], a[204:207]
    ds_read_b128 a[4:7], v36 offset:17408
    v_perm_b32 v164, v177, v176, s86
    v_mfma_f32_32x32x16_bf16 v[64:79], a[24:27], v[152:155], v[64:79]
    buffer_load_dwordx4 v10, s[4:7], s66 offen offset:2048 lds
    v_perm_b32 v165, v179, v178, s86
    v_perm_b32 v166, v181, v180, s86
    v_mfma_f32_16x16x32_bf16 a[204:207], v[4:7], v[152:155], a[204:207]
    ds_read_b128 a[8:11], v37 offset:16384
    v_perm_b32 v167, v183, v182, s86
    v_mfma_f32_32x32x16_bf16 v[80:95], a[28:31], v[156:159], v[80:95]
    buffer_load_dwordx4 v11, s[4:7], s66 offen offset:3072 lds
    v_perm_b32 v168, v185, v184, s85
    v_perm_b32 v169, v187, v186, s85
    v_mfma_f32_16x16x32_bf16 a[204:207], v[4:7], v[156:159], a[204:207]
    ds_read_b128 a[12:15], v37 offset:17408
    v_perm_b32 v170, v189, v188, s85
    v_perm_b32 v171, v191, v190, s85
    v_perm_b32 v172, v185, v184, s86
    v_perm_b32 v173, v187, v186, s86
    v_perm_b32 v174, v189, v188, s86
    v_perm_b32 v175, v191, v190, s86
    s_waitcnt vmcnt(4)
    ds_read_b128 v[192:195], v12 offset:8192
    ds_read_b128 v[196:199], v13 offset:8192
    ds_read_b128 v[200:203], v14 offset:8192
    ds_read_b128 v[204:207], v15 offset:8192
    v_dot2c_f32_bf16 v31, v160, v160
    v_dot2c_f32_bf16 v32, v161, v161
    v_dot2c_f32_bf16 v31, v162, v162
    v_dot2c_f32_bf16 v32, v163, v163
    v_dot2c_f32_bf16 v31, v164, v164
    v_dot2c_f32_bf16 v32, v165, v165
    v_dot2c_f32_bf16 v31, v166, v166
    v_dot2c_f32_bf16 v32, v167, v167
    v_dot2c_f32_bf16 v31, v168, v168
    v_dot2c_f32_bf16 v32, v169, v169
    v_dot2c_f32_bf16 v31, v170, v170
    v_dot2c_f32_bf16 v32, v171, v171
    v_dot2c_f32_bf16 v31, v172, v172
    v_dot2c_f32_bf16 v32, v173, v173
    v_dot2c_f32_bf16 v31, v174, v174
    v_dot2c_f32_bf16 v32, v175, v175
    s_waitcnt lgkmcnt(0)
    v_mfma_f32_32x32x16_bf16 v[64:79], a[0:3], v[160:163], v[64:79]
    s_add_u32 m0, s56, 4096
    s_nop 0
    buffer_load_dwordx4 v8, s[4:7], s67 offen offset:0 lds
    v_perm_b32 v176, v193, v192, s85
    v_mfma_f32_16x16x32_bf16 a[204:207], v[4:7], v[160:163], a[204:207]
    ds_read_b128 a[16:19], v36 offset:20480
    v_perm_b32 v177, v195, v194, s85
    v_mfma_f32_32x32x16_bf16 v[80:95], a[4:7], v[164:167], v[80:95]
    buffer_load_dwordx4 v9, s[4:7], s67 offen offset:1024 lds
    v_perm_b32 v178, v197, v196, s85
    v_perm_b32 v179, v199, v198, s85
    v_mfma_f32_16x16x32_bf16 a[204:207], v[4:7], v[164:167], a[204:207]
    ds_read_b128 a[20:23], v36 offset:21504
    v_perm_b32 v180, v193, v192, s86
    v_mfma_f32_32x32x16_bf16 v[64:79], a[8:11], v[168:171], v[64:79]
    buffer_load_dwordx4 v10, s[4:7], s67 offen offset:2048 lds
    v_perm_b32 v181, v195, v194, s86
    v_perm_b32 v182, v197, v196, s86
    v_mfma_f32_16x16x32_bf16 a[204:207], v[4:7], v[168:171], a[204:207]
    ds_read_b128 a[24:27], v37 offset:20480
    v_perm_b32 v183, v199, v198, s86
    v_mfma_f32_32x32x16_bf16 v[80:95], a[12:15], v[172:175], v[80:95]
    buffer_load_dwordx4 v11, s[4:7], s67 offen offset:3072 lds
    v_perm_b32 v184, v201, v200, s85
    v_perm_b32 v185, v203, v202, s85
    v_mfma_f32_16x16x32_bf16 a[204:207], v[4:7], v[172:175], a[204:207]
    ds_read_b128 a[28:31], v37 offset:21504
    v_perm_b32 v186, v205, v204, s85
    v_perm_b32 v187, v207, v206, s85
    v_perm_b32 v188, v201, v200, s86
    v_perm_b32 v189, v203, v202, s86
    v_perm_b32 v190, v205, v204, s86
    v_perm_b32 v191, v207, v206, s86
    s_waitcnt vmcnt(4)
    ds_read_b128 v[208:211], v12 offset:0
    ds_read_b128 v[212:215], v13 offset:0
    ds_read_b128 v[216:219], v14 offset:0
    ds_read_b128 v[220:223], v15 offset:0
    v_dot2c_f32_bf16 v31, v176, v176
    v_dot2c_f32_bf16 v32, v177, v177
    v_dot2c_f32_bf16 v31, v178, v178
    v_dot2c_f32_bf16 v32, v179, v179
    v_dot2c_f32_bf16 v31, v180, v180
    v_dot2c_f32_bf16 v32, v181, v181
    v_dot2c_f32_bf16 v31, v182, v182
    v_dot2c_f32_bf16 v32, v183, v183
    v_dot2c_f32_bf16 v31, v184, v184
    v_dot2c_f32_bf16 v32, v185, v185
    v_dot2c_f32_bf16 v31, v186, v186
    v_dot2c_f32_bf16 v32, v187, v187
    v_dot2c_f32_bf16 v31, v188, v188
    v_dot2c_f32_bf16 v32, v189, v189
    v_dot2c_f32_bf16 v31, v190, v190
    v_dot2c_f32_bf16 v32, v191, v191
    s_waitcnt lgkmcnt(0)
    v_mfma_f32_32x32x16_bf16 v[64:79], a[16:19], v[176:179], v[64:79]
    s_add_u32 m0, s56, 8192
    s_nop 0
    buffer_load_dwordx4 v8, s[4:7], s68 offen offset:0 lds
    v_perm_b32 v192, v209, v208, s85
    v_mfma_f32_16x16x32_bf16 a[204:207], v[4:7], v[176:179], a[204:207]
    ds_read_b128 a[0:3], v36 offset:24576
    v_perm_b32 v193, v211, v210, s85
    v_mfma_f32_32x32x16_bf16 v[80:95], a[20:23], v[180:183], v[80:95]
    buffer_load_dwordx4 v9, s[4:7], s68 offen offset:1024 lds
    v_perm_b32 v194, v213, v212, s85
    v_perm_b32 v195, v215, v214, s85
    v_mfma_f32_16x16x32_bf16 a[204:207], v[4:7], v[180:183], a[204:207]
    ds_read_b128 a[4:7], v36 offset:25600
    v_perm_b32 v196, v209, v208, s86
    v_mfma_f32_32x32x16_bf16 v[64:79], a[24:27], v[184:187], v[64:79]
    buffer_load_dwordx4 v10, s[4:7], s68 offen offset:2048 lds
    v_perm_b32 v197, v211, v210, s86
    v_perm_b32 v198, v213, v212, s86
    v_mfma_f32_16x16x32_bf16 a[204:207], v[4:7], v[184:187], a[204:207]
    ds_read_b128 a[8:11], v37 offset:24576
    v_perm_b32 v199, v215, v214, s86
    v_mfma_f32_32x32x16_bf16 v[80:95], a[28:31], v[188:191], v[80:95]
    buffer_load_dwordx4 v11, s[4:7], s68 offen offset:3072 lds
    v_perm_b32 v200, v217, v216, s85
    v_perm_b32 v201, v219, v218, s85
    v_mfma_f32_16x16x32_bf16 a[204:207], v[4:7], v[188:191], a[204:207]
    ds_read_b128 a[12:15], v37 offset:25600
    v_perm_b32 v202, v221, v220, s85
    v_perm_b32 v203, v223, v222, s85
    v_perm_b32 v204, v217, v216, s86
    v_perm_b32 v205, v219, v218, s86
    v_perm_b32 v206, v221, v220, s86
    v_perm_b32 v207, v223, v222, s86
    s_waitcnt vmcnt(4)
    ds_read_b128 v[224:227], v12 offset:4096
    ds_read_b128 v[228:231], v13 offset:4096
    ds_read_b128 v[232:235], v14 offset:4096
    ds_read_b128 v[236:239], v15 offset:4096
    v_dot2c_f32_bf16 v31, v192, v192
    v_dot2c_f32_bf16 v32, v193, v193
    v_dot2c_f32_bf16 v31, v194, v194
    v_dot2c_f32_bf16 v32, v195, v195
    v_dot2c_f32_bf16 v31, v196, v196
    v_dot2c_f32_bf16 v32, v197, v197
    v_dot2c_f32_bf16 v31, v198, v198
    v_dot2c_f32_bf16 v32, v199, v199
    v_dot2c_f32_bf16 v31, v200, v200
    v_dot2c_f32_bf16 v32, v201, v201
    v_dot2c_f32_bf16 v31, v202, v202
    v_dot2c_f32_bf16 v32, v203, v203
    v_dot2c_f32_bf16 v31, v204, v204
    v_dot2c_f32_bf16 v32, v205, v205
    v_dot2c_f32_bf16 v31, v206, v206
    v_dot2c_f32_bf16 v32, v207, v207
    s_waitcnt lgkmcnt(0)
    v_mfma_f32_32x32x16_bf16 v[64:79], a[0:3], v[192:195], v[64:79]
    s_add_u32 m0, s56, 0
    s_nop 0
    buffer_load_dwordx4 v8, s[4:7], s69 offen offset:0 lds
    v_perm_b32 v208, v225, v224, s85
    v_mfma_f32_16x16x32_bf16 a[204:207], v[4:7], v[192:195], a[204:207]
    ds_read_b128 a[16:19], v36 offset:28672
    v_perm_b32 v209, v227, v226, s85
    v_mfma_f32_32x32x16_bf16 v[80:95], a[4:7], v[196:199], v[80:95]
    buffer_load_dwordx4 v9, s[4:7], s69 offen offset:1024 lds
    v_perm_b32 v210, v229, v228, s85
    v_perm_b32 v211, v231, v230, s85
    v_mfma_f32_16x16x32_bf16 a[204:207], v[4:7], v[196:199], a[204:207]
    ds_read_b128 a[20:23], v36 offset:29696
    v_perm_b32 v212, v225, v224, s86
    v_mfma_f32_32x32x16_bf16 v[64:79], a[8:11], v[200:203], v[64:79]
    buffer_load_dwordx4 v10, s[4:7], s69 offen offset:2048 lds
    v_perm_b32 v213, v227, v226, s86
    v_perm_b32 v214, v229, v228, s86
    v_mfma_f32_16x16x32_bf16 a[204:207], v[4:7], v[200:203], a[204:207]
    ds_read_b128 a[24:27], v37 offset:28672
    v_perm_b32 v215, v231, v230, s86
    v_mfma_f32_32x32x16_bf16 v[80:95], a[12:15], v[204:207], v[80:95]
    buffer_load_dwordx4 v11, s[4:7], s69 offen offset:3072 lds
    v_perm_b32 v216, v233, v232, s85
    v_perm_b32 v217, v235, v234, s85
    v_mfma_f32_16x16x32_bf16 a[204:207], v[4:7], v[204:207], a[204:207]
    ds_read_b128 a[28:31], v37 offset:29696
    v_perm_b32 v218, v237, v236, s85
    v_perm_b32 v219, v239, v238, s85
    v_perm_b32 v220, v233, v232, s86
    v_perm_b32 v221, v235, v234, s86
    v_perm_b32 v222, v237, v236, s86
    v_perm_b32 v223, v239, v238, s86
    s_waitcnt vmcnt(4)
    ds_read_b128 v[240:243], v12 offset:8192
    ds_read_b128 v[244:247], v13 offset:8192
    ds_read_b128 v[248:251], v14 offset:8192
    ds_read_b128 v[252:255], v15 offset:8192
    v_dot2c_f32_bf16 v31, v208, v208
    v_dot2c_f32_bf16 v32, v209, v209
    v_dot2c_f32_bf16 v31, v210, v210
    v_dot2c_f32_bf16 v32, v211, v211
    v_dot2c_f32_bf16 v31, v212, v212
    v_dot2c_f32_bf16 v32, v213, v213
    v_dot2c_f32_bf16 v31, v214, v214
    v_dot2c_f32_bf16 v32, v215, v215
    v_dot2c_f32_bf16 v31, v216, v216
    v_dot2c_f32_bf16 v32, v217, v217
    v_dot2c_f32_bf16 v31, v218, v218
    v_dot2c_f32_bf16 v32, v219, v219
    v_dot2c_f32_bf16 v31, v220, v220
    v_dot2c_f32_bf16 v32, v221, v221
    v_dot2c_f32_bf16 v31, v222, v222
    v_dot2c_f32_bf16 v32, v223, v223
    s_waitcnt lgkmcnt(0)
    v_mfma_f32_32x32x16_bf16 v[64:79], a[16:19], v[208:211], v[64:79]
    s_add_u32 m0, s56, 12288
    s_nop 0
    buffer_load_dwordx4 v16, s[12:15], s70 offen lds
    v_perm_b32 v224, v241, v240, s85
    v_mfma_f32_16x16x32_bf16 a[204:207], v[4:7], v[208:211], a[204:207]
    ds_read_b128 a[0:3], v36 offset:32768
    v_perm_b32 v225, v243, v242, s85
    v_mfma_f32_32x32x16_bf16 v[80:95], a[20:23], v[212:215], v[80:95]
    buffer_load_dwordx4 v17, s[12:15], s70 offen offset:1024 lds
    v_perm_b32 v226, v245, v244, s85
    v_perm_b32 v227, v247, v246, s85
    v_mfma_f32_16x16x32_bf16 a[204:207], v[4:7], v[212:215], a[204:207]
    ds_read_b128 a[4:7], v36 offset:33792
    v_perm_b32 v228, v241, v240, s86
    v_mfma_f32_32x32x16_bf16 v[64:79], a[24:27], v[216:219], v[64:79]
    s_add_u32 m0, s56, 14336
    s_nop 0
    buffer_load_dwordx4 v16, s[12:15], s71 offen lds
    v_perm_b32 v229, v243, v242, s86
    v_mfma_f32_16x16x32_bf16 a[204:207], v[4:7], v[216:219], a[204:207]
    ds_read_b128 a[8:11], v37 offset:32768
    v_perm_b32 v230, v245, v244, s86
    v_mfma_f32_32x32x16_bf16 v[80:95], a[28:31], v[220:223], v[80:95]
    buffer_load_dwordx4 v17, s[12:15], s71 offen offset:1024 lds
    v_perm_b32 v231, v247, v246, s86
    v_perm_b32 v232, v249, v248, s85
    v_mfma_f32_16x16x32_bf16 a[204:207], v[4:7], v[220:223], a[204:207]
    ds_read_b128 a[12:15], v37 offset:33792
    v_perm_b32 v233, v251, v250, s85
    v_perm_b32 v234, v253, v252, s85
    v_perm_b32 v235, v255, v254, s85
    v_perm_b32 v236, v249, v248, s86
    v_perm_b32 v237, v251, v250, s86
    v_perm_b32 v238, v253, v252, s86
    v_perm_b32 v239, v255, v254, s86
    s_waitcnt vmcnt(4)
    ds_read_b128 v[40:43], v12 offset:0
    ds_read_b128 v[44:47], v13 offset:0
    ds_read_b128 v[48:51], v14 offset:0
    ds_read_b128 v[52:55], v15 offset:0
    v_dot2c_f32_bf16 v31, v224, v224
    v_dot2c_f32_bf16 v32, v225, v225
    v_dot2c_f32_bf16 v31, v226, v226
    v_dot2c_f32_bf16 v32, v227, v227
    v_dot2c_f32_bf16 v31, v228, v228
    v_dot2c_f32_bf16 v32, v229, v229
    v_dot2c_f32_bf16 v31, v230, v230
    v_dot2c_f32_bf16 v32, v231, v231
    v_dot2c_f32_bf16 v31, v232, v232
    v_dot2c_f32_bf16 v32, v233, v233
    v_dot2c_f32_bf16 v31, v234, v234
    v_dot2c_f32_bf16 v32, v235, v235
    v_dot2c_f32_bf16 v31, v236, v236
    v_dot2c_f32_bf16 v32, v237, v237
    v_dot2c_f32_bf16 v31, v238, v238
    v_dot2c_f32_bf16 v32, v239, v239
    s_waitcnt lgkmcnt(0)
    v_mfma_f32_32x32x16_bf16 v[64:79], a[0:3], v[224:227], v[64:79]
    s_add_u32 m0, s56, 16384
    s_nop 0
    buffer_load_dwordx4 v16, s[12:15], s72 offen lds
    v_perm_b32 v240, v41, v40, s85
    v_mfma_f32_16x16x32_bf16 a[204:207], v[4:7], v[224:227], a[204:207]
    ds_read_b128 a[16:19], v36 offset:36864
    v_perm_b32 v241, v43, v42, s85
    v_mfma_f32_32x32x16_bf16 v[80:95], a[4:7], v[228:231], v[80:95]
    buffer_load_dwordx4 v17, s[12:15], s72 offen offset:1024 lds
    v_perm_b32 v242, v45, v44, s85
    v_perm_b32 v243, v47, v46, s85
    v_mfma_f32_16x16x32_bf16 a[204:207], v[4:7], v[228:231], a[204:207]
    ds_read_b128 a[20:23], v36 offset:37888
    v_perm_b32 v244, v41, v40, s86
    v_mfma_f32_32x32x16_bf16 v[64:79], a[8:11], v[232:235], v[64:79]
    s_add_u32 m0, s56, 18432
    s_nop 0
    buffer_load_dwordx4 v16, s[12:15], s73 offen lds
    v_perm_b32 v245, v43, v42, s86
    v_mfma_f32_16x16x32_bf16 a[204:207], v[4:7], v[232:235], a[204:207]
    ds_read_b128 a[24:27], v37 offset:36864
    v_perm_b32 v246, v45, v44, s86
    v_mfma_f32_32x32x16_bf16 v[80:95], a[12:15], v[236:239], v[80:95]
    buffer_load_dwordx4 v17, s[12:15], s73 offen offset:1024 lds
    v_perm_b32 v247, v47, v46, s86
    v_perm_b32 v248, v49, v48, s85
    v_mfma_f32_16x16x32_bf16 a[204:207], v[4:7], v[236:239], a[204:207]
    ds_read_b128 a[28:31], v37 offset:37888
    v_perm_b32 v249, v51, v50, s85
    v_perm_b32 v250, v53, v52, s85
    v_perm_b32 v251, v55, v54, s85
    v_perm_b32 v252, v49, v48, s86
    v_perm_b32 v253, v51, v50, s86
    v_perm_b32 v254, v53, v52, s86
    v_perm_b32 v255, v55, v54, s86
    v_dot2c_f32_bf16 v31, v240, v240
    v_dot2c_f32_bf16 v32, v241, v241
    v_dot2c_f32_bf16 v31, v242, v242
    v_dot2c_f32_bf16 v32, v243, v243
    v_dot2c_f32_bf16 v31, v244, v244
    v_dot2c_f32_bf16 v32, v245, v245
    v_dot2c_f32_bf16 v31, v246, v246
    v_dot2c_f32_bf16 v32, v247, v247
    v_dot2c_f32_bf16 v31, v248, v248
    v_dot2c_f32_bf16 v32, v249, v249
    v_dot2c_f32_bf16 v31, v250, v250
    v_dot2c_f32_bf16 v32, v251, v251
    v_dot2c_f32_bf16 v31, v252, v252
    v_dot2c_f32_bf16 v32, v253, v253
    v_dot2c_f32_bf16 v31, v254, v254
    v_dot2c_f32_bf16 v32, v255, v255
    s_waitcnt lgkmcnt(0)
    s_barrier
    v_mfma_f32_16x16x32_bf16 a[204:207], v[4:7], v[240:243], a[204:207]
    v_mfma_f32_16x16x32_bf16 a[204:207], v[4:7], v[244:247], a[204:207]
    v_mfma_f32_16x16x32_bf16 a[204:207], v[4:7], v[248:251], a[204:207]
    v_mfma_f32_16x16x32_bf16 a[204:207], v[4:7], v[252:255], a[204:207]
    v_mfma_f32_32x32x16_bf16 v[64:79], a[16:19], v[240:243], v[64:79]
    v_add_f32 v31, v31, v32
    v_and_b32 v1, 16, v0
    v_cmp_ne_u32 vcc, 0, v1
    v_mov_b32 v32, v31
    v_and_b32 v1, 31, v0
    s_lshl_b32 s57, s50, 7
    v_mfma_f32_32x32x16_bf16 v[80:95], a[20:23], v[244:247], v[80:95]
    v_permlane32_swap_b32 v31, v32
    v_accvgpr_read_b32 v29, a204
    v_accvgpr_read_b32 v30, a205
    v_add_f32 v31, v31, v32
    v_cndmask_b32 v29, v29, v30, vcc
    v_mul_f32 v33, 0xbacccccd, v29
    v_mfma_f32_32x32x16_bf16 v[64:79], a[24:27], v[248:251], v[64:79]
    v_mul_f32 v31, 0x3acccccd, v31
    v_fma_f32 v31, -v33, v33, v31
    v_max_f32 v31, 0, v31
    v_add_f32 v31, 0x3727c5ac, v31
    v_rsq_f32 v34, v31
    v_mfma_f32_32x32x16_bf16 v[80:95], a[28:31], v[252:255], v[80:95]
    s_add_u32 s57, s57, 156672
    v_lshl_add_u32 v1, v1, 2, s57
    ds_write_b32 v1, v34
    v_cvt_pk_bf16_f32 v12, v33, v33
    v_mov_b32 v14, 0
    v_mov_b32 v15, 0
    v_lshlrev_b32 v13, 16, v12
    v_sub_f32 v13, v33, v13
    v_cvt_pk_bf16_f32 v13, v13, v14
    v_cmp_gt_u32 vcc, 32, v0
    s_nop 1
    v_cndmask_b32 v12, 0, v12, vcc
    v_cndmask_b32 v13, 0, v13, vcc
    v_mul_f32 v34, 0xb58df4e0, v34
    s_cmp_eq_u32 s54, 0
    s_cselect_b32 s88, -1, 0
    s_add_u32 m0, s56, 20480
    s_mov_b32 s89, 0
    buffer_load_dwordx4 v16, s[12:15], s74 offen lds
    v_pk_mul_f32 v[44:45], v[80:81], v[34:35] op_sel_hi:[1,0]
    v_pk_fma_f32 v[80:81], v[64:65], v[34:35], v[44:45] op_sel_hi:[1,0,1] neg_lo:[0,0,1] neg_hi:[1,0,0]
    v_pk_fma_f32 v[64:65], v[64:65], v[34:35], v[44:45] op_sel_hi:[1,0,1]
    s_mov_b64 exec, s[88:89]
    v_sub_f32 v64, v65, v45
    v_mov_b32 v65, v45
    v_mov_b32 v81, 0
    s_mov_b64 exec, -1
    v_pk_mul_f32 v[46:47], v[82:83], v[34:35] op_sel_hi:[1,0]
    v_pk_fma_f32 v[82:83], v[66:67], v[34:35], v[46:47] op_sel_hi:[1,0,1] neg_lo:[0,0,1] neg_hi:[1,0,0]
    v_pk_fma_f32 v[66:67], v[66:67], v[34:35], v[46:47] op_sel_hi:[1,0,1]
    v_pk_mul_f32 v[44:45], v[84:85], v[34:35] op_sel_hi:[1,0]
    v_pk_fma_f32 v[84:85], v[68:69], v[34:35], v[44:45] op_sel_hi:[1,0,1] neg_lo:[0,0,1] neg_hi:[1,0,0]
    v_pk_fma_f32 v[68:69], v[68:69], v[34:35], v[44:45] op_sel_hi:[1,0,1]
    v_pk_mul_f32 v[46:47], v[86:87], v[34:35] op_sel_hi:[1,0]
    v_pk_fma_f32 v[86:87], v[70:71], v[34:35], v[46:47] op_sel_hi:[1,0,1] neg_lo:[0,0,1] neg_hi:[1,0,0]
    buffer_load_dwordx4 v17, s[12:15], s74 offen offset:1024 lds
    v_pk_fma_f32 v[70:71], v[70:71], v[34:35], v[46:47] op_sel_hi:[1,0,1]
    v_pk_mul_f32 v[44:45], v[88:89], v[34:35] op_sel_hi:[1,0]
    v_pk_fma_f32 v[88:89], v[72:73], v[34:35], v[44:45] op_sel_hi:[1,0,1] neg_lo:[0,0,1] neg_hi:[1,0,0]
    v_pk_fma_f32 v[72:73], v[72:73], v[34:35], v[44:45] op_sel_hi:[1,0,1]
    v_pk_mul_f32 v[46:47], v[90:91], v[34:35] op_sel_hi:[1,0]
    v_pk_fma_f32 v[90:91], v[74:75], v[34:35], v[46:47] op_sel_hi:[1,0,1] neg_lo:[0,0,1] neg_hi:[1,0,0]
    v_pk_fma_f32 v[74:75], v[74:75], v[34:35], v[46:47] op_sel_hi:[1,0,1]
    v_pk_mul_f32 v[44:45], v[92:93], v[34:35] op_sel_hi:[1,0]
    v_pk_fma_f32 v[92:93], v[76:77], v[34:35], v[44:45] op_sel_hi:[1,0,1] neg_lo:[0,0,1] neg_hi:[1,0,0]
    s_add_u32 m0, s56, 22528
    v_pk_fma_f32 v[76:77], v[76:77], v[34:35], v[44:45] op_sel_hi:[1,0,1]
    buffer_load_dwordx4 v16, s[12:15], s75 offen lds
    v_pk_mul_f32 v[46:47], v[94:95], v[34:35] op_sel_hi:[1,0]
    v_pk_fma_f32 v[94:95], v[78:79], v[34:35], v[46:47] op_sel_hi:[1,0,1] neg_lo:[0,0,1] neg_hi:[1,0,0]
    v_pk_fma_f32 v[78:79], v[78:79], v[34:35], v[46:47] op_sel_hi:[1,0,1]
    v_fmac_f32_dpp v64, v64, v58 quad_perm:[1,0,3,2] row_mask:0xf bank_mask:0xf
    v_fmac_f32_dpp v65, v65, v58 quad_perm:[1,0,3,2] row_mask:0xf bank_mask:0xf
    v_fmac_f32_dpp v66, v66, v58 quad_perm:[1,0,3,2] row_mask:0xf bank_mask:0xf
    v_fmac_f32_dpp v67, v67, v58 quad_perm:[1,0,3,2] row_mask:0xf bank_mask:0xf
    v_fmac_f32_dpp v68, v68, v58 quad_perm:[1,0,3,2] row_mask:0xf bank_mask:0xf
    v_fmac_f32_dpp v69, v69, v58 quad_perm:[1,0,3,2] row_mask:0xf bank_mask:0xf
    v_fmac_f32_dpp v70, v70, v58 quad_perm:[1,0,3,2] row_mask:0xf bank_mask:0xf
    v_fmac_f32_dpp v71, v71, v58 quad_perm:[1,0,3,2] row_mask:0xf bank_mask:0xf
    buffer_load_dwordx4 v17, s[12:15], s75 offen offset:1024 lds
    v_fmac_f32_dpp v72, v72, v58 quad_perm:[1,0,3,2] row_mask:0xf bank_mask:0xf
    v_fmac_f32_dpp v73, v73, v58 quad_perm:[1,0,3,2] row_mask:0xf bank_mask:0xf
    v_fmac_f32_dpp v74, v74, v58 quad_perm:[1,0,3,2] row_mask:0xf bank_mask:0xf
    v_fmac_f32_dpp v75, v75, v58 quad_perm:[1,0,3,2] row_mask:0xf bank_mask:0xf
    v_fmac_f32_dpp v76, v76, v58 quad_perm:[1,0,3,2] row_mask:0xf bank_mask:0xf
    v_fmac_f32_dpp v77, v77, v58 quad_perm:[1,0,3,2] row_mask:0xf bank_mask:0xf
    v_fmac_f32_dpp v78, v78, v58 quad_perm:[1,0,3,2] row_mask:0xf bank_mask:0xf
    v_fmac_f32_dpp v79, v79, v58 quad_perm:[1,0,3,2] row_mask:0xf bank_mask:0xf
    v_fmac_f32_dpp v80, v80, v58 quad_perm:[1,0,3,2] row_mask:0xf bank_mask:0xf
    s_add_u32 m0, s56, 24576
    v_fmac_f32_dpp v81, v81, v58 quad_perm:[1,0,3,2] row_mask:0xf bank_mask:0xf
    buffer_load_dwordx4 v16, s[12:15], s76 offen lds
    v_fmac_f32_dpp v82, v82, v58 quad_perm:[1,0,3,2] row_mask:0xf bank_mask:0xf
    v_fmac_f32_dpp v83, v83, v58 quad_perm:[1,0,3,2] row_mask:0xf bank_mask:0xf
    v_fmac_f32_dpp v84, v84, v58 quad_perm:[1,0,3,2] row_mask:0xf bank_mask:0xf
    v_fmac_f32_dpp v85, v85, v58 quad_perm:[1,0,3,2] row_mask:0xf bank_mask:0xf
    v_fmac_f32_dpp v86, v86, v58 quad_perm:[1,0,3,2] row_mask:0xf bank_mask:0xf
    v_fmac_f32_dpp v87, v87, v58 quad_perm:[1,0,3,2] row_mask:0xf bank_mask:0xf
    v_fmac_f32_dpp v88, v88, v58 quad_perm:[1,0,3,2] row_mask:0xf bank_mask:0xf
    v_fmac_f32_dpp v89, v89, v58 quad_perm:[1,0,3,2] row_mask:0xf bank_mask:0xf
    v_fmac_f32_dpp v90, v90, v58 quad_perm:[1,0,3,2] row_mask:0xf bank_mask:0xf
    v_fmac_f32_dpp v91, v91, v58 quad_perm:[1,0,3,2] row_mask:0xf bank_mask:0xf
    v_fmac_f32_dpp v92, v92, v58 quad_perm:[1,0,3,2] row_mask:0xf bank_mask:0xf
    buffer_load_dwordx4 v17, s[12:15], s76 offen offset:1024 lds
    v_fmac_f32_dpp v93, v93, v58 quad_perm:[1,0,3,2] row_mask:0xf bank_mask:0xf
    v_fmac_f32_dpp v94, v94, v58 quad_perm:[1,0,3,2] row_mask:0xf bank_mask:0xf
    v_fmac_f32_dpp v95, v95, v58 quad_perm:[1,0,3,2] row_mask:0xf bank_mask:0xf
    v_pk_mul_f32 v[44:45], v[64:65], v[56:57] op_sel_hi:[1,0]
    v_pk_fma_f32 v[64:65], v[64:65], v[56:57], v[44:45] op_sel:[1,1,0] op_sel_hi:[0,1,1] neg_lo:[0,1,0]
    v_pk_mul_f32 v[46:47], v[80:81], v[56:57] op_sel_hi:[1,0]
    v_pk_fma_f32 v[80:81], v[80:81], v[56:57], v[46:47] op_sel:[1,1,0] op_sel_hi:[0,1,1] neg_lo:[0,1,0]
    v_cvt_pk_bf16_f32 v48, v64, v65
    v_cvt_pk_bf16_f32 v49, v80, v81
    ds_write_b32 v59, v48 offset:0
    ds_write_b32 v59, v49 offset:512
    v_pk_mul_f32 v[44:45], v[66:67], v[56:57] op_sel_hi:[1,0]
    v_pk_fma_f32 v[66:67], v[66:67], v[56:57], v[44:45] op_sel:[1,1,0] op_sel_hi:[0,1,1] neg_lo:[0,1,0]
    v_pk_mul_f32 v[46:47], v[82:83], v[56:57] op_sel_hi:[1,0]
    v_pk_fma_f32 v[82:83], v[82:83], v[56:57], v[46:47] op_sel:[1,1,0] op_sel_hi:[0,1,1] neg_lo:[0,1,0]
    v_cvt_pk_bf16_f32 v50, v66, v67
    v_cvt_pk_bf16_f32 v51, v82, v83
    ds_write_b32 v59, v50 offset:1024
    ds_write_b32 v59, v51 offset:1536
    v_pk_mul_f32 v[44:45], v[68:69], v[56:57] op_sel_hi:[1,0]
    v_pk_fma_f32 v[68:69], v[68:69], v[56:57], v[44:45] op_sel:[1,1,0] op_sel_hi:[0,1,1] neg_lo:[0,1,0]
    v_pk_mul_f32 v[46:47], v[84:85], v[56:57] op_sel_hi:[1,0]
    v_pk_fma_f32 v[84:85], v[84:85], v[56:57], v[46:47] op_sel:[1,1,0] op_sel_hi:[0,1,1] neg_lo:[0,1,0]
    v_cvt_pk_bf16_f32 v48, v68, v69
    v_cvt_pk_bf16_f32 v49, v84, v85
    ds_write_b32 v59, v48 offset:4096
    ds_write_b32 v59, v49 offset:4608
    v_pk_mul_f32 v[44:45], v[70:71], v[56:57] op_sel_hi:[1,0]
    v_pk_fma_f32 v[70:71], v[70:71], v[56:57], v[44:45] op_sel:[1,1,0] op_sel_hi:[0,1,1] neg_lo:[0,1,0]
    v_pk_mul_f32 v[46:47], v[86:87], v[56:57] op_sel_hi:[1,0]
    v_pk_fma_f32 v[86:87], v[86:87], v[56:57], v[46:47] op_sel:[1,1,0] op_sel_hi:[0,1,1] neg_lo:[0,1,0]
    v_cvt_pk_bf16_f32 v50, v70, v71
    v_cvt_pk_bf16_f32 v51, v86, v87
    ds_write_b32 v59, v50 offset:5120
    ds_write_b32 v59, v51 offset:5632
    v_pk_mul_f32 v[44:45], v[72:73], v[56:57] op_sel_hi:[1,0]
    v_pk_fma_f32 v[72:73], v[72:73], v[56:57], v[44:45] op_sel:[1,1,0] op_sel_hi:[0,1,1] neg_lo:[0,1,0]
    v_pk_mul_f32 v[46:47], v[88:89], v[56:57] op_sel_hi:[1,0]
    v_pk_fma_f32 v[88:89], v[88:89], v[56:57], v[46:47] op_sel:[1,1,0] op_sel_hi:[0,1,1] neg_lo:[0,1,0]
    v_cvt_pk_bf16_f32 v48, v72, v73
    v_cvt_pk_bf16_f32 v49, v88, v89
    ds_write_b32 v59, v48 offset:8192
    ds_write_b32 v59, v49 offset:8704
    v_pk_mul_f32 v[44:45], v[74:75], v[56:57] op_sel_hi:[1,0]
    v_pk_fma_f32 v[74:75], v[74:75], v[56:57], v[44:45] op_sel:[1,1,0] op_sel_hi:[0,1,1] neg_lo:[0,1,0]
    v_pk_mul_f32 v[46:47], v[90:91], v[56:57] op_sel_hi:[1,0]
    v_pk_fma_f32 v[90:91], v[90:91], v[56:57], v[46:47] op_sel:[1,1,0] op_sel_hi:[0,1,1] neg_lo:[0,1,0]
    v_cvt_pk_bf16_f32 v50, v74, v75
    v_cvt_pk_bf16_f32 v51, v90, v91
    ds_write_b32 v59, v50 offset:9216
    ds_write_b32 v59, v51 offset:9728
    v_pk_mul_f32 v[44:45], v[76:77], v[56:57] op_sel_hi:[1,0]
    v_pk_fma_f32 v[76:77], v[76:77], v[56:57], v[44:45] op_sel:[1,1,0] op_sel_hi:[0,1,1] neg_lo:[0,1,0]
    v_pk_mul_f32 v[46:47], v[92:93], v[56:57] op_sel_hi:[1,0]
    v_pk_fma_f32 v[92:93], v[92:93], v[56:57], v[46:47] op_sel:[1,1,0] op_sel_hi:[0,1,1] neg_lo:[0,1,0]
    v_cvt_pk_bf16_f32 v48, v76, v77
    v_cvt_pk_bf16_f32 v49, v92, v93
    ds_write_b32 v59, v48 offset:12288
    ds_write_b32 v59, v49 offset:12800
    v_pk_mul_f32 v[44:45], v[78:79], v[56:57] op_sel_hi:[1,0]
    v_pk_fma_f32 v[78:79], v[78:79], v[56:57], v[44:45] op_sel:[1,1,0] op_sel_hi:[0,1,1] neg_lo:[0,1,0]
    v_pk_mul_f32 v[46:47], v[94:95], v[56:57] op_sel_hi:[1,0]
    v_pk_fma_f32 v[94:95], v[94:95], v[56:57], v[46:47] op_sel:[1,1,0] op_sel_hi:[0,1,1] neg_lo:[0,1,0]
    v_cvt_pk_bf16_f32 v50, v78, v79
    v_cvt_pk_bf16_f32 v51, v94, v95
    ds_write_b32 v59, v50 offset:13312
    ds_write_b32 v59, v51 offset:13824
    s_waitcnt vmcnt(10)
    s_waitcnt lgkmcnt(0)
    s_barrier
    ds_read_b128 a[0:3], v60 offset:0
    ds_read_b128 a[4:7], v60 offset:4096
    ds_read_b128 a[8:11], v60 offset:8192
    ds_read_b128 a[12:15], v60 offset:12288
    v_mov_b32 v3, v61
    ds_read_b64_tr_b16 v[40:41], v20 offset:12288
    ds_read_b64_tr_b16 v[42:43], v20 offset:12800
    ds_read_b64_tr_b16 v[44:45], v21 offset:12288
    ds_read_b64_tr_b16 v[46:47], v21 offset:12800
    ds_read_b64_tr_b16 v[48:49], v20 offset:40960
    ds_read_b64_tr_b16 v[50:51], v20 offset:41472
    ds_read_b64_tr_b16 v[52:53], v21 offset:40960
    ds_read_b64_tr_b16 v[54:55], v21 offset:41472
    ds_read_b64_tr_b16 v[56:57], v22 offset:12288
    ds_read_b64_tr_b16 v[58:59], v22 offset:12800
    ds_read_b64_tr_b16 v[60:61], v23 offset:12288
    ds_read_b64_tr_b16 v[62:63], v23 offset:12800
    s_waitcnt lgkmcnt(12)
    s_waitcnt lgkmcnt(8)
    v_mfma_f32_32x32x16_bf16 v[64:79], v[40:43], v[96:99], 0
    ds_read_b64_tr_b16 a[196:197], v22 offset:40960
    ds_read_b64_tr_b16 a[198:199], v22 offset:41472
    buffer_store_dwordx4 a[0:3], v3, s[8:11], s90 offen sc1
    v_mfma_f32_32x32x16_bf16 v[80:95], v[44:47], v[96:99], 0
    ds_read_b64_tr_b16 a[200:201], v23 offset:40960
    ds_read_b64_tr_b16 a[202:203], v23 offset:41472
    buffer_store_dwordx4 a[4:7], v3, s[8:11], s91 offen sc1
    v_mfma_f32_16x16x32_bf16 a[204:207], v[40:43], v[4:7], 0
    s_mul_i32 s59, s50, 3
    s_waitcnt lgkmcnt(8)
    v_mfma_f32_32x32x16_bf16 v[64:79], v[48:51], v[100:103], v[64:79]
    ds_read_b64_tr_b16 v[40:41], v20 offset:14336
    ds_read_b64_tr_b16 v[42:43], v20 offset:14848
    buffer_store_dwordx4 a[8:11], v3, s[8:11], s92 offen sc1
    v_mfma_f32_32x32x16_bf16 v[80:95], v[52:55], v[100:103], v[80:95]
    ds_read_b64_tr_b16 v[44:45], v21 offset:14336
    ds_read_b64_tr_b16 v[46:47], v21 offset:14848
    buffer_store_dwordx4 a[12:15], v3, s[8:11], s93 offen sc1
    v_mfma_f32_16x16x32_bf16 a[204:207], v[48:51], v[4:7], a[204:207]
    s_mul_i32 s57, s82, 54
    s_waitcnt lgkmcnt(8)
    v_mfma_f32_32x32x16_bf16 v[64:79], v[56:59], v[104:107], v[64:79]
    s_add_u32 m0, s56, 26624
    ds_read_b64_tr_b16 v[48:49], v20 offset:43008
    ds_read_b64_tr_b16 v[50:51], v20 offset:43520
    buffer_load_dwordx4 v16, s[12:15], s77 offen lds
    v_mfma_f32_32x32x16_bf16 v[80:95], v[60:63], v[104:107], v[80:95]
    ds_read_b64_tr_b16 v[52:53], v21 offset:43008
    ds_read_b64_tr_b16 v[54:55], v21 offset:43520
    s_add_u32 s60, s57, s59
    s_lshl_b32 s60, s60, 12
    s_add_u32 s60, s60, 7864320
    s_waitcnt lgkmcnt(8)
    v_mfma_f32_32x32x16_bf16 v[64:79], a[196:199], v[108:111], v[64:79]
    ds_read_b64_tr_b16 v[56:57], v22 offset:14336
    ds_read_b64_tr_b16 v[58:59], v22 offset:14848
    buffer_load_dwordx4 v17, s[12:15], s77 offen offset:1024 lds
    v_mfma_f32_32x32x16_bf16 v[80:95], a[200:203], v[108:111], v[80:95]
    ds_read_b64_tr_b16 v[60:61], v23 offset:14336
    ds_read_b64_tr_b16 v[62:63], v23 offset:14848
    s_mul_i32 s57, s83, 54
    s_add_u32 s61, s57, s59
    s_mul_i32 s61, s61, 5120
    s_waitcnt lgkmcnt(8)
    v_mfma_f32_32x32x16_bf16 v[64:79], v[40:43], v[112:115], v[64:79]
    s_add_u32 m0, s56, 4096
    ds_read_b64_tr_b16 a[196:197], v22 offset:43008
    ds_read_b64_tr_b16 a[198:199], v22 offset:43520
    buffer_load_dwordx4 v16, s[12:15], s78 offen lds
    v_mfma_f32_32x32x16_bf16 v[80:95], v[44:47], v[112:115], v[80:95]
    ds_read_b64_tr_b16 a[200:201], v23 offset:43008
    ds_read_b64_tr_b16 a[202:203], v23 offset:43520
    s_add_u32 s61, s61, 14942208
    s_add_u32 s35, s60, 131072
    s_add_u32 s39, s61, 163840
    s_lshl_b32 s59, s50, 1
    v_mfma_f32_16x16x32_bf16 a[204:207], v[40:43], v[4:7], a[204:207]
    s_add_u32 s59, s59, 12
    s_waitcnt lgkmcnt(8)
    v_mfma_f32_32x32x16_bf16 v[64:79], v[48:51], v[116:119], v[64:79]
    s_waitcnt vmcnt(13)
    s_barrier
    ds_read_b64_tr_b16 v[40:41], v20 offset:16384
    ds_read_b64_tr_b16 v[42:43], v20 offset:16896
    buffer_load_dwordx4 v17, s[12:15], s78 offen offset:1024 lds
    v_mfma_f32_32x32x16_bf16 v[80:95], v[52:55], v[116:119], v[80:95]
    ds_read_b64_tr_b16 v[44:45], v21 offset:16384
    ds_read_b64_tr_b16 v[46:47], v21 offset:16896
    s_lshl_b32 s57, s59, 12
    s_add_u32 s32, s60, s57
    s_mul_i32 s57, s59, 5120
    s_add_u32 s36, s61, s57
    v_mfma_f32_16x16x32_bf16 a[204:207], v[48:51], v[4:7], a[204:207]
    s_waitcnt lgkmcnt(8)
    v_mfma_f32_32x32x16_bf16 v[64:79], v[56:59], v[120:123], v[64:79]
    s_add_u32 m0, s56, 6144
    ds_read_b64_tr_b16 v[48:49], v20 offset:45056
    ds_read_b64_tr_b16 v[50:51], v20 offset:45568
    buffer_load_dwordx4 v16, s[12:15], s79 offen lds
    v_mfma_f32_32x32x16_bf16 v[80:95], v[60:63], v[120:123], v[80:95]
    ds_read_b64_tr_b16 v[52:53], v21 offset:45056
    ds_read_b64_tr_b16 v[54:55], v21 offset:45568
    s_cmp_eq_u32 s50, 3
    s_cselect_b32 s59, 11, 12
    s_lshl_b32 s57, s59, 12
    s_waitcnt lgkmcnt(8)
    v_mfma_f32_32x32x16_bf16 v[64:79], a[196:199], v[124:127], v[64:79]
    ds_read_b64_tr_b16 v[56:57], v22 offset:16384
    ds_read_b64_tr_b16 v[58:59], v22 offset:16896
    buffer_load_dwordx4 v17, s[12:15], s79 offen offset:1024 lds
    v_mfma_f32_32x32x16_bf16 v[80:95], a[200:203], v[124:127], v[80:95]
    ds_read_b64_tr_b16 v[60:61], v23 offset:16384
    ds_read_b64_tr_b16 v[62:63], v23 offset:16896
    s_add_u32 s33, s35, s57
    s_mul_i32 s57, s59, 5120
    s_add_u32 s37, s39, s57
    s_waitcnt lgkmcnt(8)
    v_mfma_f32_32x32x16_bf16 v[64:79], v[40:43], v[128:131], v[64:79]
    s_add_u32 m0, s56, 8192
    ds_read_b64_tr_b16 a[196:197], v22 offset:45056
    ds_read_b64_tr_b16 a[198:199], v22 offset:45568
    buffer_load_dwordx4 v18, s[12:15], s70 offen lds
    v_mfma_f32_32x32x16_bf16 v[80:95], v[44:47], v[128:131], v[80:95]
    ds_read_b64_tr_b16 a[200:201], v23 offset:45056
    ds_read_b64_tr_b16 a[202:203], v23 offset:45568
    s_add_u32 s34, s33, 8192
    s_add_u32 s38, s37, 10240
    v_mfma_f32_16x16x32_bf16 a[204:207], v[40:43], v[4:7], a[204:207]
    s_waitcnt lgkmcnt(8)
    v_mfma_f32_32x32x16_bf16 v[64:79], v[48:51], v[132:135], v[64:79]
    s_add_u32 m0, s56, 9216
    ds_read_b64_tr_b16 v[40:41], v20 offset:18432
    ds_read_b64_tr_b16 v[42:43], v20 offset:18944
    buffer_load_dwordx4 v18, s[12:15], s71 offen lds
    v_mfma_f32_32x32x16_bf16 v[80:95], v[52:55], v[132:135], v[80:95]
    ds_read_b64_tr_b16 v[44:45], v21 offset:18432
    ds_read_b64_tr_b16 v[46:47], v21 offset:18944
    s_cmp_ge_u32 s50, 2
    s_cselect_b32 s34, s33, s34
    s_cselect_b32 s38, s37, s38
    s_cselect_b32 s18, 0, 18874368
    v_mfma_f32_16x16x32_bf16 a[204:207], v[48:51], v[4:7], a[204:207]
    s_mov_b32 s16, s8
    s_waitcnt lgkmcnt(8)
    v_mfma_f32_32x32x16_bf16 v[64:79], v[56:59], v[136:139], v[64:79]
    s_add_u32 m0, s56, 10240
    ds_read_b64_tr_b16 v[48:49], v20 offset:47104
    ds_read_b64_tr_b16 v[50:51], v20 offset:47616
    buffer_load_dwordx4 v18, s[12:15], s72 offen lds
    v_mfma_f32_32x32x16_bf16 v[80:95], v[60:63], v[136:139], v[80:95]
    ds_read_b64_tr_b16 v[52:53], v21 offset:47104
    ds_read_b64_tr_b16 v[54:55], v21 offset:47616
    s_mov_b32 s17, s9
    s_lshr_b32 s57, s50, 1
    s_lshl_b32 s58, s51, 1
    s_waitcnt lgkmcnt(8)
    v_mfma_f32_32x32x16_bf16 v[64:79], a[196:199], v[140:143], v[64:79]
    s_add_u32 m0, s56, 11264
    ds_read_b64_tr_b16 v[56:57], v22 offset:18432
    ds_read_b64_tr_b16 v[58:59], v22 offset:18944
    buffer_load_dwordx4 v18, s[12:15], s73 offen lds
    v_mfma_f32_32x32x16_bf16 v[80:95], a[200:203], v[140:143], v[80:95]
    ds_read_b64_tr_b16 v[60:61], v23 offset:18432
    ds_read_b64_tr_b16 v[62:63], v23 offset:18944
    s_add_u32 s57, s57, s58
    s_mul_i32 s57, s57, 54
    s_lshl_b32 s58, s54, 1
    s_waitcnt lgkmcnt(8)
    v_mfma_f32_32x32x16_bf16 v[64:79], v[40:43], v[144:147], v[64:79]
    s_add_u32 m0, s56, 0
    ds_read_b64_tr_b16 a[196:197], v22 offset:47104
    ds_read_b64_tr_b16 a[198:199], v22 offset:47616
    buffer_load_dwordx4 v18, s[12:15], s74 offen lds
    v_mfma_f32_32x32x16_bf16 v[80:95], v[44:47], v[144:147], v[80:95]
    ds_read_b64_tr_b16 a[200:201], v23 offset:47104
    ds_read_b64_tr_b16 a[202:203], v23 offset:47616
    s_add_u32 s57, s57, s58
    s_add_u32 s57, s57, 12
    s_and_b32 s58, s50, 1
    s_xor_b32 s58, s58, 0
    v_mfma_f32_16x16x32_bf16 a[204:207], v[40:43], v[4:7], a[204:207]
    s_add_u32 s57, s57, s58
    s_waitcnt lgkmcnt(8)
    v_mfma_f32_32x32x16_bf16 v[64:79], v[48:51], v[148:151], v[64:79]
    s_add_u32 m0, s56, 1024
    s_waitcnt vmcnt(17)
    s_waitcnt vmcnt(11)
    s_barrier
    s_mov_b32 s98, 17833984
    v_mov_b32 v36, s55
    s_mov_b64 exec, s[80:81]
    buffer_store_dword v36, v38, s[8:11], s98 offen sc1
    s_mov_b64 exec, -1
    ds_read_b64_tr_b16 v[40:41], v20 offset:20480
    ds_read_b64_tr_b16 v[42:43], v20 offset:20992
    buffer_load_dwordx4 v18, s[12:15], s75 offen lds
    v_mfma_f32_32x32x16_bf16 v[80:95], v[52:55], v[148:151], v[80:95]
    s_add_u32 m0, s56, 2048
    ds_read_b64_tr_b16 v[44:45], v21 offset:20480
    ds_read_b64_tr_b16 v[46:47], v21 offset:20992
    buffer_load_dwordx4 v18, s[12:15], s76 offen lds
    v_mfma_f32_16x16x32_bf16 a[204:207], v[48:51], v[4:7], a[204:207]
    s_lshl_b32 s57, s57, 12
    s_waitcnt lgkmcnt(8)
    v_mfma_f32_32x32x16_bf16 v[64:79], v[56:59], v[152:155], v[64:79]
    ds_read_b64_tr_b16 v[48:49], v20 offset:49152
    ds_read_b64_tr_b16 v[50:51], v20 offset:49664
    s_add_u32 s94, s57, 7864320
    s_xor_b32 s95, s94, 4096
    v_mfma_f32_32x32x16_bf16 v[80:95], v[60:63], v[152:155], v[80:95]
    s_add_u32 m0, s56, 3072
    ds_read_b64_tr_b16 v[52:53], v21 offset:49152
    ds_read_b64_tr_b16 v[54:55], v21 offset:49664
    buffer_load_dwordx4 v18, s[12:15], s77 offen lds
    s_waitcnt lgkmcnt(8)
    v_mfma_f32_32x32x16_bf16 v[64:79], a[196:199], v[156:159], v[64:79]
    ds_read_b64_tr_b16 v[56:57], v22 offset:20480
    ds_read_b64_tr_b16 v[58:59], v22 offset:20992
    v_mfma_f32_32x32x16_bf16 v[80:95], a[200:203], v[156:159], v[80:95]
    s_add_u32 m0, s56, 12288
    ds_read_b64_tr_b16 v[60:61], v23 offset:20480
    ds_read_b64_tr_b16 v[62:63], v23 offset:20992
    buffer_load_dwordx4 v18, s[12:15], s78 offen lds
    s_waitcnt lgkmcnt(8)
    v_mfma_f32_32x32x16_bf16 v[64:79], v[40:43], v[160:163], v[64:79]
    ds_read_b64_tr_b16 a[196:197], v22 offset:49152
    ds_read_b64_tr_b16 a[198:199], v22 offset:49664
    v_mfma_f32_32x32x16_bf16 v[80:95], v[44:47], v[160:163], v[80:95]
    s_add_u32 m0, s56, 13312
    ds_read_b64_tr_b16 a[200:201], v23 offset:49152
    ds_read_b64_tr_b16 a[202:203], v23 offset:49664
    buffer_load_dwordx4 v18, s[12:15], s79 offen lds
    v_mfma_f32_16x16x32_bf16 a[204:207], v[40:43], v[4:7], a[204:207]
    s_waitcnt lgkmcnt(8)
    v_mfma_f32_32x32x16_bf16 v[64:79], v[48:51], v[164:167], v[64:79]
    ds_read_b64_tr_b16 v[40:41], v20 offset:22528
    ds_read_b64_tr_b16 v[42:43], v20 offset:23040
    v_mfma_f32_32x32x16_bf16 v[80:95], v[52:55], v[164:167], v[80:95]
    s_mul_i32 s45, s50, 6144
    v_lshl_add_u32 v2, v0, 4, s45
    v_add_u32 v8, 4096, v2
    ds_read_b64_tr_b16 v[44:45], v21 offset:22528
    ds_read_b64_tr_b16 v[46:47], v21 offset:23040
    v_mfma_f32_16x16x32_bf16 a[204:207], v[48:51], v[4:7], a[204:207]
    s_waitcnt lgkmcnt(8)
    v_mfma_f32_32x32x16_bf16 v[64:79], v[56:59], v[168:171], v[64:79]
    s_add_u32 m0, s45, 0
    ds_read_b64_tr_b16 v[48:49], v20 offset:51200
    ds_read_b64_tr_b16 v[50:51], v20 offset:51712
    global_load_lds_dwordx4 v2, s[40:41] offset:0
    v_mfma_f32_32x32x16_bf16 v[80:95], v[60:63], v[168:171], v[80:95]
    ds_read_b64_tr_b16 v[52:53], v21 offset:51200
    ds_read_b64_tr_b16 v[54:55], v21 offset:51712
    s_waitcnt lgkmcnt(8)
    v_mfma_f32_32x32x16_bf16 v[64:79], a[196:199], v[172:175], v[64:79]
    ds_read_b64_tr_b16 v[56:57], v22 offset:22528
    ds_read_b64_tr_b16 v[58:59], v22 offset:23040
    global_load_lds_dwordx4 v2, s[40:41] offset:1024
    v_mfma_f32_32x32x16_bf16 v[80:95], a[200:203], v[172:175], v[80:95]
    ds_read_b64_tr_b16 v[60:61], v23 offset:22528
    ds_read_b64_tr_b16 v[62:63], v23 offset:23040
    s_waitcnt lgkmcnt(8)
    v_mfma_f32_32x32x16_bf16 v[64:79], v[40:43], v[176:179], v[64:79]
    ds_read_b64_tr_b16 a[196:197], v22 offset:51200
    ds_read_b64_tr_b16 a[198:199], v22 offset:51712
    v_mfma_f32_32x32x16_bf16 v[80:95], v[44:47], v[176:179], v[80:95]
    v_min_u32 v1, 47, v0
    v_lshlrev_b32 v1, 3, v1
    s_and_b32 s42, s2, 7
    s_lshl_b32 s42, s42, 9
    s_add_u32 s42, s42, 17829888
    ds_read_b64_tr_b16 a[200:201], v23 offset:51200
    ds_read_b64_tr_b16 a[202:203], v23 offset:51712
    s_mov_b64 exec, s[0:1]
    buffer_load_dwordx2 v[10:11], v1, s[8:11], s42 offen sc1
    s_mov_b64 exec, -1
    v_mfma_f32_16x16x32_bf16 a[204:207], v[40:43], v[4:7], a[204:207]
    s_waitcnt lgkmcnt(8)
    v_mfma_f32_32x32x16_bf16 v[64:79], v[48:51], v[180:183], v[64:79]
    s_waitcnt vmcnt(18)
    s_barrier
    ds_read_b64_tr_b16 v[40:41], v20 offset:24576
    ds_read_b64_tr_b16 v[42:43], v20 offset:25088
    global_load_lds_dwordx4 v2, s[40:41] offset:2048
    v_mfma_f32_32x32x16_bf16 v[80:95], v[52:55], v[180:183], v[80:95]
    ds_read_b64_tr_b16 v[44:45], v21 offset:24576
    ds_read_b64_tr_b16 v[46:47], v21 offset:25088
    v_mfma_f32_16x16x32_bf16 a[204:207], v[48:51], v[4:7], a[204:207]
    s_waitcnt lgkmcnt(8)
    v_mfma_f32_32x32x16_bf16 v[64:79], v[56:59], v[184:187], v[64:79]
    ds_read_b64_tr_b16 v[48:49], v20 offset:53248
    ds_read_b64_tr_b16 v[50:51], v20 offset:53760
    global_load_lds_dwordx4 v2, s[40:41] offset:3072
    v_mfma_f32_32x32x16_bf16 v[80:95], v[60:63], v[184:187], v[80:95]
    ds_read_b64_tr_b16 v[52:53], v21 offset:53248
    ds_read_b64_tr_b16 v[54:55], v21 offset:53760
    s_waitcnt lgkmcnt(8)
    v_mfma_f32_32x32x16_bf16 v[64:79], a[196:199], v[188:191], v[64:79]
    s_add_u32 m0, s45, 4096
    ds_read_b64_tr_b16 v[56:57], v22 offset:24576
    ds_read_b64_tr_b16 v[58:59], v22 offset:25088
    global_load_lds_dwordx4 v8, s[40:41] offset:0
    v_mfma_f32_32x32x16_bf16 v[80:95], a[200:203], v[188:191], v[80:95]
    ds_read_b64_tr_b16 v[60:61], v23 offset:24576
    ds_read_b64_tr_b16 v[62:63], v23 offset:25088
    s_waitcnt lgkmcnt(8)
    v_mfma_f32_32x32x16_bf16 v[64:79], v[40:43], v[192:195], v[64:79]
    ds_read_b64_tr_b16 a[196:197], v22 offset:53248
    ds_read_b64_tr_b16 a[198:199], v22 offset:53760
    global_load_lds_dwordx4 v8, s[40:41] offset:1024
    v_mfma_f32_32x32x16_bf16 v[80:95], v[44:47], v[192:195], v[80:95]
    ds_read_b64_tr_b16 a[200:201], v23 offset:53248
    ds_read_b64_tr_b16 a[202:203], v23 offset:53760
    v_mfma_f32_16x16x32_bf16 a[204:207], v[40:43], v[4:7], a[204:207]
    s_waitcnt lgkmcnt(8)
    v_mfma_f32_32x32x16_bf16 v[64:79], v[48:51], v[196:199], v[64:79]
    ds_read_b64_tr_b16 v[40:41], v20 offset:26624
    ds_read_b64_tr_b16 v[42:43], v20 offset:27136
    v_mfma_f32_32x32x16_bf16 v[80:95], v[52:55], v[196:199], v[80:95]
    ds_read_b64_tr_b16 v[44:45], v21 offset:26624
    ds_read_b64_tr_b16 v[46:47], v21 offset:27136
    v_mfma_f32_16x16x32_bf16 a[204:207], v[48:51], v[4:7], a[204:207]
    s_waitcnt lgkmcnt(8)
    v_mfma_f32_32x32x16_bf16 v[64:79], v[56:59], v[200:203], v[64:79]
    ds_read_b64_tr_b16 v[48:49], v20 offset:55296
    ds_read_b64_tr_b16 v[50:51], v20 offset:55808
    v_mfma_f32_32x32x16_bf16 v[80:95], v[60:63], v[200:203], v[80:95]
    ds_read_b64_tr_b16 v[52:53], v21 offset:55296
    ds_read_b64_tr_b16 v[54:55], v21 offset:55808
    s_waitcnt lgkmcnt(8)
    v_mfma_f32_32x32x16_bf16 v[64:79], a[196:199], v[204:207], v[64:79]
    ds_read_b64_tr_b16 v[56:57], v22 offset:26624
    ds_read_b64_tr_b16 v[58:59], v22 offset:27136
    v_mfma_f32_32x32x16_bf16 v[80:95], a[200:203], v[204:207], v[80:95]
    ds_read_b64_tr_b16 v[60:61], v23 offset:26624
    ds_read_b64_tr_b16 v[62:63], v23 offset:27136
    s_waitcnt lgkmcnt(8)
    v_mfma_f32_32x32x16_bf16 v[64:79], v[40:43], v[208:211], v[64:79]
    ds_read_b64_tr_b16 a[196:197], v22 offset:55296
    ds_read_b64_tr_b16 a[198:199], v22 offset:55808
    v_mfma_f32_32x32x16_bf16 v[80:95], v[44:47], v[208:211], v[80:95]
    ds_read_b64_tr_b16 a[200:201], v23 offset:55296
    ds_read_b64_tr_b16 a[202:203], v23 offset:55808
    v_mfma_f32_16x16x32_bf16 a[204:207], v[40:43], v[4:7], a[204:207]
    s_waitcnt lgkmcnt(8)
    v_mfma_f32_32x32x16_bf16 v[64:79], v[48:51], v[212:215], v[64:79]
    s_waitcnt vmcnt(18)
    s_waitcnt vmcnt(4)
    v_cmp_ne_u32 vcc, s55, v10
    v_cmp_ne_u32 s[88:89], s55, v11
    s_nop 0
    s_or_b64 vcc, vcc, s[88:89]
    s_and_b64 vcc, vcc, s[0:1]
    s_cbranch_vccnz L_again_2
L_ok_1:
    s_barrier
    v_lshlrev_b32 v10, 4, v0
    v_add_u32 v11, 4096, v10
    ds_read_b64_tr_b16 v[40:41], v20 offset:4096
    ds_read_b64_tr_b16 v[42:43], v20 offset:4608
    v_mfma_f32_32x32x16_bf16 v[80:95], v[52:55], v[212:215], v[80:95]
    s_add_u32 s99, s36, 0
    ds_read_b64_tr_b16 v[44:45], v21 offset:4096
    ds_read_b64_tr_b16 v[46:47], v21 offset:4608
    buffer_load_dwordx4 a[0:3], v10, s[8:11], s99 offen offset:0 sc1
    v_mfma_f32_16x16x32_bf16 a[204:207], v[48:51], v[4:7], a[204:207]
    s_waitcnt lgkmcnt(8)
    v_mfma_f32_32x32x16_bf16 v[64:79], v[56:59], v[216:219], v[64:79]
    ds_read_b64_tr_b16 v[48:49], v20 offset:32768
    ds_read_b64_tr_b16 v[50:51], v20 offset:33280
    v_mfma_f32_32x32x16_bf16 v[80:95], v[60:63], v[216:219], v[80:95]
    ds_read_b64_tr_b16 v[52:53], v21 offset:32768
    ds_read_b64_tr_b16 v[54:55], v21 offset:33280
    buffer_load_dwordx4 a[4:7], v10, s[8:11], s99 offen offset:1024 sc1
    s_waitcnt lgkmcnt(8)
    v_mfma_f32_32x32x16_bf16 v[64:79], a[196:199], v[220:223], v[64:79]
    ds_read_b64_tr_b16 v[56:57], v22 offset:4096
    ds_read_b64_tr_b16 v[58:59], v22 offset:4608
    v_mfma_f32_32x32x16_bf16 v[80:95], a[200:203], v[220:223], v[80:95]
    ds_read_b64_tr_b16 v[60:61], v23 offset:4096
    ds_read_b64_tr_b16 v[62:63], v23 offset:4608
    buffer_load_dwordx4 a[8:11], v10, s[8:11], s99 offen offset:2048 sc1
    s_waitcnt lgkmcnt(8)
    v_mfma_f32_32x32x16_bf16 v[64:79], v[40:43], v[224:227], v[64:79]
    ds_read_b64_tr_b16 a[196:197], v22 offset:32768
    ds_read_b64_tr_b16 a[198:199], v22 offset:33280
    v_mfma_f32_32x32x16_bf16 v[80:95], v[44:47], v[224:227], v[80:95]
    ds_read_b64_tr_b16 a[200:201], v23 offset:32768
    ds_read_b64_tr_b16 a[202:203], v23 offset:33280
    buffer_load_dwordx4 a[12:15], v10, s[8:11], s99 offen offset:3072 sc1
    v_mfma_f32_16x16x32_bf16 a[204:207], v[40:43], v[4:7], a[204:207]
    s_waitcnt lgkmcnt(8)
    v_mfma_f32_32x32x16_bf16 v[64:79], v[48:51], v[228:231], v[64:79]
    ds_read_b64_tr_b16 v[40:41], v20 offset:6144
    ds_read_b64_tr_b16 v[42:43], v20 offset:6656
    v_mfma_f32_32x32x16_bf16 v[80:95], v[52:55], v[228:231], v[80:95]
    ds_read_b64_tr_b16 v[44:45], v21 offset:6144
    ds_read_b64_tr_b16 v[46:47], v21 offset:6656
    buffer_load_dwordx4 a[16:19], v11, s[8:11], s99 offen offset:0 sc1
    v_mfma_f32_16x16x32_bf16 a[204:207], v[48:51], v[4:7], a[204:207]
    s_waitcnt lgkmcnt(8)
    v_mfma_f32_32x32x16_bf16 v[64:79], v[56:59], v[232:235], v[64:79]
    ds_read_b64_tr_b16 v[48:49], v20 offset:34816
    ds_read_b64_tr_b16 v[50:51], v20 offset:35328
    v_mfma_f32_32x32x16_bf16 v[80:95], v[60:63], v[232:235], v[80:95]
    s_add_u32 s99, s36, 5120
    ds_read_b64_tr_b16 v[52:53], v21 offset:34816
    ds_read_b64_tr_b16 v[54:55], v21 offset:35328
    buffer_load_dwordx4 a[20:23], v10, s[8:11], s99 offen offset:0 sc1
    s_waitcnt lgkmcnt(8)
    v_mfma_f32_32x32x16_bf16 v[64:79], a[196:199], v[236:239], v[64:79]
    ds_read_b64_tr_b16 v[56:57], v22 offset:6144
    ds_read_b64_tr_b16 v[58:59], v22 offset:6656
    v_mfma_f32_32x32x16_bf16 v[80:95], a[200:203], v[236:239], v[80:95]
    ds_read_b64_tr_b16 v[60:61], v23 offset:6144
    ds_read_b64_tr_b16 v[62:63], v23 offset:6656
    buffer_load_dwordx4 a[24:27], v10, s[8:11], s99 offen offset:1024 sc1
    s_waitcnt lgkmcnt(8)
    v_mfma_f32_32x32x16_bf16 v[64:79], v[40:43], v[240:243], v[64:79]
    ds_read_b64_tr_b16 a[196:197], v22 offset:34816
    ds_read_b64_tr_b16 a[198:199], v22 offset:35328
    v_mfma_f32_32x32x16_bf16 v[80:95], v[44:47], v[240:243], v[80:95]
    ds_read_b64_tr_b16 a[200:201], v23 offset:34816
    ds_read_b64_tr_b16 a[202:203], v23 offset:35328
    buffer_load_dwordx4 a[28:31], v10, s[8:11], s99 offen offset:2048 sc1
    v_mfma_f32_16x16x32_bf16 a[204:207], v[40:43], v[4:7], a[204:207]
    s_waitcnt lgkmcnt(8)
    v_mfma_f32_32x32x16_bf16 v[64:79], v[48:51], v[244:247], v[64:79]
    s_barrier
    ds_read_b64_tr_b16 v[40:41], v24 offset:8192
    ds_read_b64_tr_b16 v[42:43], v24 offset:8448
    v_mfma_f32_32x32x16_bf16 v[80:95], v[52:55], v[244:247], v[80:95]
    buffer_load_dwordx4 a[32:35], v10, s[8:11], s99 offen offset:3072 sc1
    v_mfma_f32_16x16x32_bf16 a[204:207], v[48:51], v[4:7], a[204:207]
    s_waitcnt lgkmcnt(6)
    v_mfma_f32_32x32x16_bf16 v[64:79], v[56:59], v[248:251], v[64:79]
    ds_read_b64_tr_b16 v[44:45], v24 offset:36864
    ds_read_b64_tr_b16 v[46:47], v24 offset:37120
    v_mfma_f32_32x32x16_bf16 v[80:95], v[60:63], v[248:251], v[80:95]
    buffer_load_dwordx4 a[36:39], v11, s[8:11], s99 offen offset:0 sc1
    s_waitcnt lgkmcnt(4)
    v_mfma_f32_32x32x16_bf16 v[64:79], a[196:199], v[252:255], v[64:79]
    ds_read_b64_tr_b16 v[48:49], v25 offset:8192
    ds_read_b64_tr_b16 v[50:51], v25 offset:8448
    v_mfma_f32_32x32x16_bf16 v[80:95], a[200:203], v[252:255], v[80:95]
    s_mov_b32 exec_lo, 0x00030003
    s_mov_b32 exec_hi, 0x00030003
    ds_write_b128 v26, a[204:207] offset:0
    s_mov_b64 exec, -1
    s_waitcnt lgkmcnt(5)
    v_mfma_f32_32x32x16_bf16 a[208:223], v[40:43], v[96:99], 0
    ds_read_b64_tr_b16 v[52:53], v25 offset:36864
    ds_read_b64_tr_b16 v[54:55], v25 offset:37120
    ds_read_b64_tr_b16 v[56:57], v24 offset:9216
    ds_read_b64_tr_b16 v[58:59], v24 offset:9472
    s_lshl_b32 s57, s51, 5
    s_lshl_b32 s58, s53, 3
    v_mfma_f32_16x16x32_bf16 a[204:207], v[40:43], v[4:7], 0
    s_add_u32 s57, s57, s58
    s_waitcnt lgkmcnt(7)
    v_mfma_f32_32x32x16_bf16 a[208:223], v[44:47], v[100:103], a[208:223]
    s_add_u32 s99, s36, 10240
    ds_read_b64_tr_b16 v[60:61], v24 offset:37888
    ds_read_b64_tr_b16 v[62:63], v24 offset:38144
    ds_read_b64_tr_b16 v[40:41], v25 offset:9216
    ds_read_b64_tr_b16 v[42:43], v25 offset:9472
    buffer_load_dwordx4 a[40:43], v10, s[8:11], s99 offen offset:0 sc1
    v_mfma_f32_16x16x32_bf16 a[204:207], v[44:47], v[4:7], a[204:207]
    s_add_u32 s57, s57, s52
    s_waitcnt lgkmcnt(9)
    v_mfma_f32_32x32x16_bf16 a[208:223], v[48:51], v[104:107], a[208:223]
    ds_read_b64_tr_b16 v[44:45], v25 offset:37888
    ds_read_b64_tr_b16 v[46:47], v25 offset:38144
    buffer_load_dwordx4 a[44:47], v10, s[8:11], s99 offen offset:1024 sc1
    s_waitcnt lgkmcnt(8)
    v_mfma_f32_32x32x16_bf16 a[208:223], v[52:55], v[108:111], a[208:223]
    s_barrier
    ds_read_b64_tr_b16 v[48:49], v24 offset:10240
    ds_read_b64_tr_b16 v[50:51], v24 offset:10496
    ds_read2_b32 v[30:31], v27 offset0:0 offset1:64
    ds_read2_b32 v[32:33], v28 offset0:0 offset1:64
    s_waitcnt lgkmcnt(10)
    v_mfma_f32_32x32x16_bf16 a[208:223], v[56:59], v[112:115], a[208:223]
    ds_read_b64_tr_b16 v[52:53], v24 offset:38912
    ds_read_b64_tr_b16 v[54:55], v24 offset:39168
    buffer_load_dwordx4 a[48:51], v10, s[8:11], s99 offen offset:2048 sc1
    v_mfma_f32_16x16x32_bf16 a[204:207], v[56:59], v[4:7], a[204:207]
    v_mov_b32 v34, 0
    s_waitcnt lgkmcnt(10)
    v_mfma_f32_32x32x16_bf16 a[208:223], v[60:63], v[116:119], a[208:223]
    ds_read_b64_tr_b16 v[56:57], v25 offset:10240
    ds_read_b64_tr_b16 v[58:59], v25 offset:10496
    v_mov_b32 v35, 0
    s_lshl_b32 s57, s57, 2
    v_mov_b32 v38, s57
    v_lshlrev_b32 v20, 4, v0
    v_mfma_f32_16x16x32_bf16 a[204:207], v[60:63], v[4:7], a[204:207]
    v_add_u32 v21, 4096, v20
    s_waitcnt lgkmcnt(10)
    v_mfma_f32_32x32x16_bf16 a[208:223], v[40:43], v[120:123], a[208:223]
    ds_read_b64_tr_b16 v[60:61], v25 offset:38912
    ds_read_b64_tr_b16 v[62:63], v25 offset:39168
    s_lshl_b32 s57, s50, 10
    v_add_u32 v22, s57, v20
    v_xor_b32 v23, 0x400, v22
    s_waitcnt lgkmcnt(10)
    v_xor_b32 v8, 0x800, v22
    v_and_b32 v1, 15, v0
    v_lshlrev_b32 v1, 2, v1
    s_lshl_b32 s43, s54, 7
    s_add_u32 s43, s43, 17833984
    v_xor_b32 v9, 0xc00, v22
    s_mov_b64 exec, s[0:1]
    buffer_load_dword v2, v1, s[8:11], s43 offen sc1
    s_mov_b64 exec, -1
    s_waitcnt lgkmcnt(6)
    v_add_f32 v30, v30, v31
    v_cvt_pk_bf16_f32 v31, v30, v14
    v_lshlrev_b32 v3, 16, v31
    v_sub_f32 v3, v30, v3
    v_cvt_pk_bf16_f32 v30, v30, v3
    v_add_f32 v32, v32, v33
    v_cvt_pk_bf16_f32 v33, v32, v14
    v_lshlrev_b32 v3, 16, v33
    v_sub_f32 v3, v32, v3
    v_cvt_pk_bf16_f32 v32, v32, v3
    buffer_load_dwordx4 a[52:55], v10, s[8:11], s99 offen offset:3072 sc1
    s_nop 0
    v_mfma_f32_32x32x16_bf16 v[64:79], v[30:33], v[12:15], v[64:79]
    v_mfma_f32_32x32x16_bf16 v[80:95], v[32:35], v[12:15], v[80:95]
    v_mfma_f32_32x32x16_bf16 a[208:223], v[44:47], v[124:127], a[208:223]
    ds_read_b64_tr_b16 v[40:41], v24 offset:11264
    ds_read_b64_tr_b16 v[42:43], v24 offset:11520
    buffer_load_dwordx4 a[56:59], v11, s[8:11], s99 offen offset:0 sc1
    v_mfma_f32_32x32x16_bf16 a[208:223], v[48:51], v[128:131], a[208:223]
    ds_read_b64_tr_b16 v[44:45], v24 offset:39936
    ds_read_b64_tr_b16 v[46:47], v24 offset:40192
    s_nop 3
    v_cvt_pk_bf16_f32 v64, v64, v65
    v_cvt_pk_bf16_f32 v65, v66, v67
    v_cvt_pk_bf16_f32 v66, v68, v69
    v_cvt_pk_bf16_f32 v67, v70, v71
    v_mfma_f32_16x16x32_bf16 a[204:207], v[48:51], v[4:7], a[204:207]
    v_pk_max_i16 v64, v64, 0
    s_waitcnt lgkmcnt(8)
    v_mfma_f32_32x32x16_bf16 a[208:223], v[52:55], v[132:135], a[208:223]
    s_add_u32 s99, s36, 15360
    ds_read_b64_tr_b16 v[48:49], v25 offset:11264
    ds_read_b64_tr_b16 v[50:51], v25 offset:11520
    buffer_load_dwordx4 a[60:63], v10, s[8:11], s99 offen offset:0 sc1
    v_mfma_f32_16x16x32_bf16 a[204:207], v[52:55], v[4:7], a[204:207]
    v_pk_max_i16 v65, v65, 0
    s_waitcnt lgkmcnt(8)
    v_mfma_f32_32x32x16_bf16 a[208:223], v[56:59], v[136:139], a[208:223]
    ds_read_b64_tr_b16 v[52:53], v25 offset:39936
    ds_read_b64_tr_b16 v[54:55], v25 offset:40192
    v_pk_max_i16 v66, v66, 0
    v_pk_max_i16 v67, v67, 0
    v_cvt_pk_bf16_f32 v68, v72, v73
    s_waitcnt lgkmcnt(8)
    v_mfma_f32_32x32x16_bf16 a[208:223], v[60:63], v[140:143], a[208:223]
    s_barrier
    ds_read_b64_tr_b16 v[56:57], v24 offset:0
    ds_read_b64_tr_b16 v[58:59], v24 offset:256
    buffer_store_dwordx4 v[64:67], v19, s[8:11], s94 offen offset:0 sc1
    s_waitcnt lgkmcnt(8)
    v_mfma_f32_32x32x16_bf16 a[208:223], v[40:43], v[144:147], a[208:223]
    ds_read_b64_tr_b16 v[60:61], v24 offset:28672
    ds_read_b64_tr_b16 v[62:63], v24 offset:28928
    buffer_load_dwordx4 a[64:67], v10, s[8:11], s99 offen offset:1024 sc1
    v_mfma_f32_16x16x32_bf16 a[204:207], v[40:43], v[4:7], a[204:207]
    v_cvt_pk_bf16_f32 v69, v74, v75
    s_waitcnt lgkmcnt(8)
    v_mfma_f32_32x32x16_bf16 a[208:223], v[44:47], v[148:151], a[208:223]
    ds_read_b64_tr_b16 v[40:41], v25 offset:0
    ds_read_b64_tr_b16 v[42:43], v25 offset:256
    v_cvt_pk_bf16_f32 v70, v76, v77
    v_cvt_pk_bf16_f32 v71, v78, v79
    v_pk_max_i16 v68, v68, 0
    v_pk_max_i16 v69, v69, 0
    v_mfma_f32_16x16x32_bf16 a[204:207], v[44:47], v[4:7], a[204:207]
    v_pk_max_i16 v70, v70, 0
    s_waitcnt lgkmcnt(8)
    v_mfma_f32_32x32x16_bf16 a[208:223], v[48:51], v[152:155], a[208:223]
    ds_read_b64_tr_b16 v[44:45], v25 offset:28672
    ds_read_b64_tr_b16 v[46:47], v25 offset:28928
    buffer_load_dwordx4 a[68:71], v10, s[8:11], s99 offen offset:2048 sc1
    s_waitcnt lgkmcnt(8)
    v_mfma_f32_32x32x16_bf16 a[208:223], v[52:55], v[156:159], a[208:223]
    ds_read_b64_tr_b16 v[48:49], v24 offset:1024
    ds_read_b64_tr_b16 v[50:51], v24 offset:1280
    v_pk_max_i16 v71, v71, 0
    v_cvt_pk_bf16_f32 v80, v80, v81
    v_cvt_pk_bf16_f32 v81, v82, v83
    s_waitcnt lgkmcnt(8)
    v_mfma_f32_32x32x16_bf16 a[208:223], v[56:59], v[160:163], a[208:223]
    ds_read_b64_tr_b16 v[52:53], v24 offset:29696
    ds_read_b64_tr_b16 v[54:55], v24 offset:29952
    buffer_store_dwordx4 v[68:71], v19, s[8:11], s94 offen offset:512 sc1
    v_mfma_f32_16x16x32_bf16 a[204:207], v[56:59], v[4:7], a[204:207]
    v_cvt_pk_bf16_f32 v82, v84, v85
    s_waitcnt lgkmcnt(8)
    v_mfma_f32_32x32x16_bf16 a[208:223], v[60:63], v[164:167], a[208:223]
    ds_read_b64_tr_b16 v[56:57], v25 offset:1024
    ds_read_b64_tr_b16 v[58:59], v25 offset:1280
    buffer_load_dwordx4 a[72:75], v10, s[8:11], s99 offen offset:3072 sc1
    v_mfma_f32_16x16x32_bf16 a[204:207], v[60:63], v[4:7], a[204:207]
    v_cvt_pk_bf16_f32 v83, v86, v87
    s_waitcnt lgkmcnt(8)
    v_mfma_f32_32x32x16_bf16 a[208:223], v[40:43], v[168:171], a[208:223]
    ds_read_b64_tr_b16 v[60:61], v25 offset:29696
    ds_read_b64_tr_b16 v[62:63], v25 offset:29952
    v_pk_max_i16 v80, v80, 0
    v_pk_max_i16 v81, v81, 0
    v_pk_max_i16 v82, v82, 0
    s_waitcnt lgkmcnt(8)
    v_mfma_f32_32x32x16_bf16 a[208:223], v[44:47], v[172:175], a[208:223]
    s_waitcnt vmcnt(8)
    v_cmp_ne_u32 vcc, s55, v2
    s_nop 0
    s_and_b64 vcc, vcc, s[0:1]
    s_cbranch_vccnz L_again_5
L_ok_4:
    s_barrier
    s_lshl_b32 s46, s54, 4
    s_add_u32 s46, s46, s51
    s_lshl_b32 s90, s46, 2
    s_add_u32 s90, s90, s50
    s_lshl_b32 s90, s90, 12
    s_add_u32 s91, s90, 2621440
    ds_read_b64_tr_b16 v[40:41], v24 offset:2048
    ds_read_b64_tr_b16 v[42:43], v24 offset:2304
    buffer_load_dwordx4 v[96:99], v10, s[8:11], s90 offen offset:0 sc1
    s_waitcnt lgkmcnt(8)
    v_mfma_f32_32x32x16_bf16 a[208:223], v[48:51], v[176:179], a[208:223]
    ds_read_b64_tr_b16 v[44:45], v24 offset:30720
    ds_read_b64_tr_b16 v[46:47], v24 offset:30976
    buffer_load_dwordx4 v[100:103], v10, s[8:11], s90 offen offset:1024 sc1
    v_mfma_f32_16x16x32_bf16 a[204:207], v[48:51], v[4:7], a[204:207]
    v_pk_max_i16 v83, v83, 0
    s_waitcnt lgkmcnt(8)
    v_mfma_f32_32x32x16_bf16 a[208:223], v[52:55], v[180:183], a[208:223]
    ds_read_b64_tr_b16 v[48:49], v25 offset:2048
    ds_read_b64_tr_b16 v[50:51], v25 offset:2304
    v_cvt_pk_bf16_f32 v84, v88, v89
    v_cvt_pk_bf16_f32 v85, v90, v91
    v_cvt_pk_bf16_f32 v86, v92, v93
    v_cvt_pk_bf16_f32 v87, v94, v95
    v_mfma_f32_16x16x32_bf16 a[204:207], v[52:55], v[4:7], a[204:207]
    v_pk_max_i16 v84, v84, 0
    s_waitcnt lgkmcnt(8)
    v_mfma_f32_32x32x16_bf16 a[208:223], v[56:59], v[184:187], a[208:223]
    ds_read_b64_tr_b16 v[52:53], v25 offset:30720
    ds_read_b64_tr_b16 v[54:55], v25 offset:30976
    buffer_store_dwordx4 v[80:83], v19, s[8:11], s95 offen offset:0 sc1
    s_waitcnt lgkmcnt(8)
    v_mfma_f32_32x32x16_bf16 a[208:223], v[60:63], v[188:191], a[208:223]
    ds_read_b64_tr_b16 v[56:57], v24 offset:3072
    ds_read_b64_tr_b16 v[58:59], v24 offset:3328
    buffer_load_dwordx4 v[104:107], v10, s[8:11], s90 offen offset:2048 sc1
    s_waitcnt lgkmcnt(8)
    v_mfma_f32_32x32x16_bf16 a[208:223], v[40:43], v[192:195], a[208:223]
    ds_read_b64_tr_b16 v[60:61], v24 offset:31744
    ds_read_b64_tr_b16 v[62:63], v24 offset:32000
    v_pk_max_i16 v85, v85, 0
    v_pk_max_i16 v86, v86, 0
    v_pk_max_i16 v87, v87, 0
    v_mfma_f32_16x16x32_bf16 a[204:207], v[40:43], v[4:7], a[204:207]
    s_waitcnt lgkmcnt(8)
    v_mfma_f32_32x32x16_bf16 a[208:223], v[44:47], v[196:199], a[208:223]
    ds_read_b64_tr_b16 v[40:41], v25 offset:3072
    ds_read_b64_tr_b16 v[42:43], v25 offset:3328
    buffer_store_dwordx4 v[84:87], v19, s[8:11], s95 offen offset:512 sc1
    v_mfma_f32_16x16x32_bf16 a[204:207], v[44:47], v[4:7], a[204:207]
    s_waitcnt lgkmcnt(8)
    v_mfma_f32_32x32x16_bf16 a[208:223], v[48:51], v[200:203], a[208:223]
    ds_read_b64_tr_b16 v[44:45], v25 offset:31744
    ds_read_b64_tr_b16 v[46:47], v25 offset:32000
    buffer_load_dwordx4 v[108:111], v10, s[8:11], s90 offen offset:3072 sc1
    s_waitcnt lgkmcnt(8)
    v_mfma_f32_32x32x16_bf16 a[208:223], v[52:55], v[204:207], a[208:223]
    s_barrier
    ds_read_b64_tr_b16 v[48:49], v24 offset:12288
    ds_read_b64_tr_b16 v[50:51], v24 offset:12544
    ds_read_b128 v[128:131], v20 offset:0
    ds_read_b128 v[132:135], v20 offset:1024
    s_waitcnt lgkmcnt(10)
    v_mfma_f32_32x32x16_bf16 a[208:223], v[56:59], v[208:211], a[208:223]
    ds_read_b64_tr_b16 v[52:53], v24 offset:40960
    ds_read_b64_tr_b16 v[54:55], v24 offset:41216
    buffer_load_dwordx4 v[112:115], v10, s[8:11], s91 offen offset:0 sc1
    v_mfma_f32_16x16x32_bf16 a[204:207], v[56:59], v[4:7], a[204:207]
    ds_read_b128 v[136:139], v20 offset:2048
    s_waitcnt lgkmcnt(11)
    v_mfma_f32_32x32x16_bf16 a[208:223], v[60:63], v[212:215], a[208:223]
    ds_read_b64_tr_b16 v[56:57], v25 offset:12288
    ds_read_b64_tr_b16 v[58:59], v25 offset:12544
    ds_read_b128 v[140:143], v20 offset:3072
    ds_read_b128 v[144:147], v20 offset:4096
    ds_read_b128 v[148:151], v20 offset:5120
    ds_read_b128 v[152:155], v20 offset:6144
    v_mfma_f32_16x16x32_bf16 a[204:207], v[60:63], v[4:7], a[204:207]
    ds_read_b128 v[156:159], v20 offset:7168
    s_waitcnt lgkmcnt(15)
    v_mfma_f32_32x32x16_bf16 a[208:223], v[40:43], v[216:219], a[208:223]
    ds_read_b64_tr_b16 v[60:61], v25 offset:40960
    ds_read_b64_tr_b16 v[62:63], v25 offset:41216
    buffer_load_dwordx4 v[116:119], v10, s[8:11], s91 offen offset:1024 sc1
    s_waitcnt lgkmcnt(15)
    v_mfma_f32_32x32x16_bf16 a[208:223], v[44:47], v[220:223], a[208:223]
    ds_read_b64_tr_b16 v[40:41], v24 offset:13312
    ds_read_b64_tr_b16 v[42:43], v24 offset:13568
    ds_read_b128 v[160:163], v20 offset:8192
    ds_read_b128 v[164:167], v20 offset:9216
    ds_read_b128 v[168:171], v20 offset:10240
    s_waitcnt lgkmcnt(15)
    v_mfma_f32_32x32x16_bf16 a[208:223], v[48:51], v[224:227], a[208:223]
    ds_read_b64_tr_b16 v[44:45], v24 offset:41984
    ds_read_b64_tr_b16 v[46:47], v24 offset:42240
    buffer_load_dwordx4 v[120:123], v10, s[8:11], s91 offen offset:2048 sc1
    v_mfma_f32_16x16x32_bf16 a[204:207], v[48:51], v[4:7], a[204:207]
    ds_read_b128 v[172:175], v20 offset:11264
    v_mfma_f32_32x32x16_bf16 a[208:223], v[52:55], v[228:231], a[208:223]
    ds_read_b64_tr_b16 v[48:49], v25 offset:13312
    ds_read_b64_tr_b16 v[50:51], v25 offset:13568
    ds_read_b128 v[176:179], v20 offset:12288
    ds_read_b128 v[180:183], v20 offset:13312
    ds_read_b128 v[184:187], v20 offset:14336
    ds_read_b128 v[188:191], v20 offset:15360
    v_mfma_f32_16x16x32_bf16 a[204:207], v[52:55], v[4:7], a[204:207]
    s_waitcnt lgkmcnt(15)
    v_mfma_f32_32x32x16_bf16 a[208:223], v[56:59], v[232:235], a[208:223]
    ds_read_b64_tr_b16 v[52:53], v25 offset:41984
    ds_read_b64_tr_b16 v[54:55], v25 offset:42240
    buffer_load_dwordx4 v[124:127], v10, s[8:11], s91 offen offset:3072 sc1
    s_waitcnt lgkmcnt(15)
    v_mfma_f32_32x32x16_bf16 a[208:223], v[60:63], v[236:239], a[208:223]
    s_waitcnt lgkmcnt(14)
    v_mfma_f32_32x32x16_bf16 a[208:223], v[40:43], v[240:243], a[208:223]
    buffer_load_dwordx4 a[76:79], v11, s[8:11], s99 offen offset:0 sc1
    v_mfma_f32_16x16x32_bf16 a[204:207], v[40:43], v[4:7], a[204:207]
    s_waitcnt lgkmcnt(9)
    v_mfma_f32_32x32x16_bf16 a[208:223], v[44:47], v[244:247], a[208:223]
    v_mfma_f32_16x16x32_bf16 a[204:207], v[44:47], v[4:7], a[204:207]
    s_waitcnt lgkmcnt(6)
    v_mfma_f32_32x32x16_bf16 a[208:223], v[48:51], v[248:251], a[208:223]
    s_add_u32 s99, s36, 20480
    buffer_load_dwordx4 a[80:83], v10, s[8:11], s99 offen offset:0 sc1
    s_waitcnt lgkmcnt(0)
    v_mfma_f32_32x32x16_bf16 a[208:223], v[52:55], v[252:255], a[208:223]
    s_mov_b32 exec_lo, 0x00030003
    s_mov_b32 exec_hi, 0x00030003
    ds_write_b128 v26, a[204:207] offset:512
    s_mov_b64 exec, -1
    s_waitcnt vmcnt(6)
    v_mfma_f32_32x32x16_bf16 v[224:239], v[96:99], v[128:131], 0
    buffer_load_dwordx4 a[84:87], v20, s[8:11], s99 offen offset:1024 sc1
    v_mov_b32 v24, v8
    v_mov_b32 v25, v9
    v_mfma_f32_32x32x16_bf16 v[240:255], v[96:99], v[144:147], 0
    v_and_b32 v27, 0xffffff7f, v27
    s_lshr_b32 s57, s50, 1
    s_lshl_b32 s58, s51, 1
    s_add_u32 s57, s57, s58
    s_mul_i32 s57, s57, 54
    s_lshl_b32 s58, s54, 0
    v_mfma_f32_32x32x16_bf16 v[224:239], v[100:103], v[132:135], v[224:239]
    buffer_load_dwordx4 a[88:91], v20, s[8:11], s99 offen offset:2048 sc1
    s_add_u32 s57, s57, s58
    s_add_u32 s57, s57, 44
    v_mfma_f32_32x32x16_bf16 v[240:255], v[100:103], v[148:151], v[240:255]
    s_lshl_b32 s57, s57, 12
    s_add_u32 s94, s57, 7864320
    ds_read_b128 v[192:195], v20 offset:16384
    ds_read_b128 v[196:199], v20 offset:17408
    ds_read_b128 v[200:203], v20 offset:18432
    ds_read_b128 v[204:207], v20 offset:19456
    v_mfma_f32_32x32x16_bf16 v[224:239], v[104:107], v[136:139], v[224:239]
    buffer_load_dwordx4 a[92:95], v20, s[8:11], s99 offen offset:3072 sc1
    ds_read_b128 v[208:211], v20 offset:20480
    ds_read_b128 v[212:215], v20 offset:21504
    v_mfma_f32_32x32x16_bf16 v[240:255], v[104:107], v[152:155], v[240:255]
    ds_read_b128 v[216:219], v20 offset:22528
    ds_read_b128 v[220:223], v20 offset:23552
    v_mfma_f32_32x32x16_bf16 v[224:239], v[108:111], v[140:143], v[224:239]
    buffer_load_dwordx4 a[96:99], v21, s[8:11], s99 offen offset:0 sc1
    v_mfma_f32_32x32x16_bf16 v[240:255], v[108:111], v[156:159], v[240:255]
    s_waitcnt lgkmcnt(8)
    s_barrier
    s_mov_b32 s98, 17838080
    v_mov_b32 v36, s55
    s_mov_b64 exec, s[80:81]
    buffer_store_dword v36, v38, s[8:11], s98 offen sc1
    s_mov_b64 exec, -1
    ds_read2_b32 v[30:31], v27 offset0:128 offset1:192
    s_add_u32 s99, s61, 0
    buffer_load_dwordx4 a[100:103], v20, s[8:11], s99 offen offset:0 sc1
    v_mov_b32 v32, 0
    v_mov_b32 v33, 0
    v_pk_mul_f32 v[16:17], v[240:241], v[176:177]
    v_pk_mul_f32 v[6:7], v[240:241], v[160:161]
    v_pk_fma_f32 v[240:241], v[224:225], v[176:177], v[6:7] neg_lo:[1,0,0] neg_hi:[1,0,0]
    v_pk_fma_f32 v[224:225], v[224:225], v[160:161], v[16:17]
    v_cvt_pk_bf16_f32 v96, v224, v240
    v_cvt_pk_bf16_f32 v97, v225, v241
    v_pk_mul_f32 v[16:17], v[242:243], v[178:179]
    v_pk_mul_f32 v[6:7], v[242:243], v[162:163]
    buffer_load_dwordx4 a[104:107], v20, s[8:11], s99 offen offset:1024 sc1
    v_pk_fma_f32 v[242:243], v[226:227], v[178:179], v[6:7] neg_lo:[1,0,0] neg_hi:[1,0,0]
    v_pk_fma_f32 v[226:227], v[226:227], v[162:163], v[16:17]
    v_cvt_pk_bf16_f32 v98, v226, v242
    v_cvt_pk_bf16_f32 v99, v227, v243
    v_pk_mul_f32 v[16:17], v[244:245], v[180:181]
    v_pk_mul_f32 v[6:7], v[244:245], v[164:165]
    v_pk_fma_f32 v[244:245], v[228:229], v[180:181], v[6:7] neg_lo:[1,0,0] neg_hi:[1,0,0]
    v_pk_fma_f32 v[228:229], v[228:229], v[164:165], v[16:17]
    v_cvt_pk_bf16_f32 v100, v228, v244
    v_cvt_pk_bf16_f32 v101, v229, v245
    v_pk_mul_f32 v[16:17], v[246:247], v[182:183]
    buffer_load_dwordx4 a[108:111], v20, s[8:11], s99 offen offset:2048 sc1
    v_pk_mul_f32 v[6:7], v[246:247], v[166:167]
    v_pk_fma_f32 v[246:247], v[230:231], v[182:183], v[6:7] neg_lo:[1,0,0] neg_hi:[1,0,0]
    v_pk_fma_f32 v[230:231], v[230:231], v[166:167], v[16:17]
    v_cvt_pk_bf16_f32 v102, v230, v246
    v_cvt_pk_bf16_f32 v103, v231, v247
    v_pk_mul_f32 v[16:17], v[248:249], v[184:185]
    v_pk_mul_f32 v[6:7], v[248:249], v[168:169]
    v_pk_fma_f32 v[248:249], v[232:233], v[184:185], v[6:7] neg_lo:[1,0,0] neg_hi:[1,0,0]
    v_pk_fma_f32 v[232:233], v[232:233], v[168:169], v[16:17]
    v_cvt_pk_bf16_f32 v104, v232, v248
    v_cvt_pk_bf16_f32 v105, v233, v249
    buffer_load_dwordx4 a[112:115], v20, s[8:11], s99 offen offset:3072 sc1
    v_pk_mul_f32 v[16:17], v[250:251], v[186:187]
    v_pk_mul_f32 v[6:7], v[250:251], v[170:171]
    v_pk_fma_f32 v[250:251], v[234:235], v[186:187], v[6:7] neg_lo:[1,0,0] neg_hi:[1,0,0]
    v_pk_fma_f32 v[234:235], v[234:235], v[170:171], v[16:17]
    v_cvt_pk_bf16_f32 v106, v234, v250
    v_cvt_pk_bf16_f32 v107, v235, v251
    v_pk_mul_f32 v[16:17], v[252:253], v[188:189]
    v_pk_mul_f32 v[6:7], v[252:253], v[172:173]
    v_pk_fma_f32 v[252:253], v[236:237], v[188:189], v[6:7] neg_lo:[1,0,0] neg_hi:[1,0,0]
    v_pk_fma_f32 v[236:237], v[236:237], v[172:173], v[16:17]
    v_cvt_pk_bf16_f32 v108, v236, v252
    buffer_load_dwordx4 a[116:119], v21, s[8:11], s99 offen offset:0 sc1
    v_cvt_pk_bf16_f32 v109, v237, v253
    v_pk_mul_f32 v[16:17], v[254:255], v[190:191]
    v_pk_mul_f32 v[6:7], v[254:255], v[174:175]
    v_pk_fma_f32 v[254:255], v[238:239], v[190:191], v[6:7] neg_lo:[1,0,0] neg_hi:[1,0,0]
    v_pk_fma_f32 v[238:239], v[238:239], v[174:175], v[16:17]
    v_cvt_pk_bf16_f32 v110, v238, v254
    v_cvt_pk_bf16_f32 v111, v239, v255
    s_waitcnt vmcnt(12)
    v_mfma_f32_32x32x16_bf16 v[224:239], v[128:131], v[96:99], 0
    s_waitcnt lgkmcnt(0)
    v_add_f32 v30, v30, v31
    v_cvt_pk_bf16_f32 v31, v30, v14
    v_lshlrev_b32 v3, 16, v31
    v_sub_f32 v3, v30, v3
    v_cvt_pk_bf16_f32 v30, v30, v3
    v_mfma_f32_32x32x16_bf16 v[240:255], v[144:147], v[96:99], 0
    s_add_u32 s99, s61, 5120
    buffer_load_dwordx4 a[120:123], v20, s[8:11], s99 offen offset:0 sc1
    v_lshlrev_b32 v64, 16, v112
    v_mfma_f32_32x32x16_bf16 v[224:239], v[132:135], v[100:103], v[224:239]
    v_and_b32 v112, 0xffff0000, v112
    v_lshlrev_b32 v65, 16, v113
    v_and_b32 v113, 0xffff0000, v113
    v_lshlrev_b32 v66, 16, v114
    v_and_b32 v114, 0xffff0000, v114
    v_lshlrev_b32 v67, 16, v115
    v_mfma_f32_32x32x16_bf16 v[240:255], v[148:151], v[100:103], v[240:255]
    buffer_load_dwordx4 a[124:127], v20, s[8:11], s99 offen offset:1024 sc1
    v_and_b32 v115, 0xffff0000, v115
    v_lshlrev_b32 v68, 16, v116
    v_mfma_f32_32x32x16_bf16 v[224:239], v[136:139], v[104:107], v[224:239]
    v_and_b32 v116, 0xffff0000, v116
    v_lshlrev_b32 v69, 16, v117
    v_and_b32 v117, 0xffff0000, v117
    v_lshlrev_b32 v70, 16, v118
    v_and_b32 v118, 0xffff0000, v118
    v_lshlrev_b32 v71, 16, v119
    v_mfma_f32_32x32x16_bf16 v[240:255], v[152:155], v[104:107], v[240:255]
    buffer_load_dwordx4 a[128:131], v20, s[8:11], s99 offen offset:2048 sc1
    v_and_b32 v119, 0xffff0000, v119
    v_lshlrev_b32 v72, 16, v120
    v_mfma_f32_32x32x16_bf16 v[224:239], v[140:143], v[108:111], v[224:239]
    v_and_b32 v120, 0xffff0000, v120
    v_lshlrev_b32 v73, 16, v121
    v_and_b32 v121, 0xffff0000, v121
    v_lshlrev_b32 v74, 16, v122
    v_and_b32 v122, 0xffff0000, v122
    v_lshlrev_b32 v75, 16, v123
    v_mfma_f32_32x32x16_bf16 v[240:255], v[156:159], v[108:111], v[240:255]
    buffer_load_dwordx4 a[132:135], v20, s[8:11], s99 offen offset:3072 sc1
    v_and_b32 v123, 0xffff0000, v123
    v_lshlrev_b32 v76, 16, v124
    v_and_b32 v124, 0xffff0000, v124
    v_lshlrev_b32 v77, 16, v125
    v_and_b32 v125, 0xffff0000, v125
    v_lshlrev_b32 v78, 16, v126
    v_and_b32 v126, 0xffff0000, v126
    v_lshlrev_b32 v79, 16, v127
    v_and_b32 v127, 0xffff0000, v127
    buffer_load_dwordx4 a[136:139], v21, s[8:11], s99 offen offset:0 sc1
    v_bfe_u32 v26, v0, 1, 3
    v_min_u32 v26, 4, v26
    v_and_b32 v27, 1, v0
    v_lshlrev_b32 v27, 3, v27
    v_add_lshl_u32 v26, v26, v27, 2
    v_bfe_u32 v37, v0, 1, 2
    v_min_u32 v37, 2, v37
    v_add3_u32 v37, v37, v27, 5
    v_lshlrev_b32 v37, 2, v37
    s_add_u32 s99, s61, 10240
    s_lshl_b32 s42, s51, 7
    buffer_load_dwordx4 a[140:143], v20, s[8:11], s99 offen offset:0 sc1
    s_add_u32 s43, s42, 17842176
    s_add_u32 s42, s42, 17838080
    v_mfma_f32_32x32x16_bf16 a[208:223], v[30:33], v[12:15], a[208:223]
    v_pk_mul_f32 v[16:17], v[240:241], v[112:113]
    buffer_load_dwordx4 a[144:147], v20, s[8:11], s99 offen offset:1024 sc1
    v_pk_mul_f32 v[6:7], v[240:241], v[64:65]
    v_pk_fma_f32 v[240:241], v[224:225], v[112:113], v[6:7]
    v_pk_fma_f32 v[224:225], v[224:225], v[64:65], v[16:17] neg_lo:[0,0,1] neg_hi:[0,0,1]
    v_cvt_pk_bf16_f32 v96, v240, v224
    v_cvt_pk_bf16_f32 v97, v241, v225
    v_pk_mul_f32 v[16:17], v[242:243], v[114:115]
    v_pk_mul_f32 v[6:7], v[242:243], v[66:67]
    v_pk_fma_f32 v[242:243], v[226:227], v[114:115], v[6:7]
    v_pk_fma_f32 v[226:227], v[226:227], v[66:67], v[16:17] neg_lo:[0,0,1] neg_hi:[0,0,1]
    v_cvt_pk_bf16_f32 v98, v242, v226
    v_cvt_pk_bf16_f32 v99, v243, v227
    buffer_load_dwordx4 a[148:151], v20, s[8:11], s99 offen offset:2048 sc1
    v_pk_mul_f32 v[16:17], v[244:245], v[116:117]
    v_pk_mul_f32 v[6:7], v[244:245], v[68:69]
    v_pk_fma_f32 v[244:245], v[228:229], v[116:117], v[6:7]
    v_pk_fma_f32 v[228:229], v[228:229], v[68:69], v[16:17] neg_lo:[0,0,1] neg_hi:[0,0,1]
    v_cvt_pk_bf16_f32 v100, v244, v228
    v_cvt_pk_bf16_f32 v101, v245, v229
    v_pk_mul_f32 v[16:17], v[246:247], v[118:119]
    v_pk_mul_f32 v[6:7], v[246:247], v[70:71]
    v_pk_fma_f32 v[246:247], v[230:231], v[118:119], v[6:7]
    v_pk_fma_f32 v[230:231], v[230:231], v[70:71], v[16:17] neg_lo:[0,0,1] neg_hi:[0,0,1]
    v_cvt_pk_bf16_f32 v102, v246, v230
    buffer_load_dwordx4 a[152:155], v20, s[8:11], s99 offen offset:3072 sc1
    v_cvt_pk_bf16_f32 v103, v247, v231
    v_pk_mul_f32 v[16:17], v[248:249], v[120:121]
    v_pk_mul_f32 v[6:7], v[248:249], v[72:73]
    v_pk_fma_f32 v[248:249], v[232:233], v[120:121], v[6:7]
    v_pk_fma_f32 v[232:233], v[232:233], v[72:73], v[16:17] neg_lo:[0,0,1] neg_hi:[0,0,1]
    v_cvt_pk_bf16_f32 v104, v248, v232
    v_cvt_pk_bf16_f32 v105, v249, v233
    v_pk_mul_f32 v[16:17], v[250:251], v[122:123]
    v_pk_mul_f32 v[6:7], v[250:251], v[74:75]
    v_pk_fma_f32 v[250:251], v[234:235], v[122:123], v[6:7]
    v_pk_fma_f32 v[234:235], v[234:235], v[74:75], v[16:17] neg_lo:[0,0,1] neg_hi:[0,0,1]
    buffer_load_dwordx4 a[156:159], v21, s[8:11], s99 offen offset:0 sc1
    v_cvt_pk_bf16_f32 v106, v250, v234
    v_cvt_pk_bf16_f32 v107, v251, v235
    v_pk_mul_f32 v[16:17], v[252:253], v[124:125]
    v_pk_mul_f32 v[6:7], v[252:253], v[76:77]
    v_pk_fma_f32 v[252:253], v[236:237], v[124:125], v[6:7]
    v_pk_fma_f32 v[236:237], v[236:237], v[76:77], v[16:17] neg_lo:[0,0,1] neg_hi:[0,0,1]
    v_cvt_pk_bf16_f32 v108, v252, v236
    v_cvt_pk_bf16_f32 v109, v253, v237
    v_pk_mul_f32 v[16:17], v[254:255], v[126:127]
    s_add_u32 s99, s37, 0
    v_pk_mul_f32 v[6:7], v[254:255], v[78:79]
    buffer_load_dwordx4 a[160:163], v20, s[8:11], s99 offen offset:0 sc1
    v_pk_fma_f32 v[254:255], v[238:239], v[126:127], v[6:7]
    v_pk_fma_f32 v[238:239], v[238:239], v[78:79], v[16:17] neg_lo:[0,0,1] neg_hi:[0,0,1]
    v_cvt_pk_bf16_f32 v110, v254, v238
    v_cvt_pk_bf16_f32 v111, v255, v239
    v_mfma_f32_32x32x16_bf16 v[224:239], v[96:99], v[128:131], 0
    v_accvgpr_read_b32 v64, a208
    v_accvgpr_read_b32 v65, a209
    v_accvgpr_read_b32 v66, a210
    v_accvgpr_read_b32 v67, a211
    v_accvgpr_read_b32 v68, a212
    v_accvgpr_read_b32 v69, a213
    v_mfma_f32_32x32x16_bf16 v[240:255], v[96:99], v[144:147], 0
    s_mov_b64 exec, s[0:1]
    buffer_load_dword v27, v26, s[8:11], s42 offen sc1
    s_mov_b64 exec, -1
    v_accvgpr_read_b32 v70, a214
    v_accvgpr_read_b32 v71, a215
    v_mfma_f32_32x32x16_bf16 v[224:239], v[100:103], v[132:135], v[224:239]
    v_cvt_pk_bf16_f32 v64, v64, v65
    v_cvt_pk_bf16_f32 v65, v66, v67
    v_cvt_pk_bf16_f32 v66, v68, v69
    v_cvt_pk_bf16_f32 v67, v70, v71
    v_pk_max_i16 v64, v64, 0
    v_pk_max_i16 v65, v65, 0
    v_mfma_f32_32x32x16_bf16 v[240:255], v[100:103], v[148:151], v[240:255]
    buffer_load_dwordx4 a[164:167], v20, s[8:11], s99 offen offset:1024 sc1
    v_pk_max_i16 v66, v66, 0
    v_pk_max_i16 v67, v67, 0
    v_mfma_f32_32x32x16_bf16 v[224:239], v[104:107], v[136:139], v[224:239]
    v_accvgpr_read_b32 v72, a216
    v_accvgpr_read_b32 v73, a217
    v_accvgpr_read_b32 v74, a218
    v_accvgpr_read_b32 v75, a219
    v_accvgpr_read_b32 v76, a220
    v_accvgpr_read_b32 v77, a221
    v_mfma_f32_32x32x16_bf16 v[240:255], v[104:107], v[152:155], v[240:255]
    buffer_store_dwordx4 v[64:67], v19, s[8:11], s94 offen offset:0 sc1
    v_mfma_f32_32x32x16_bf16 v[224:239], v[108:111], v[140:143], v[224:239]
    buffer_load_dwordx4 a[168:171], v20, s[8:11], s99 offen offset:2048 sc1
    v_accvgpr_read_b32 v78, a222
    v_accvgpr_read_b32 v79, a223
    v_mfma_f32_32x32x16_bf16 v[240:255], v[108:111], v[156:159], v[240:255]
    v_cvt_pk_bf16_f32 v68, v72, v73
    v_cvt_pk_bf16_f32 v69, v74, v75
    v_cvt_pk_bf16_f32 v70, v76, v77
    v_cvt_pk_bf16_f32 v71, v78, v79
    v_pk_max_i16 v68, v68, 0
    v_pk_max_i16 v69, v69, 0
    v_pk_max_i16 v70, v70, 0
    buffer_load_dwordx4 a[172:175], v20, s[8:11], s99 offen offset:3072 sc1
    v_pk_max_i16 v71, v71, 0
    s_nop 2
    v_pk_mul_f32 v[16:17], v[240:241], v[176:177]
    buffer_store_dwordx4 v[68:71], v19, s[8:11], s94 offen offset:512 sc1
    v_pk_mul_f32 v[6:7], v[240:241], v[160:161]
    buffer_load_dwordx4 a[176:179], v21, s[8:11], s99 offen offset:0 sc1
    v_pk_fma_f32 v[240:241], v[224:225], v[176:177], v[6:7] neg_lo:[1,0,0] neg_hi:[1,0,0]
    v_pk_fma_f32 v[224:225], v[224:225], v[160:161], v[16:17]
    v_cvt_pk_bf16_f32 v96, v224, v240
    v_cvt_pk_bf16_f32 v97, v225, v241
    v_pk_mul_f32 v[16:17], v[242:243], v[178:179]
    v_pk_mul_f32 v[6:7], v[242:243], v[162:163]
    v_pk_fma_f32 v[242:243], v[226:227], v[178:179], v[6:7] neg_lo:[1,0,0] neg_hi:[1,0,0]
    v_pk_fma_f32 v[226:227], v[226:227], v[162:163], v[16:17]
    v_cvt_pk_bf16_f32 v98, v226, v242
    s_add_u32 s99, s37, 5120
    v_cvt_pk_bf16_f32 v99, v227, v243
    buffer_load_dwordx4 a[180:183], v20, s[8:11], s99 offen offset:0 sc1
    v_pk_mul_f32 v[16:17], v[244:245], v[180:181]
    v_pk_mul_f32 v[6:7], v[244:245], v[164:165]
    v_pk_fma_f32 v[244:245], v[228:229], v[180:181], v[6:7] neg_lo:[1,0,0] neg_hi:[1,0,0]
    v_pk_fma_f32 v[228:229], v[228:229], v[164:165], v[16:17]
    v_cvt_pk_bf16_f32 v100, v228, v244
    v_cvt_pk_bf16_f32 v101, v229, v245
    v_pk_mul_f32 v[16:17], v[246:247], v[182:183]
    v_pk_mul_f32 v[6:7], v[246:247], v[166:167]
    v_pk_fma_f32 v[246:247], v[230:231], v[182:183], v[6:7] neg_lo:[1,0,0] neg_hi:[1,0,0]
    v_pk_fma_f32 v[230:231], v[230:231], v[166:167], v[16:17]
    v_cvt_pk_bf16_f32 v102, v230, v246
    buffer_load_dwordx4 a[184:187], v20, s[8:11], s99 offen offset:1024 sc1
    v_cvt_pk_bf16_f32 v103, v231, v247
    v_pk_mul_f32 v[16:17], v[248:249], v[184:185]
    v_pk_mul_f32 v[6:7], v[248:249], v[168:169]
    v_pk_fma_f32 v[248:249], v[232:233], v[184:185], v[6:7] neg_lo:[1,0,0] neg_hi:[1,0,0]
    v_pk_fma_f32 v[232:233], v[232:233], v[168:169], v[16:17]
    v_cvt_pk_bf16_f32 v104, v232, v248
    v_cvt_pk_bf16_f32 v105, v233, v249
    v_pk_mul_f32 v[16:17], v[250:251], v[186:187]
    v_pk_mul_f32 v[6:7], v[250:251], v[170:171]
    v_pk_fma_f32 v[250:251], v[234:235], v[186:187], v[6:7] neg_lo:[1,0,0] neg_hi:[1,0,0]
    v_pk_fma_f32 v[234:235], v[234:235], v[170:171], v[16:17]
    buffer_load_dwordx4 a[188:191], v20, s[8:11], s99 offen offset:2048 sc1
    v_cvt_pk_bf16_f32 v106, v234, v250
    v_cvt_pk_bf16_f32 v107, v235, v251
    v_pk_mul_f32 v[16:17], v[252:253], v[188:189]
    v_pk_mul_f32 v[6:7], v[252:253], v[172:173]
    v_pk_fma_f32 v[252:253], v[236:237], v[188:189], v[6:7] neg_lo:[1,0,0] neg_hi:[1,0,0]
    v_pk_fma_f32 v[236:237], v[236:237], v[172:173], v[16:17]
    v_cvt_pk_bf16_f32 v108, v236, v252
    v_cvt_pk_bf16_f32 v109, v237, v253
    v_pk_mul_f32 v[16:17], v[254:255], v[190:191]
    v_pk_mul_f32 v[6:7], v[254:255], v[174:175]
    v_pk_fma_f32 v[254:255], v[238:239], v[190:191], v[6:7] neg_lo:[1,0,0] neg_hi:[1,0,0]
    buffer_load_dwordx4 a[192:195], v20, s[8:11], s99 offen offset:3072 sc1
    v_pk_fma_f32 v[238:239], v[238:239], v[174:175], v[16:17]
    v_cvt_pk_bf16_f32 v110, v238, v254
    v_cvt_pk_bf16_f32 v111, v239, v255
    s_waitcnt vmcnt(10)
    v_cmp_ne_u32 vcc, s55, v27
    s_nop 0
    s_and_b64 vcc, vcc, s[0:1]
    s_cbranch_vccnz L_again_8
L_ok_7:
    s_barrier
    v_mfma_f32_32x32x16_bf16 v[224:239], v[128:131], v[96:99], 0
    s_lshl_b32 s57, s50, 13
    s_add_u32 s57, s57, 81920
    v_add_u32 v1, s57, v20
    s_lshl_b32 s57, s50, 11
    s_add_u32 s57, s57, 81920
    v_add_u32 v2, s57, v20
    v_mfma_f32_32x32x16_bf16 v[240:255], v[144:147], v[96:99], 0
    s_add_u32 s47, s32, 0
    buffer_load_dwordx4 v[40:43], v22, s[8:11], s47 offen sc1
    v_lshrrev_b32 v5, 4, v0
    v_mfma_f32_32x32x16_bf16 v[224:239], v[132:135], v[100:103], v[224:239]
    v_mul_u32_u24 v5, 163840, v5
    v_and_b32 v6, 15, v0
    v_lshl_add_u32 v5, v6, 4, v5
    s_mul_i32 s57, s50, 655360
    s_lshl_b32 s90, s46, 8
    s_add_u32 s90, s90, s57
    v_mfma_f32_32x32x16_bf16 v[240:255], v[148:151], v[100:103], v[240:255]
    buffer_load_dwordx4 v[44:47], v23, s[8:11], s47 offen sc1
    s_add_u32 s90, s90, 5242880
    s_add_u32 s91, s90, 40960
    v_mfma_f32_32x32x16_bf16 v[224:239], v[136:139], v[104:107], v[224:239]
    s_add_u32 s92, s90, 81920
    s_add_u32 s93, s90, 122880
    v_and_b32 v3, 15, v0
    s_lshr_b32 s44, s50, 1
    s_mul_i32 s95, s83, 80
    v_lshl_add_u32 v4, v3, 1, s95
    v_mfma_f32_32x32x16_bf16 v[240:255], v[152:155], v[104:107], v[240:255]
    buffer_load_dwordx4 v[48:51], v24, s[8:11], s47 offen sc1
    v_add_u32 v4, s44, v4
    v_add_u32 v6, 32, v4
    v_mfma_f32_32x32x16_bf16 v[224:239], v[140:143], v[108:111], v[224:239]
    v_add3_u32 v3, v3, 64, s95
    s_movk_i32 s95, 320
    v_cmp_le_u32 vcc, s95, v4
    v_subrev_u32 v7, 640, v4
    s_nop 0
    v_cndmask_b32 v7, v4, v7, vcc
    v_mfma_f32_32x32x16_bf16 v[240:255], v[156:159], v[108:111], v[240:255]
    buffer_load_dwordx4 v[52:55], v25, s[8:11], s47 offen sc1
    v_cvt_f32_i32 v7, v7
    v_mul_f32 v8, 0x3acccccd, v7
    v_cmp_le_u32 vcc, s95, v6
    v_subrev_u32 v7, 640, v6
    s_nop 0
    v_cndmask_b32 v7, v6, v7, vcc
    v_cvt_f32_i32 v7, v7
    s_add_u32 s47, s32, 4096
    v_mul_f32 v9, 0x3acccccd, v7
    buffer_load_dwordx4 v[80:83], v22, s[8:11], s47 offen sc1
    v_cmp_le_u32 vcc, s95, v3
    v_subrev_u32 v7, 640, v3
    s_nop 0
    v_cndmask_b32 v7, v3, v7, vcc
    v_cvt_f32_i32 v7, v7
    v_mul_f32 v10, 0x3acccccd, v7
    v_lshrrev_b32 v4, 4, v0
    v_lshlrev_b32 v4, 2, v4
    s_and_b32 s95, s50, 1
    s_mul_i32 s95, s95, 80
    v_add_u32 v4, s95, v4
    buffer_load_dwordx4 v[84:87], v23, s[8:11], s47 offen sc1
    v_cvt_f32_u32 v4, v4
    v_mul_f32 v11, v4, v8
    v_mul_f32 v12, v4, v9
    v_mul_f32 v13, v4, v10
    v_and_b32 v4, 1, v0
    v_cmp_eq_u32 vcc, s44, v4
    s_nop 1
    v_cndmask_b32 v14, 0, -1, vcc
    s_bitcmp1_b32 s50, 0
    s_cselect_b64 exec, -1, 0
    v_pk_mul_f32 v[16:17], v[240:241], v[208:209]
    v_pk_mul_f32 v[6:7], v[240:241], v[192:193]
    v_pk_fma_f32 v[240:241], v[224:225], v[208:209], v[6:7] neg_lo:[1,0,0] neg_hi:[1,0,0]
    v_pk_fma_f32 v[224:225], v[224:225], v[192:193], v[16:17]
    v_pk_mul_f32 v[16:17], v[242:243], v[210:211]
    v_pk_mul_f32 v[6:7], v[242:243], v[194:195]
    v_pk_fma_f32 v[242:243], v[226:227], v[210:211], v[6:7] neg_lo:[1,0,0] neg_hi:[1,0,0]
    v_pk_fma_f32 v[226:227], v[226:227], v[194:195], v[16:17]
    v_pk_mul_f32 v[16:17], v[244:245], v[212:213]
    v_pk_mul_f32 v[6:7], v[244:245], v[196:197]
    v_pk_fma_f32 v[244:245], v[228:229], v[212:213], v[6:7] neg_lo:[1,0,0] neg_hi:[1,0,0]
    v_pk_fma_f32 v[228:229], v[228:229], v[196:197], v[16:17]
    v_pk_mul_f32 v[16:17], v[246:247], v[214:215]
    v_pk_mul_f32 v[6:7], v[246:247], v[198:199]
    v_pk_fma_f32 v[246:247], v[230:231], v[214:215], v[6:7] neg_lo:[1,0,0] neg_hi:[1,0,0]
    v_pk_fma_f32 v[230:231], v[230:231], v[198:199], v[16:17]
    v_pk_mul_f32 v[16:17], v[248:249], v[216:217]
    v_pk_mul_f32 v[6:7], v[248:249], v[200:201]
    v_pk_fma_f32 v[248:249], v[232:233], v[216:217], v[6:7] neg_lo:[1,0,0] neg_hi:[1,0,0]
    v_pk_fma_f32 v[232:233], v[232:233], v[200:201], v[16:17]
    v_pk_mul_f32 v[16:17], v[250:251], v[218:219]
    v_pk_mul_f32 v[6:7], v[250:251], v[202:203]
    v_pk_fma_f32 v[250:251], v[234:235], v[218:219], v[6:7] neg_lo:[1,0,0] neg_hi:[1,0,0]
    v_pk_fma_f32 v[234:235], v[234:235], v[202:203], v[16:17]
    v_pk_mul_f32 v[16:17], v[252:253], v[220:221]
    v_pk_mul_f32 v[6:7], v[252:253], v[204:205]
    v_pk_fma_f32 v[252:253], v[236:237], v[220:221], v[6:7] neg_lo:[1,0,0] neg_hi:[1,0,0]
    v_pk_fma_f32 v[236:237], v[236:237], v[204:205], v[16:17]
    v_pk_mul_f32 v[16:17], v[254:255], v[222:223]
    v_pk_mul_f32 v[6:7], v[254:255], v[206:207]
    v_pk_fma_f32 v[254:255], v[238:239], v[222:223], v[6:7] neg_lo:[1,0,0] neg_hi:[1,0,0]
    v_pk_fma_f32 v[238:239], v[238:239], v[206:207], v[16:17]
    s_mov_b64 exec, -1
    ds_write_b128 v1, v[240:243] offset:0
    buffer_load_dwordx4 v[88:91], v24, s[8:11], s47 offen sc1
    ds_write_b128 v1, v[224:227] offset:1024
    ds_write_b128 v1, v[244:247] offset:2048
    buffer_load_dwordx4 v[92:95], v25, s[8:11], s47 offen sc1
    ds_write_b128 v1, v[228:231] offset:3072
    ds_write_b128 v1, v[248:251] offset:4096
    s_add_u32 s47, s32, 8192
    ds_write_b128 v1, v[232:235] offset:5120
    buffer_load_dwordx4 a[240:243], v22, s[8:11], s47 offen sc1
    ds_write_b128 v1, v[252:255] offset:6144
    buffer_load_dwordx4 a[244:247], v23, s[8:11], s47 offen sc1
    ds_write_b128 v1, v[236:239] offset:7168
    s_waitcnt lgkmcnt(0)
    s_barrier
    ds_read_b128 v[96:99], v2 offset:0
    s_mov_b64 exec, s[0:1]
    buffer_load_dword v15, v37, s[8:11], s42 offen sc1
    s_mov_b64 exec, -1
    ds_read_b128 v[100:103], v2 offset:1024
    ds_read_b128 v[104:107], v2 offset:8192
    ds_read_b128 v[108:111], v2 offset:9216
    ds_read_b128 v[112:115], v2 offset:16384
    ds_read_b128 v[116:119], v2 offset:17408
    ds_read_b128 v[120:123], v2 offset:24576
    ds_read_b128 v[124:127], v2 offset:25600
    s_waitcnt lgkmcnt(4)
    v_pk_add_f32 v[128:129], v[96:97], v[104:105]
    v_pk_add_f32 v[136:137], v[96:97], v[104:105] neg_lo:[0,1] neg_hi:[0,1]
    v_pk_add_f32 v[130:131], v[98:99], v[106:107]
    v_pk_add_f32 v[138:139], v[98:99], v[106:107] neg_lo:[0,1] neg_hi:[0,1]
    buffer_load_dwordx4 a[248:251], v24, s[8:11], s47 offen sc1
    v_pk_add_f32 v[132:133], v[100:101], v[108:109]
    v_pk_add_f32 v[140:141], v[100:101], v[108:109] neg_lo:[0,1] neg_hi:[0,1]
    v_pk_add_f32 v[134:135], v[102:103], v[110:111]
    v_pk_add_f32 v[142:143], v[102:103], v[110:111] neg_lo:[0,1] neg_hi:[0,1]
    s_waitcnt lgkmcnt(0)
    v_pk_add_f32 v[144:145], v[112:113], v[120:121]
    v_pk_add_f32 v[152:153], v[112:113], v[120:121] neg_lo:[0,1] neg_hi:[0,1]
    v_pk_add_f32 v[146:147], v[114:115], v[122:123]
    v_pk_add_f32 v[154:155], v[114:115], v[122:123] neg_lo:[0,1] neg_hi:[0,1]
    v_pk_add_f32 v[148:149], v[116:117], v[124:125]
    v_pk_add_f32 v[156:157], v[116:117], v[124:125] neg_lo:[0,1] neg_hi:[0,1]
    v_pk_add_f32 v[150:151], v[118:119], v[126:127]
    buffer_load_dwordx4 a[252:255], v25, s[8:11], s47 offen sc1
    v_pk_add_f32 v[158:159], v[118:119], v[126:127] neg_lo:[0,1] neg_hi:[0,1]
    s_cmp_eq_u32 s46, 0
    s_cbranch_scc1 L_zspec_10
    v_pk_add_f32 v[96:97], v[128:129], v[144:145]
    v_pk_add_f32 v[98:99], v[130:131], v[146:147]
    v_pk_add_f32 v[100:101], v[132:133], v[148:149] neg_lo:[0,1] neg_hi:[0,1]
    v_pk_add_f32 v[102:103], v[134:135], v[150:151] neg_lo:[0,1] neg_hi:[0,1]
    v_pk_add_f32 v[104:105], v[136:137], v[152:153]
    v_pk_add_f32 v[106:107], v[138:139], v[154:155]
    v_pk_add_f32 v[108:109], v[140:141], v[156:157] neg_lo:[0,1] neg_hi:[0,1]
    v_pk_add_f32 v[110:111], v[142:143], v[158:159] neg_lo:[0,1] neg_hi:[0,1]
    v_pk_add_f32 v[112:113], v[128:129], v[144:145] neg_lo:[0,1] neg_hi:[0,1]
    v_pk_add_f32 v[114:115], v[130:131], v[146:147] neg_lo:[0,1] neg_hi:[0,1]
    v_pk_add_f32 v[116:117], v[132:133], v[148:149]
    v_pk_add_f32 v[118:119], v[134:135], v[150:151]
    v_pk_add_f32 v[120:121], v[136:137], v[152:153] neg_lo:[0,1] neg_hi:[0,1]
    v_pk_add_f32 v[122:123], v[138:139], v[154:155] neg_lo:[0,1] neg_hi:[0,1]
    v_pk_add_f32 v[124:125], v[140:141], v[156:157]
    v_pk_add_f32 v[126:127], v[142:143], v[158:159]
    v_cvt_pk_bf16_f32 v160, v96, v104
    v_cvt_pk_bf16_f32 v161, v97, v105
    v_cvt_pk_bf16_f32 v162, v100, v108
    v_cvt_pk_bf16_f32 v163, v101, v109
    v_cvt_pk_bf16_f32 v164, v112, v120
    v_cvt_pk_bf16_f32 v165, v113, v121
    v_cvt_pk_bf16_f32 v166, v116, v124
    v_cvt_pk_bf16_f32 v167, v117, v125
    v_cvt_pk_bf16_f32 v168, v98, v106
    v_cvt_pk_bf16_f32 v169, v99, v107
    v_cvt_pk_bf16_f32 v170, v102, v110
    v_cvt_pk_bf16_f32 v171, v103, v111
    v_cvt_pk_bf16_f32 v172, v114, v122
    v_cvt_pk_bf16_f32 v173, v115, v123
    v_cvt_pk_bf16_f32 v174, v118, v126
    v_cvt_pk_bf16_f32 v175, v119, v127
L_zdone_11:
    buffer_store_dwordx4 v[160:163], v5, s[8:11], s90 offen sc1
    buffer_store_dwordx4 v[164:167], v5, s[8:11], s91 offen sc1
    buffer_store_dwordx4 v[168:171], v5, s[8:11], s92 offen sc1
    buffer_store_dwordx4 v[172:175], v5, s[8:11], s93 offen sc1
    s_waitcnt vmcnt(13)
    v_mfma_f32_16x16x32_bf16 v[96:99], v[40:43], a[0:3], 0
    v_mul_f32 v2, 0x41800000, v8
    v_mfma_f32_16x16x32_bf16 v[100:103], v[40:43], a[4:7], 0
    v_cos_f32 v2, v2
    v_mfma_f32_16x16x32_bf16 v[104:107], v[40:43], a[8:11], 0
    v_fmamk_f32 v64, v8, 0x00000000, v11
    v_mfma_f32_16x16x32_bf16 v[108:111], v[40:43], a[12:15], 0
    v_sin_f32 v68, v64
    v_mfma_f32_16x16x32_bf16 v[112:115], v[40:43], a[16:19], 0
    s_add_u32 s47, s32, 12288
    buffer_load_dwordx4 v[56:59], v22, s[8:11], s47 offen sc1
    v_mfma_f32_16x16x32_bf16 v[116:119], v[44:47], a[0:3], 0
    v_cos_f32 v64, v64
    v_mfma_f32_16x16x32_bf16 v[120:123], v[44:47], a[4:7], 0
    v_fmamk_f32 v65, v8, 0x3f800000, v11
    v_mfma_f32_16x16x32_bf16 v[124:127], v[44:47], a[8:11], 0
    buffer_load_dwordx4 v[60:63], v23, s[8:11], s47 offen sc1
    v_mfma_f32_16x16x32_bf16 v[128:131], v[44:47], a[12:15], 0
    v_sin_f32 v69, v65
    v_mfma_f32_16x16x32_bf16 v[132:135], v[44:47], a[16:19], 0
    v_cos_f32 v65, v65
    v_mfma_f32_16x16x32_bf16 v[136:139], v[48:51], a[0:3], 0
    v_fmamk_f32 v66, v8, 0x40000000, v11
    v_mfma_f32_16x16x32_bf16 v[140:143], v[48:51], a[4:7], 0
    buffer_load_dwordx4 v[28:31], v24, s[8:11], s47 offen sc1
    v_mfma_f32_16x16x32_bf16 v[144:147], v[48:51], a[8:11], 0
    v_sin_f32 v70, v66
    v_mfma_f32_16x16x32_bf16 v[148:151], v[48:51], a[12:15], 0
    v_cos_f32 v66, v66
    v_mfma_f32_16x16x32_bf16 v[152:155], v[48:51], a[16:19], 0
    v_fmamk_f32 v67, v8, 0x40400000, v11
    v_mfma_f32_16x16x32_bf16 v[156:159], v[52:55], a[0:3], 0
    buffer_load_dwordx4 v[32:35], v25, s[8:11], s47 offen sc1
    v_mfma_f32_16x16x32_bf16 v[160:163], v[52:55], a[4:7], 0
    v_sin_f32 v71, v67
    v_mfma_f32_16x16x32_bf16 v[164:167], v[52:55], a[8:11], 0
    v_cos_f32 v67, v67
    v_mfma_f32_16x16x32_bf16 v[168:171], v[52:55], a[12:15], 0
    v_add_f32 v2, v2, v2
    v_cvt_pk_bf16_f32 v176, v64, -v68
    v_mfma_f32_16x16x32_bf16 v[172:175], v[52:55], a[16:19], 0
    s_add_u32 s47, s32, 16384
    buffer_load_dwordx4 v[224:227], v22, s[8:11], s47 offen sc1
    s_waitcnt vmcnt(11)
    v_cmp_ne_u32 vcc, s55, v15
    s_nop 0
    s_and_b64 vcc, vcc, s[0:1]
    s_cbranch_vccnz L_again_13
L_ok_12:
    s_barrier
    s_mov_b32 s98, 17842176
    v_mov_b32 v36, s55
    s_mov_b64 exec, s[80:81]
    buffer_store_dword v36, v38, s[8:11], s98 offen sc1
    s_mov_b64 exec, -1
    v_mfma_f32_16x16x32_bf16 v[96:99], v[80:83], a[20:23], v[96:99]
    v_cvt_pk_bf16_f32 v177, v65, -v69
    v_cvt_pk_bf16_f32 v178, v66, -v70
    v_mfma_f32_16x16x32_bf16 v[100:103], v[80:83], a[24:27], v[100:103]
    v_cvt_pk_bf16_f32 v179, v67, -v71
    v_fmamk_f32 v72, v8, 0x41800000, v11
    v_mfma_f32_16x16x32_bf16 v[104:107], v[80:83], a[28:31], v[104:107]
    buffer_load_dwordx4 v[228:231], v23, s[8:11], s47 offen sc1
    v_mfma_f32_16x16x32_bf16 v[108:111], v[80:83], a[32:35], v[108:111]
    v_sin_f32 v76, v72
    v_mfma_f32_16x16x32_bf16 v[112:115], v[80:83], a[36:39], v[112:115]
    v_cos_f32 v72, v72
    v_mfma_f32_16x16x32_bf16 v[116:119], v[84:87], a[20:23], v[116:119]
    v_fmamk_f32 v73, v8, 0x41880000, v11
    v_mfma_f32_16x16x32_bf16 v[120:123], v[84:87], a[24:27], v[120:123]
    buffer_load_dwordx4 v[232:235], v24, s[8:11], s47 offen sc1
    v_mfma_f32_16x16x32_bf16 v[124:127], v[84:87], a[28:31], v[124:127]
    v_sin_f32 v77, v73
    v_mfma_f32_16x16x32_bf16 v[128:131], v[84:87], a[32:35], v[128:131]
    v_cos_f32 v73, v73
    v_mfma_f32_16x16x32_bf16 v[132:135], v[84:87], a[36:39], v[132:135]
    v_fmamk_f32 v74, v8, 0x41900000, v11
    v_mfma_f32_16x16x32_bf16 v[136:139], v[88:91], a[20:23], v[136:139]
    buffer_load_dwordx4 v[236:239], v25, s[8:11], s47 offen sc1
    v_mfma_f32_16x16x32_bf16 v[140:143], v[88:91], a[24:27], v[140:143]
    v_sin_f32 v78, v74
    v_mfma_f32_16x16x32_bf16 v[144:147], v[88:91], a[28:31], v[144:147]
    v_cos_f32 v74, v74
    v_mfma_f32_16x16x32_bf16 v[148:151], v[88:91], a[32:35], v[148:151]
    v_fmamk_f32 v75, v8, 0x41980000, v11
    v_mfma_f32_16x16x32_bf16 v[152:155], v[88:91], a[36:39], v[152:155]
    s_add_u32 s47, s60, 0
    buffer_load_dwordx4 v[240:243], v22, s[8:11], s47 offen sc1
    v_mfma_f32_16x16x32_bf16 v[156:159], v[92:95], a[20:23], v[156:159]
    v_sin_f32 v79, v75
    v_mfma_f32_16x16x32_bf16 v[160:163], v[92:95], a[24:27], v[160:163]
    v_cos_f32 v75, v75
    v_mfma_f32_16x16x32_bf16 v[164:167], v[92:95], a[28:31], v[164:167]
    buffer_load_dwordx4 v[244:247], v23, s[8:11], s47 offen sc1
    v_mfma_f32_16x16x32_bf16 v[168:171], v[92:95], a[32:35], v[168:171]
    v_cvt_pk_bf16_f32 v180, v72, -v76
    v_cvt_pk_bf16_f32 v181, v73, -v77
    v_mfma_f32_16x16x32_bf16 v[172:175], v[92:95], a[36:39], v[172:175]
    v_cvt_pk_bf16_f32 v182, v74, -v78
    v_cvt_pk_bf16_f32 v183, v75, -v79
    s_waitcnt vmcnt(15)
    v_mfma_f32_16x16x32_bf16 v[96:99], a[240:243], a[40:43], v[96:99]
    v_fma_f32 v64, v2, v72, -v64
    v_fma_f32 v68, v2, v76, -v68
    v_mfma_f32_16x16x32_bf16 v[100:103], a[240:243], a[44:47], v[100:103]
    buffer_load_dwordx4 v[248:251], v24, s[8:11], s47 offen sc1
    v_mfma_f32_16x16x32_bf16 v[104:107], a[240:243], a[48:51], v[104:107]
    v_fma_f32 v65, v2, v73, -v65
    v_fma_f32 v69, v2, v77, -v69
    v_mfma_f32_16x16x32_bf16 v[108:111], a[240:243], a[52:55], v[108:111]
    v_fma_f32 v66, v2, v74, -v66
    v_fma_f32 v70, v2, v78, -v70
    v_mfma_f32_16x16x32_bf16 v[112:115], a[240:243], a[56:59], v[112:115]
    v_fma_f32 v67, v2, v75, -v67
    v_fma_f32 v71, v2, v79, -v71
    v_mfma_f32_16x16x32_bf16 v[116:119], a[244:247], a[40:43], v[116:119]
    buffer_load_dwordx4 v[252:255], v25, s[8:11], s47 offen sc1
    v_mfma_f32_16x16x32_bf16 v[120:123], a[244:247], a[44:47], v[120:123]
    v_cvt_pk_bf16_f32 v184, v64, -v68
    v_cvt_pk_bf16_f32 v185, v65, -v69
    v_mfma_f32_16x16x32_bf16 v[124:127], a[244:247], a[48:51], v[124:127]
    v_cvt_pk_bf16_f32 v186, v66, -v70
    v_cvt_pk_bf16_f32 v187, v67, -v71
    v_mfma_f32_16x16x32_bf16 v[128:131], a[244:247], a[52:55], v[128:131]
    v_fma_f32 v72, v2, v64, -v72
    v_fma_f32 v76, v2, v68, -v76
    v_mfma_f32_16x16x32_bf16 v[132:135], a[244:247], a[56:59], v[132:135]
    s_add_u32 s47, s60, 4096
    buffer_load_dwordx4 v[40:43], v22, s[8:11], s47 offen sc1
    v_mfma_f32_16x16x32_bf16 v[136:139], a[248:251], a[40:43], v[136:139]
    v_fma_f32 v73, v2, v65, -v73
    v_fma_f32 v77, v2, v69, -v77
    v_mfma_f32_16x16x32_bf16 v[140:143], a[248:251], a[44:47], v[140:143]
    v_fma_f32 v74, v2, v66, -v74
    v_fma_f32 v78, v2, v70, -v78
    v_mfma_f32_16x16x32_bf16 v[144:147], a[248:251], a[48:51], v[144:147]
    buffer_load_dwordx4 v[44:47], v23, s[8:11], s47 offen sc1
    v_mfma_f32_16x16x32_bf16 v[148:151], a[248:251], a[52:55], v[148:151]
    v_fma_f32 v75, v2, v67, -v75
    v_fma_f32 v79, v2, v71, -v79
    v_mfma_f32_16x16x32_bf16 v[152:155], a[248:251], a[56:59], v[152:155]
    v_cvt_pk_bf16_f32 v188, v72, -v76
    v_cvt_pk_bf16_f32 v189, v73, -v77
    v_mfma_f32_16x16x32_bf16 v[156:159], a[252:255], a[40:43], v[156:159]
    v_cvt_pk_bf16_f32 v190, v74, -v78
    v_cvt_pk_bf16_f32 v191, v75, -v79
    v_mfma_f32_16x16x32_bf16 v[160:163], a[252:255], a[44:47], v[160:163]
    buffer_load_dwordx4 v[48:51], v24, s[8:11], s47 offen sc1
    v_mfma_f32_16x16x32_bf16 v[164:167], a[252:255], a[48:51], v[164:167]
    v_fma_f32 v64, v2, v72, -v64
    v_fma_f32 v68, v2, v76, -v68
    v_mfma_f32_16x16x32_bf16 v[168:171], a[252:255], a[52:55], v[168:171]
    v_fma_f32 v65, v2, v73, -v65
    v_fma_f32 v69, v2, v77, -v69
    v_mfma_f32_16x16x32_bf16 v[172:175], a[252:255], a[56:59], v[172:175]
    v_fma_f32 v66, v2, v74, -v66
    v_fma_f32 v70, v2, v78, -v70
    s_waitcnt vmcnt(12)
    v_mfma_f32_16x16x32_bf16 v[96:99], v[56:59], a[60:63], v[96:99]
    s_mov_b64 exec, s[0:1]
    buffer_load_dword v27, v26, s[8:11], s43 offen sc1
    s_mov_b64 exec, -1
    v_mfma_f32_16x16x32_bf16 v[100:103], v[56:59], a[64:67], v[100:103]
    v_fma_f32 v67, v2, v75, -v67
    v_fma_f32 v71, v2, v79, -v71
    v_mfma_f32_16x16x32_bf16 v[104:107], v[56:59], a[68:71], v[104:107]
    v_cvt_pk_bf16_f32 v192, v64, -v68
    v_cvt_pk_bf16_f32 v193, v65, -v69
    v_mfma_f32_16x16x32_bf16 v[108:111], v[56:59], a[72:75], v[108:111]
    v_cvt_pk_bf16_f32 v194, v66, -v70
    v_cvt_pk_bf16_f32 v195, v67, -v71
    v_mfma_f32_16x16x32_bf16 v[112:115], v[56:59], a[76:79], v[112:115]
    buffer_load_dwordx4 v[52:55], v25, s[8:11], s47 offen sc1
    v_mfma_f32_16x16x32_bf16 v[116:119], v[60:63], a[60:63], v[116:119]
    v_mul_f32 v2, 0x41800000, v9
    v_mfma_f32_16x16x32_bf16 v[120:123], v[60:63], a[64:67], v[120:123]
    v_cos_f32 v2, v2
    v_mfma_f32_16x16x32_bf16 v[124:127], v[60:63], a[68:71], v[124:127]
    v_fmamk_f32 v64, v9, 0x00000000, v12
    v_mfma_f32_16x16x32_bf16 v[128:131], v[60:63], a[72:75], v[128:131]
    s_add_u32 s47, s60, 8192
    buffer_load_dwordx4 v[80:83], v22, s[8:11], s47 offen sc1
    v_mfma_f32_16x16x32_bf16 v[132:135], v[60:63], a[76:79], v[132:135]
    v_sin_f32 v68, v64
    v_mfma_f32_16x16x32_bf16 v[136:139], v[28:31], a[60:63], v[136:139]
    v_cos_f32 v64, v64
    v_mfma_f32_16x16x32_bf16 v[140:143], v[28:31], a[64:67], v[140:143]
    buffer_load_dwordx4 v[84:87], v23, s[8:11], s47 offen sc1
    v_mfma_f32_16x16x32_bf16 v[144:147], v[28:31], a[68:71], v[144:147]
    v_fmamk_f32 v65, v9, 0x3f800000, v12
    v_mfma_f32_16x16x32_bf16 v[148:151], v[28:31], a[72:75], v[148:151]
    v_sin_f32 v69, v65
    v_mfma_f32_16x16x32_bf16 v[152:155], v[28:31], a[76:79], v[152:155]
    v_cos_f32 v65, v65
    v_mfma_f32_16x16x32_bf16 v[156:159], v[32:35], a[60:63], v[156:159]
    buffer_load_dwordx4 v[88:91], v24, s[8:11], s47 offen sc1
    v_mfma_f32_16x16x32_bf16 v[160:163], v[32:35], a[64:67], v[160:163]
    v_fmamk_f32 v66, v9, 0x40000000, v12
    v_mfma_f32_16x16x32_bf16 v[164:167], v[32:35], a[68:71], v[164:167]
    v_sin_f32 v70, v66
    v_mfma_f32_16x16x32_bf16 v[168:171], v[32:35], a[72:75], v[168:171]
    v_cos_f32 v66, v66
    v_mfma_f32_16x16x32_bf16 v[172:175], v[32:35], a[76:79], v[172:175]
    buffer_load_dwordx4 v[92:95], v25, s[8:11], s47 offen sc1
    s_waitcnt vmcnt(13)
    v_mfma_f32_16x16x32_bf16 v[96:99], v[224:227], a[80:83], v[96:99]
    v_fmamk_f32 v67, v9, 0x40400000, v12
    v_mfma_f32_16x16x32_bf16 v[100:103], v[224:227], a[84:87], v[100:103]
    v_sin_f32 v71, v67
    v_mfma_f32_16x16x32_bf16 v[104:107], v[224:227], a[88:91], v[104:107]
    v_cos_f32 v67, v67
    v_mfma_f32_16x16x32_bf16 v[108:111], v[224:227], a[92:95], v[108:111]
    buffer_load_dwordx4 a[196:199], v21, s[8:11], s99 offen offset:0 sc1
    v_mfma_f32_16x16x32_bf16 v[112:115], v[224:227], a[96:99], v[112:115]
    v_add_f32 v2, v2, v2
    v_cvt_pk_bf16_f32 v196, v64, -v68
    v_mfma_f32_16x16x32_bf16 v[116:119], v[228:231], a[80:83], v[116:119]
    v_cvt_pk_bf16_f32 v197, v65, -v69
    v_cvt_pk_bf16_f32 v198, v66, -v70
    v_mfma_f32_16x16x32_bf16 v[120:123], v[228:231], a[84:87], v[120:123]
    v_cvt_pk_bf16_f32 v199, v67, -v71
    v_fmamk_f32 v72, v9, 0x41800000, v12
    v_mfma_f32_16x16x32_bf16 v[124:127], v[228:231], a[88:91], v[124:127]
    s_mov_b32 s99, s38
    buffer_load_dwordx4 a[200:203], v20, s[8:11], s99 offen offset:0 sc1
    v_mfma_f32_16x16x32_bf16 v[128:131], v[228:231], a[92:95], v[128:131]
    v_sin_f32 v76, v72
    v_mfma_f32_16x16x32_bf16 v[132:135], v[228:231], a[96:99], v[132:135]
    v_cos_f32 v72, v72
    v_mfma_f32_16x16x32_bf16 v[136:139], v[232:235], a[80:83], v[136:139]
    buffer_load_dwordx4 a[204:207], v20, s[8:11], s99 offen offset:1024 sc1
    v_mfma_f32_16x16x32_bf16 v[140:143], v[232:235], a[84:87], v[140:143]
    v_fmamk_f32 v73, v9, 0x41880000, v12
    v_mfma_f32_16x16x32_bf16 v[144:147], v[232:235], a[88:91], v[144:147]
    v_sin_f32 v77, v73
    v_mfma_f32_16x16x32_bf16 v[148:151], v[232:235], a[92:95], v[148:151]
    v_cos_f32 v73, v73
    v_mfma_f32_16x16x32_bf16 v[152:155], v[232:235], a[96:99], v[152:155]
    buffer_load_dwordx4 a[208:211], v20, s[8:11], s99 offen offset:2048 sc1
    v_mfma_f32_16x16x32_bf16 v[156:159], v[236:239], a[80:83], v[156:159]
    v_fmamk_f32 v74, v9, 0x41900000, v12
    v_mfma_f32_16x16x32_bf16 v[160:163], v[236:239], a[84:87], v[160:163]
    v_sin_f32 v78, v74
    v_mfma_f32_16x16x32_bf16 v[164:167], v[236:239], a[88:91], v[164:167]
    v_cos_f32 v74, v74
    v_mfma_f32_16x16x32_bf16 v[168:171], v[236:239], a[92:95], v[168:171]
    buffer_load_dwordx4 a[212:215], v20, s[8:11], s99 offen offset:3072 sc1
    v_mfma_f32_16x16x32_bf16 v[172:175], v[236:239], a[96:99], v[172:175]
    v_fmamk_f32 v75, v9, 0x41980000, v12
    s_waitcnt vmcnt(10)
    v_cmp_ne_u32 vcc, s55, v27
    s_nop 0
    s_and_b64 vcc, vcc, s[0:1]
    s_cbranch_vccnz L_again_16
L_ok_15:
    s_barrier
    v_lshlrev_b32 v16, 10, v0
    s_lshl_b32 s98, s46, 2
    s_add_u32 s98, s98, 17846272
    s_mul_i32 s88, s80, 0xff
    s_mov_b32 s89, 0
    v_mov_b32 v17, s55
    s_mov_b64 exec, s[88:89]
    buffer_store_dword v17, v16, s[8:11], s98 offen sc1
    s_mov_b64 exec, -1
    v_mfma_f32_16x16x32_bf16 v[96:99], v[240:243], a[100:103], v[96:99]
    v_sin_f32 v79, v75
    v_mfma_f32_16x16x32_bf16 v[100:103], v[240:243], a[104:107], v[100:103]
    v_cos_f32 v75, v75
    v_mfma_f32_16x16x32_bf16 v[104:107], v[240:243], a[108:111], v[104:107]
    s_add_u32 s47, s33, 0
    buffer_load_dwordx4 a[240:243], v22, s[8:11], s47 offen sc1
    v_mfma_f32_16x16x32_bf16 v[108:111], v[240:243], a[112:115], v[108:111]
    v_cvt_pk_bf16_f32 v200, v72, -v76
    v_cvt_pk_bf16_f32 v201, v73, -v77
    v_mfma_f32_16x16x32_bf16 v[112:115], v[240:243], a[116:119], v[112:115]
    v_cvt_pk_bf16_f32 v202, v74, -v78
    v_cvt_pk_bf16_f32 v203, v75, -v79
    v_mfma_f32_16x16x32_bf16 v[116:119], v[244:247], a[100:103], v[116:119]
    buffer_load_dwordx4 a[244:247], v23, s[8:11], s47 offen sc1
    v_mfma_f32_16x16x32_bf16 v[120:123], v[244:247], a[104:107], v[120:123]
    v_fma_f32 v64, v2, v72, -v64
    v_fma_f32 v68, v2, v76, -v68
    v_mfma_f32_16x16x32_bf16 v[124:127], v[244:247], a[108:111], v[124:127]
    v_fma_f32 v65, v2, v73, -v65
    v_fma_f32 v69, v2, v77, -v69
    v_mfma_f32_16x16x32_bf16 v[128:131], v[244:247], a[112:115], v[128:131]
    v_fma_f32 v66, v2, v74, -v66
    v_fma_f32 v70, v2, v78, -v70
    v_mfma_f32_16x16x32_bf16 v[132:135], v[244:247], a[116:119], v[132:135]
    buffer_load_dwordx4 a[248:251], v24, s[8:11], s47 offen sc1
    v_mfma_f32_16x16x32_bf16 v[136:139], v[248:251], a[100:103], v[136:139]
    v_fma_f32 v67, v2, v75, -v67
    v_fma_f32 v71, v2, v79, -v71
    v_mfma_f32_16x16x32_bf16 v[140:143], v[248:251], a[104:107], v[140:143]
    v_cvt_pk_bf16_f32 v204, v64, -v68
    v_cvt_pk_bf16_f32 v205, v65, -v69
    v_mfma_f32_16x16x32_bf16 v[144:147], v[248:251], a[108:111], v[144:147]
    v_cvt_pk_bf16_f32 v206, v66, -v70
    v_cvt_pk_bf16_f32 v207, v67, -v71
    v_mfma_f32_16x16x32_bf16 v[148:151], v[248:251], a[112:115], v[148:151]
    buffer_load_dwordx4 a[252:255], v25, s[8:11], s47 offen sc1
    v_mfma_f32_16x16x32_bf16 v[152:155], v[248:251], a[116:119], v[152:155]
    v_fma_f32 v72, v2, v64, -v72
    v_fma_f32 v76, v2, v68, -v76
    v_mfma_f32_16x16x32_bf16 v[156:159], v[252:255], a[100:103], v[156:159]
    v_fma_f32 v73, v2, v65, -v73
    v_fma_f32 v77, v2, v69, -v77
    v_mfma_f32_16x16x32_bf16 v[160:163], v[252:255], a[104:107], v[160:163]
    v_fma_f32 v74, v2, v66, -v74
    v_fma_f32 v78, v2, v70, -v78
    v_mfma_f32_16x16x32_bf16 v[164:167], v[252:255], a[108:111], v[164:167]
    s_add_u32 s47, s33, 4096
    buffer_load_dwordx4 v[56:59], v22, s[8:11], s47 offen sc1
    v_mfma_f32_16x16x32_bf16 v[168:171], v[252:255], a[112:115], v[168:171]
    v_fma_f32 v75, v2, v67, -v75
    v_fma_f32 v79, v2, v71, -v79
    v_mfma_f32_16x16x32_bf16 v[172:175], v[252:255], a[116:119], v[172:175]
    v_cvt_pk_bf16_f32 v208, v72, -v76
    v_cvt_pk_bf16_f32 v209, v73, -v77
    s_waitcnt vmcnt(15)
    v_mfma_f32_16x16x32_bf16 v[96:99], v[40:43], a[120:123], v[96:99]
    s_mov_b64 exec, s[0:1]
    buffer_load_dword v15, v37, s[8:11], s43 offen sc1
    s_mov_b64 exec, -1
    v_mfma_f32_16x16x32_bf16 v[100:103], v[40:43], a[124:127], v[100:103]
    v_cvt_pk_bf16_f32 v210, v74, -v78
    v_cvt_pk_bf16_f32 v211, v75, -v79
    v_mfma_f32_16x16x32_bf16 v[104:107], v[40:43], a[128:131], v[104:107]
    v_fma_f32 v64, v2, v72, -v64
    v_fma_f32 v68, v2, v76, -v68
    v_mfma_f32_16x16x32_bf16 v[108:111], v[40:43], a[132:135], v[108:111]
    v_fma_f32 v65, v2, v73, -v65
    v_fma_f32 v69, v2, v77, -v69
    v_mfma_f32_16x16x32_bf16 v[112:115], v[40:43], a[136:139], v[112:115]
    buffer_load_dwordx4 v[60:63], v23, s[8:11], s47 offen sc1
    v_mfma_f32_16x16x32_bf16 v[116:119], v[44:47], a[120:123], v[116:119]
    v_fma_f32 v66, v2, v74, -v66
    v_fma_f32 v70, v2, v78, -v70
    v_mfma_f32_16x16x32_bf16 v[120:123], v[44:47], a[124:127], v[120:123]
    v_fma_f32 v67, v2, v75, -v67
    v_fma_f32 v71, v2, v79, -v71
    v_mfma_f32_16x16x32_bf16 v[124:127], v[44:47], a[128:131], v[124:127]
    v_cvt_pk_bf16_f32 v212, v64, -v68
    v_cvt_pk_bf16_f32 v213, v65, -v69
    v_mfma_f32_16x16x32_bf16 v[128:131], v[44:47], a[132:135], v[128:131]
    buffer_load_dwordx4 v[28:31], v24, s[8:11], s47 offen sc1
    v_mfma_f32_16x16x32_bf16 v[132:135], v[44:47], a[136:139], v[132:135]
    v_cvt_pk_bf16_f32 v214, v66, -v70
    v_cvt_pk_bf16_f32 v215, v67, -v71
    v_mfma_f32_16x16x32_bf16 v[136:139], v[48:51], a[120:123], v[136:139]
    v_mul_f32 v2, 0x41800000, v10
    v_mfma_f32_16x16x32_bf16 v[140:143], v[48:51], a[124:127], v[140:143]
    v_cos_f32 v2, v2
    v_mfma_f32_16x16x32_bf16 v[144:147], v[48:51], a[128:131], v[144:147]
    buffer_load_dwordx4 v[32:35], v25, s[8:11], s47 offen sc1
    v_mfma_f32_16x16x32_bf16 v[148:151], v[48:51], a[132:135], v[148:151]
    v_fmamk_f32 v64, v10, 0x00000000, v13
    v_mfma_f32_16x16x32_bf16 v[152:155], v[48:51], a[136:139], v[152:155]
    v_sin_f32 v68, v64
    v_mfma_f32_16x16x32_bf16 v[156:159], v[52:55], a[120:123], v[156:159]
    v_cos_f32 v64, v64
    v_mfma_f32_16x16x32_bf16 v[160:163], v[52:55], a[124:127], v[160:163]
    s_mov_b32 s47, s34
    buffer_load_dwordx4 a[40:43], v22, s[16:19], s47 offen sc1
    v_mfma_f32_16x16x32_bf16 v[164:167], v[52:55], a[128:131], v[164:167]
    v_fmamk_f32 v65, v10, 0x3f800000, v13
    v_mfma_f32_16x16x32_bf16 v[168:171], v[52:55], a[132:135], v[168:171]
    v_sin_f32 v69, v65
    v_mfma_f32_16x16x32_bf16 v[172:175], v[52:55], a[136:139], v[172:175]
    buffer_load_dwordx4 a[44:47], v23, s[16:19], s47 offen sc1
    s_waitcnt vmcnt(17)
    v_mfma_f32_16x16x32_bf16 v[96:99], v[80:83], a[140:143], v[96:99]
    v_cos_f32 v65, v65
    v_mfma_f32_16x16x32_bf16 v[100:103], v[80:83], a[144:147], v[100:103]
    v_fmamk_f32 v66, v10, 0x40000000, v13
    v_mfma_f32_16x16x32_bf16 v[104:107], v[80:83], a[148:151], v[104:107]
    v_sin_f32 v70, v66
    v_mfma_f32_16x16x32_bf16 v[108:111], v[80:83], a[152:155], v[108:111]
    buffer_load_dwordx4 a[48:51], v24, s[16:19], s47 offen sc1
    v_mfma_f32_16x16x32_bf16 v[112:115], v[80:83], a[156:159], v[112:115]
    v_cos_f32 v66, v66
    v_mfma_f32_16x16x32_bf16 v[116:119], v[84:87], a[140:143], v[116:119]
    v_fmamk_f32 v67, v10, 0x40400000, v13
    v_mfma_f32_16x16x32_bf16 v[120:123], v[84:87], a[144:147], v[120:123]
    v_sin_f32 v71, v67
    v_mfma_f32_16x16x32_bf16 v[124:127], v[84:87], a[148:151], v[124:127]
    buffer_load_dwordx4 a[52:55], v25, s[16:19], s47 offen sc1
    v_mfma_f32_16x16x32_bf16 v[128:131], v[84:87], a[152:155], v[128:131]
    v_cos_f32 v67, v67
    v_mfma_f32_16x16x32_bf16 v[132:135], v[84:87], a[156:159], v[132:135]
    v_add_f32 v2, v2, v2
    v_cvt_pk_bf16_f32 v216, v64, -v68
    v_mfma_f32_16x16x32_bf16 v[136:139], v[88:91], a[140:143], v[136:139]
    v_cvt_pk_bf16_f32 v217, v65, -v69
    v_cvt_pk_bf16_f32 v218, v66, -v70
    v_mfma_f32_16x16x32_bf16 v[140:143], v[88:91], a[144:147], v[140:143]
    buffer_load_dwordx4 a[216:219], v21, s[8:11], s99 offen offset:0 sc1
    v_mfma_f32_16x16x32_bf16 v[144:147], v[88:91], a[148:151], v[144:147]
    v_cvt_pk_bf16_f32 v219, v67, -v71
    v_and_b32 v216, v14, v216
    v_mfma_f32_16x16x32_bf16 v[148:151], v[88:91], a[152:155], v[148:151]
    v_and_b32 v217, v14, v217
    v_and_b32 v218, v14, v218
    v_mfma_f32_16x16x32_bf16 v[152:155], v[88:91], a[156:159], v[152:155]
    v_and_b32 v219, v14, v219
    v_fmamk_f32 v72, v10, 0x41800000, v13
    v_mfma_f32_16x16x32_bf16 v[156:159], v[92:95], a[140:143], v[156:159]
    s_add_u32 s99, s39, 0
    buffer_load_dwordx4 a[220:223], v20, s[8:11], s99 offen offset:0 sc1
    v_mfma_f32_16x16x32_bf16 v[160:163], v[92:95], a[144:147], v[160:163]
    v_sin_f32 v76, v72
    v_mfma_f32_16x16x32_bf16 v[164:167], v[92:95], a[148:151], v[164:167]
    v_cos_f32 v72, v72
    v_mfma_f32_16x16x32_bf16 v[168:171], v[92:95], a[152:155], v[168:171]
    buffer_load_dwordx4 a[224:227], v20, s[8:11], s99 offen offset:1024 sc1
    v_mfma_f32_16x16x32_bf16 v[172:175], v[92:95], a[156:159], v[172:175]
    v_fmamk_f32 v73, v10, 0x41880000, v13
    s_waitcnt vmcnt(10)
    v_cmp_ne_u32 vcc, s55, v15
    s_nop 0
    s_and_b64 vcc, vcc, s[0:1]
    s_cbranch_vccnz L_again_19
L_ok_18:
    s_barrier
    v_mfma_f32_16x16x32_bf16 v[96:99], a[240:243], a[160:163], v[96:99]
    v_sin_f32 v77, v73
    v_mfma_f32_16x16x32_bf16 v[100:103], a[240:243], a[164:167], v[100:103]
    v_cos_f32 v73, v73
    v_mfma_f32_16x16x32_bf16 v[104:107], a[240:243], a[168:171], v[104:107]
    s_add_u32 s47, s35, 0
    buffer_load_dwordx4 a[60:63], v22, s[8:11], s47 offen sc1
    v_mfma_f32_16x16x32_bf16 v[108:111], a[240:243], a[172:175], v[108:111]
    v_fmamk_f32 v74, v10, 0x41900000, v13
    v_mfma_f32_16x16x32_bf16 v[112:115], a[240:243], a[176:179], v[112:115]
    v_sin_f32 v78, v74
    v_mfma_f32_16x16x32_bf16 v[116:119], a[244:247], a[160:163], v[116:119]
    buffer_load_dwordx4 a[64:67], v23, s[8:11], s47 offen sc1
    v_mfma_f32_16x16x32_bf16 v[120:123], a[244:247], a[164:167], v[120:123]
    v_cos_f32 v74, v74
    v_mfma_f32_16x16x32_bf16 v[124:127], a[244:247], a[168:171], v[124:127]
    v_fmamk_f32 v75, v10, 0x41980000, v13
    v_mfma_f32_16x16x32_bf16 v[128:131], a[244:247], a[172:175], v[128:131]
    v_sin_f32 v79, v75
    v_mfma_f32_16x16x32_bf16 v[132:135], a[244:247], a[176:179], v[132:135]
    buffer_load_dwordx4 a[68:71], v24, s[8:11], s47 offen sc1
    v_mfma_f32_16x16x32_bf16 v[136:139], a[248:251], a[160:163], v[136:139]
    v_cos_f32 v75, v75
    v_mfma_f32_16x16x32_bf16 v[140:143], a[248:251], a[164:167], v[140:143]
    v_cvt_pk_bf16_f32 v220, v72, -v76
    v_cvt_pk_bf16_f32 v221, v73, -v77
    v_mfma_f32_16x16x32_bf16 v[144:147], a[248:251], a[168:171], v[144:147]
    v_cvt_pk_bf16_f32 v222, v74, -v78
    v_cvt_pk_bf16_f32 v223, v75, -v79
    v_mfma_f32_16x16x32_bf16 v[148:151], a[248:251], a[172:175], v[148:151]
    buffer_load_dwordx4 a[72:75], v25, s[8:11], s47 offen sc1
    v_mfma_f32_16x16x32_bf16 v[152:155], a[248:251], a[176:179], v[152:155]
    v_and_b32 v220, v14, v220
    v_and_b32 v221, v14, v221
    v_mfma_f32_16x16x32_bf16 v[156:159], a[252:255], a[160:163], v[156:159]
    v_and_b32 v222, v14, v222
    v_and_b32 v223, v14, v223
    v_mfma_f32_16x16x32_bf16 v[160:163], a[252:255], a[164:167], v[160:163]
    v_fma_f32 v64, v2, v72, -v64
    v_fma_f32 v68, v2, v76, -v68
    v_mfma_f32_16x16x32_bf16 v[164:167], a[252:255], a[168:171], v[164:167]
    s_add_u32 s47, s35, 4096
    buffer_load_dwordx4 v[40:43], v22, s[8:11], s47 offen sc1
    v_mfma_f32_16x16x32_bf16 v[168:171], a[252:255], a[172:175], v[168:171]
    v_fma_f32 v65, v2, v73, -v65
    v_fma_f32 v69, v2, v77, -v69
    v_mfma_f32_16x16x32_bf16 v[172:175], a[252:255], a[176:179], v[172:175]
    v_fma_f32 v66, v2, v74, -v66
    v_fma_f32 v70, v2, v78, -v70
    s_waitcnt vmcnt(12)
    v_mfma_f32_16x16x32_bf16 v[96:99], v[56:59], a[180:183], v[96:99]
    v_min_u32 v19, 39, v0
    v_lshlrev_b32 v19, 4, v19
    s_and_b32 s42, s2, 7
    s_lshl_b32 s42, s42, 10
    s_add_u32 s42, s42, 17846272
    s_mov_b64 exec, s[0:1]
    buffer_load_dwordx4 v[252:255], v19, s[8:11], s42 offen sc1
    s_mov_b64 exec, -1
    v_mfma_f32_16x16x32_bf16 v[100:103], v[56:59], a[184:187], v[100:103]
    v_fma_f32 v67, v2, v75, -v67
    v_fma_f32 v71, v2, v79, -v71
    v_mfma_f32_16x16x32_bf16 v[104:107], v[56:59], a[188:191], v[104:107]
    buffer_load_dwordx4 v[44:47], v23, s[8:11], s47 offen sc1
    v_mfma_f32_16x16x32_bf16 v[108:111], v[56:59], a[192:195], v[108:111]
    v_cvt_pk_bf16_f32 v224, v64, -v68
    v_cvt_pk_bf16_f32 v225, v65, -v69
    v_mfma_f32_16x16x32_bf16 v[112:115], v[56:59], a[196:199], v[112:115]
    v_cvt_pk_bf16_f32 v226, v66, -v70
    v_cvt_pk_bf16_f32 v227, v67, -v71
    v_mfma_f32_16x16x32_bf16 v[116:119], v[60:63], a[180:183], v[116:119]
    v_and_b32 v224, v14, v224
    v_and_b32 v225, v14, v225
    v_mfma_f32_16x16x32_bf16 v[120:123], v[60:63], a[184:187], v[120:123]
    buffer_load_dwordx4 v[48:51], v24, s[8:11], s47 offen sc1
    v_mfma_f32_16x16x32_bf16 v[124:127], v[60:63], a[188:191], v[124:127]
    v_and_b32 v226, v14, v226
    v_and_b32 v227, v14, v227
    v_mfma_f32_16x16x32_bf16 v[128:131], v[60:63], a[192:195], v[128:131]
    v_fma_f32 v72, v2, v64, -v72
    v_fma_f32 v76, v2, v68, -v76
    v_mfma_f32_16x16x32_bf16 v[132:135], v[60:63], a[196:199], v[132:135]
    v_fma_f32 v73, v2, v65, -v73
    v_fma_f32 v77, v2, v69, -v77
    v_mfma_f32_16x16x32_bf16 v[136:139], v[28:31], a[180:183], v[136:139]
    buffer_load_dwordx4 v[52:55], v25, s[8:11], s47 offen sc1
    v_mfma_f32_16x16x32_bf16 v[140:143], v[28:31], a[184:187], v[140:143]
    v_fma_f32 v74, v2, v66, -v74
    v_fma_f32 v78, v2, v70, -v78
    v_mfma_f32_16x16x32_bf16 v[144:147], v[28:31], a[188:191], v[144:147]
    v_fma_f32 v75, v2, v67, -v75
    v_fma_f32 v79, v2, v71, -v79
    v_mfma_f32_16x16x32_bf16 v[148:151], v[28:31], a[192:195], v[148:151]
    v_cvt_pk_bf16_f32 v228, v72, -v76
    v_cvt_pk_bf16_f32 v229, v73, -v77
    v_mfma_f32_16x16x32_bf16 v[152:155], v[28:31], a[196:199], v[152:155]
    s_add_u32 s47, s35, 8192
    buffer_load_dwordx4 v[80:83], v22, s[8:11], s47 offen sc1
    v_mfma_f32_16x16x32_bf16 v[156:159], v[32:35], a[180:183], v[156:159]
    v_cvt_pk_bf16_f32 v230, v74, -v78
    v_cvt_pk_bf16_f32 v231, v75, -v79
    v_mfma_f32_16x16x32_bf16 v[160:163], v[32:35], a[184:187], v[160:163]
    v_and_b32 v228, v14, v228
    v_and_b32 v229, v14, v229
    v_mfma_f32_16x16x32_bf16 v[164:167], v[32:35], a[188:191], v[164:167]
    buffer_load_dwordx4 v[84:87], v23, s[8:11], s47 offen sc1
    v_mfma_f32_16x16x32_bf16 v[168:171], v[32:35], a[192:195], v[168:171]
    v_and_b32 v230, v14, v230
    v_and_b32 v231, v14, v231
    v_mfma_f32_16x16x32_bf16 v[172:175], v[32:35], a[196:199], v[172:175]
    v_fma_f32 v64, v2, v72, -v64
    v_fma_f32 v68, v2, v76, -v68
    s_waitcnt vmcnt(14)
    s_waitcnt vmcnt(13)
    v_mfma_f32_16x16x32_bf16 v[116:119], a[44:47], a[200:203], v[116:119]
    s_xor_b32 s66, s50, 1
    s_mul_i32 s66, s66, 15360
    v_mfma_f32_16x16x32_bf16 v[120:123], a[44:47], a[204:207], v[120:123]
    buffer_load_dwordx4 v[88:91], v24, s[8:11], s47 offen sc1
    v_mfma_f32_16x16x32_bf16 v[124:127], a[44:47], a[208:211], v[124:127]
    s_add_u32 s66, s66, 81920
    v_add_u32 v28, s66, v20
    v_mfma_f32_16x16x32_bf16 v[128:131], a[44:47], a[212:215], v[128:131]
    s_xor_b32 s66, s50, 2
    s_mul_i32 s66, s66, 15360
    v_mfma_f32_16x16x32_bf16 v[132:135], a[44:47], a[216:219], v[132:135]
    s_add_u32 s66, s66, 87040
    v_add_u32 v29, s66, v20
    s_waitcnt vmcnt(8)
    buffer_load_dwordx4 v[92:95], v25, s[8:11], s47 offen sc1
    buffer_load_dwordx4 a[228:231], v20, s[8:11], s99 offen offset:2048 sc1
    buffer_load_dwordx4 a[232:235], v20, s[8:11], s99 offen offset:3072 sc1
    buffer_load_dwordx4 a[236:239], v21, s[8:11], s99 offen offset:0 sc1
    s_waitcnt vmcnt(0)
    v_mfma_f32_16x16x32_bf16 v[116:119], a[64:67], a[220:223], v[116:119]
    s_xor_b32 s66, s50, 3
    s_mul_i32 s66, s66, 15360
    v_mfma_f32_16x16x32_bf16 v[120:123], a[64:67], a[224:227], v[120:123]
    s_add_u32 s66, s66, 92160
    v_add_u32 v30, s66, v20
    v_mfma_f32_16x16x32_bf16 v[124:127], a[64:67], a[228:231], v[124:127]
    s_mul_i32 s66, s50, 15360
    s_add_u32 s66, s66, 81920
    v_mfma_f32_16x16x32_bf16 v[128:131], a[64:67], a[232:235], v[128:131]
    v_add_u32 v31, s66, v20
    s_lshl_b32 s66, s84, 8
    v_mfma_f32_16x16x32_bf16 v[132:135], a[64:67], a[236:239], v[132:135]
    s_add_u32 s99, s39, 5120
    buffer_load_dwordx4 a[0:3], v20, s[8:11], s99 offen offset:0 sc1
    buffer_load_dwordx4 a[4:7], v20, s[8:11], s99 offen offset:1024 sc1
    buffer_load_dwordx4 a[8:11], v20, s[8:11], s99 offen offset:2048 sc1
    buffer_load_dwordx4 a[12:15], v20, s[8:11], s99 offen offset:3072 sc1
    buffer_load_dwordx4 a[16:19], v21, s[8:11], s99 offen offset:0 sc1
    s_waitcnt vmcnt(0)
    v_mfma_f32_16x16x32_bf16 v[116:119], v[44:47], a[0:3], v[116:119]
    s_lshl_b32 s67, s50, 6
    s_add_u32 s66, s66, s67
    v_mfma_f32_16x16x32_bf16 v[120:123], v[44:47], a[4:7], v[120:123]
    s_add_u32 s66, s66, 156672
    v_lshrrev_b32 v1, 4, v0
    v_mfma_f32_16x16x32_bf16 v[124:127], v[44:47], a[8:11], v[124:127]
    v_lshl_add_u32 v1, v1, 4, s66
    ds_read_b128 v[4:7], v1
    v_mfma_f32_16x16x32_bf16 v[128:131], v[44:47], a[12:15], v[128:131]
    v_fma_f32 v65, v2, v73, -v65
    v_fma_f32 v69, v2, v77, -v69
    v_mfma_f32_16x16x32_bf16 v[132:135], v[44:47], a[16:19], v[132:135]
    s_add_u32 s99, s39, 10240
    buffer_load_dwordx4 a[20:23], v20, s[8:11], s99 offen offset:0 sc1
    buffer_load_dwordx4 a[24:27], v20, s[8:11], s99 offen offset:1024 sc1
    buffer_load_dwordx4 a[28:31], v20, s[8:11], s99 offen offset:2048 sc1
    buffer_load_dwordx4 a[32:35], v20, s[8:11], s99 offen offset:3072 sc1
    buffer_load_dwordx4 a[36:39], v21, s[8:11], s99 offen offset:0 sc1
    s_waitcnt vmcnt(0)
    v_mfma_f32_16x16x32_bf16 v[116:119], v[84:87], a[20:23], v[116:119]
    v_fma_f32 v66, v2, v74, -v66
    v_fma_f32 v70, v2, v78, -v70
    v_mfma_f32_16x16x32_bf16 v[120:123], v[84:87], a[24:27], v[120:123]
    v_fma_f32 v67, v2, v75, -v67
    v_fma_f32 v71, v2, v79, -v71
    v_mfma_f32_16x16x32_bf16 v[124:127], v[84:87], a[28:31], v[124:127]
    v_cvt_pk_bf16_f32 v232, v64, -v68
    v_cvt_pk_bf16_f32 v233, v65, -v69
    v_mfma_f32_16x16x32_bf16 v[128:131], v[84:87], a[32:35], v[128:131]
    v_cvt_pk_bf16_f32 v234, v66, -v70
    v_cvt_pk_bf16_f32 v235, v67, -v71
    v_mfma_f32_16x16x32_bf16 v[132:135], v[84:87], a[36:39], v[132:135]
    v_and_b32 v232, v14, v232
    v_and_b32 v233, v14, v233
    v_cmp_ne_u32 vcc, s55, v252
    v_cmp_ne_u32 s[88:89], s55, v253
    s_nop 0
    s_or_b64 vcc, vcc, s[88:89]
    v_cmp_ne_u32 s[88:89], s55, v254
    s_nop 0
    s_or_b64 vcc, vcc, s[88:89]
    v_cmp_ne_u32 s[88:89], s55, v255
    s_nop 0
    s_or_b64 vcc, vcc, s[88:89]
    s_and_b64 vcc, vcc, s[0:1]
    s_cbranch_vccnz L_again_22
L_ok_21:
    s_barrier
    v_lshrrev_b32 v15, 4, v0
    v_and_b32 v16, 1, v15
    v_bfe_u32 v17, v0, 2, 2
    v_xor_b32 v16, v16, v17
    v_lshlrev_b32 v16, 6, v16
    v_lshl_add_u32 v16, v15, 8, v16
    v_and_b32 v17, 3, v0
    v_lshl_add_u32 v16, v17, 4, v16
    v_xor_b32 v17, 0x80, v16
    s_mul_i32 s57, s82, 81920
    s_mul_i32 s45, s50, 20480
    s_add_u32 s57, s57, s45
    s_add_u32 s94, s57, 5242880
    v_mfma_f32_16x16x32_bf16 v[136:139], a[48:51], a[200:203], v[136:139]
    s_add_u32 m0, s45, 0
    s_add_u32 s99, s94, 0
    buffer_load_dwordx4 v16, s[8:11], s99 offen offset:0 sc1 lds
    v_mfma_f32_16x16x32_bf16 v[140:143], a[48:51], a[204:207], v[140:143]
    v_lshrrev_b32 v1, 4, v0
    v_bfe_u32 v25, v0, 3, 1
    v_mfma_f32_16x16x32_bf16 v[144:147], a[48:51], a[208:211], v[144:147]
    v_lshl_add_u32 v3, v1, 2, v25
    v_lshlrev_b32 v3, 8, v3
    v_mfma_f32_16x16x32_bf16 v[148:151], a[48:51], a[212:215], v[148:151]
    ds_write_b128 v28, v[116:119] offset:0
    buffer_load_dwordx4 v17, s[8:11], s99 offen offset:1024 sc1 lds
    v_mfma_f32_16x16x32_bf16 v[152:155], a[48:51], a[216:219], v[152:155]
    v_and_b32 v1, 1, v1
    v_lshl_add_u32 v25, v1, 1, v25
    v_mfma_f32_16x16x32_bf16 v[136:139], a[68:71], a[220:223], v[136:139]
    v_xor_b32 v25, s50, v25
    v_lshl_add_u32 v3, v25, 6, v3
    v_mfma_f32_16x16x32_bf16 v[140:143], a[68:71], a[224:227], v[140:143]
    buffer_load_dwordx4 v16, s[8:11], s99 offen offset:2048 sc1 lds
    v_mfma_f32_16x16x32_bf16 v[144:147], a[68:71], a[228:231], v[144:147]
    ds_write_b128 v28, v[120:123] offset:1024
    v_and_b32 v1, 3, v0
    v_mfma_f32_16x16x32_bf16 v[148:151], a[68:71], a[232:235], v[148:151]
    v_lshl_add_u32 v3, v1, 4, v3
    v_bfe_u32 v1, v0, 2, 1
    v_mfma_f32_16x16x32_bf16 v[152:155], a[68:71], a[236:239], v[152:155]
    v_lshl_add_u32 v3, v1, 3, v3
    s_mul_i32 s66, s50, 20480
    v_mfma_f32_16x16x32_bf16 v[136:139], v[48:51], a[0:3], v[136:139]
    buffer_load_dwordx4 v17, s[8:11], s99 offen offset:3072 sc1 lds
    v_mfma_f32_16x16x32_bf16 v[140:143], v[48:51], a[4:7], v[140:143]
    ds_write_b128 v28, v[124:127] offset:2048
    v_add_u32 v22, s66, v3
    v_mfma_f32_16x16x32_bf16 v[144:147], v[48:51], a[8:11], v[144:147]
    v_xor_b32 v23, 64, v22
    v_xor_b32 v24, 0x80, v22
    v_mfma_f32_16x16x32_bf16 v[148:151], v[48:51], a[12:15], v[148:151]
    v_xor_b32 v25, 0xc0, v22
    v_add_u32 v32, s66, v20
    v_mfma_f32_16x16x32_bf16 v[152:155], v[48:51], a[16:19], v[152:155]
    s_add_u32 m0, s45, 4096
    s_add_u32 s99, s94, 4096
    buffer_load_dwordx4 v16, s[8:11], s99 offen offset:0 sc1 lds
    v_mfma_f32_16x16x32_bf16 v[136:139], v[88:91], a[20:23], v[136:139]
    ds_write_b128 v28, v[128:131] offset:3072
    s_xor_b32 s66, s50, 1
    v_mfma_f32_16x16x32_bf16 v[140:143], v[88:91], a[24:27], v[140:143]
    s_mul_i32 s66, s66, 20480
    s_add_u32 s66, s66, 0
    v_mfma_f32_16x16x32_bf16 v[144:147], v[88:91], a[28:31], v[144:147]
    buffer_load_dwordx4 v17, s[8:11], s99 offen offset:1024 sc1 lds
    v_mfma_f32_16x16x32_bf16 v[148:151], v[88:91], a[32:35], v[148:151]
    v_add_u32 v33, s66, v20
    s_xor_b32 s66, s50, 2
    v_mfma_f32_16x16x32_bf16 v[152:155], v[88:91], a[36:39], v[152:155]
    ds_write_b128 v28, v[132:135] offset:4096
    s_mul_i32 s66, s66, 20480
    v_mfma_f32_16x16x32_bf16 v[156:159], a[52:55], a[200:203], v[156:159]
    s_add_u32 s66, s66, 3072
    v_add_u32 v34, s66, v20
    v_mfma_f32_16x16x32_bf16 v[160:163], a[52:55], a[204:207], v[160:163]
    buffer_load_dwordx4 v16, s[8:11], s99 offen offset:2048 sc1 lds
    v_mfma_f32_16x16x32_bf16 v[164:167], a[52:55], a[208:211], v[164:167]
    s_xor_b32 s66, s50, 3
    s_mul_i32 s66, s66, 20480
    v_mfma_f32_16x16x32_bf16 v[168:171], a[52:55], a[212:215], v[168:171]
    ds_write_b128 v29, v[136:139] offset:0
    s_add_u32 s66, s66, 6144
    v_mfma_f32_16x16x32_bf16 v[172:175], a[52:55], a[216:219], v[172:175]
    v_add_u32 v35, s66, v20
    v_and_b32 v234, v14, v234
    v_mfma_f32_16x16x32_bf16 v[156:159], a[72:75], a[220:223], v[156:159]
    buffer_load_dwordx4 v17, s[8:11], s99 offen offset:3072 sc1 lds
    v_mfma_f32_16x16x32_bf16 v[160:163], a[72:75], a[224:227], v[160:163]
    v_and_b32 v235, v14, v235
    v_mfma_f32_16x16x32_bf16 v[164:167], a[72:75], a[228:231], v[164:167]
    ds_write_b128 v29, v[140:143] offset:1024
    v_mfma_f32_16x16x32_bf16 v[168:171], a[72:75], a[232:235], v[168:171]
    s_bitcmp0_b32 s50, 0
    s_cselect_b32 s62, 0xffff, 0
    v_mfma_f32_16x16x32_bf16 v[172:175], a[72:75], a[236:239], v[172:175]
    s_add_u32 m0, s45, 8192
    s_add_u32 s99, s94, 8192
    buffer_load_dwordx4 v16, s[8:11], s99 offen offset:0 sc1 lds
    v_mfma_f32_16x16x32_bf16 v[156:159], v[52:55], a[0:3], v[156:159]
    s_mov_b32 s63, 0
    s_mul_i32 s64, s44, 0x3e800000
    v_mfma_f32_16x16x32_bf16 v[160:163], v[52:55], a[4:7], v[160:163]
    ds_write_b128 v29, v[144:147] offset:2048
    s_lshl_b32 s65, s44, 31
    v_mfma_f32_16x16x32_bf16 v[164:167], v[52:55], a[8:11], v[164:167]
    buffer_load_dwordx4 v17, s[8:11], s99 offen offset:1024 sc1 lds
    v_mfma_f32_16x16x32_bf16 v[168:171], v[52:55], a[12:15], v[168:171]
    s_or_b32 s65, s65, 0x3f000000
    v_mov_b32 v64, s64
    v_mfma_f32_16x16x32_bf16 v[172:175], v[52:55], a[16:19], v[172:175]
    v_mov_b32 v65, s65
    v_fmamk_f32 v66, v8, 0x43200000, v64
    v_mfma_f32_16x16x32_bf16 v[156:159], v[92:95], a[20:23], v[156:159]
    ds_write_b128 v29, v[148:151] offset:3072
    v_fmamk_f32 v67, v9, 0x43200000, v64
    v_mfma_f32_16x16x32_bf16 v[160:163], v[92:95], a[24:27], v[160:163]
    buffer_load_dwordx4 v16, s[8:11], s99 offen offset:2048 sc1 lds
    v_mfma_f32_16x16x32_bf16 v[164:167], v[92:95], a[28:31], v[164:167]
    v_fmamk_f32 v68, v10, 0x43200000, v64
    v_mfma_f32_16x16x32_bf16 v[168:171], v[92:95], a[32:35], v[168:171]
    v_cos_f32 v66, v66
    v_mfma_f32_16x16x32_bf16 v[172:175], v[92:95], a[36:39], v[172:175]
    ds_write_b128 v29, v[152:155] offset:4096
    v_mfma_f32_16x16x32_bf16 v[96:99], a[40:43], a[200:203], v[96:99]
    buffer_load_dwordx4 v17, s[8:11], s99 offen offset:3072 sc1 lds
    v_mfma_f32_16x16x32_bf16 v[100:103], a[40:43], a[204:207], v[100:103]
    v_cos_f32 v67, v67
    v_mfma_f32_16x16x32_bf16 v[104:107], a[40:43], a[208:211], v[104:107]
    v_cos_f32 v68, v68
    v_mfma_f32_16x16x32_bf16 v[108:111], a[40:43], a[212:215], v[108:111]
    ds_write_b128 v30, v[156:159] offset:0
    v_cvt_pk_bf16_f32 v66, v65, v66
    v_mfma_f32_16x16x32_bf16 v[112:115], a[40:43], a[216:219], v[112:115]
    s_add_u32 m0, s45, 12288
    s_add_u32 s99, s94, 12288
    buffer_load_dwordx4 v16, s[8:11], s99 offen offset:0 sc1 lds
    v_mfma_f32_16x16x32_bf16 v[96:99], a[60:63], a[220:223], v[96:99]
    v_cvt_pk_bf16_f32 v67, v65, v67
    v_cvt_pk_bf16_f32 v68, v65, v68
    v_mfma_f32_16x16x32_bf16 v[100:103], a[60:63], a[224:227], v[100:103]
    v_and_b32 v68, v14, v68
    v_cndmask_b32 v176, v176, v66, s[62:63]
    v_mfma_f32_16x16x32_bf16 v[104:107], a[60:63], a[228:231], v[104:107]
    ds_write_b128 v30, v[160:163] offset:1024
    buffer_load_dwordx4 v17, s[8:11], s99 offen offset:1024 sc1 lds
    v_mfma_f32_16x16x32_bf16 v[108:111], a[60:63], a[232:235], v[108:111]
    v_cndmask_b32 v196, v196, v67, s[62:63]
    v_cndmask_b32 v216, v216, v68, s[62:63]
    v_mfma_f32_16x16x32_bf16 v[112:115], a[60:63], a[236:239], v[112:115]
    v_mfma_f32_16x16x32_bf16 v[96:99], v[40:43], a[0:3], v[96:99]
    buffer_load_dwordx4 v16, s[8:11], s99 offen offset:2048 sc1 lds
    v_mfma_f32_16x16x32_bf16 v[100:103], v[40:43], a[4:7], v[100:103]
    ds_write_b128 v30, v[164:167] offset:2048
    v_mfma_f32_16x16x32_bf16 v[104:107], v[40:43], a[8:11], v[104:107]
    v_mfma_f32_16x16x32_bf16 v[108:111], v[40:43], a[12:15], v[108:111]
    v_mfma_f32_16x16x32_bf16 v[112:115], v[40:43], a[16:19], v[112:115]
    buffer_load_dwordx4 v17, s[8:11], s99 offen offset:3072 sc1 lds
    v_mfma_f32_16x16x32_bf16 v[96:99], v[80:83], a[20:23], v[96:99]
    ds_write_b128 v30, v[168:171] offset:3072
    v_mfma_f32_16x16x32_bf16 v[100:103], v[80:83], a[24:27], v[100:103]
    v_mfma_f32_16x16x32_bf16 v[104:107], v[80:83], a[28:31], v[104:107]
    v_mfma_f32_16x16x32_bf16 v[108:111], v[80:83], a[32:35], v[108:111]
    s_add_u32 m0, s45, 16384
    s_add_u32 s99, s94, 16384
    buffer_load_dwordx4 v16, s[8:11], s99 offen offset:0 sc1 lds
    v_mfma_f32_16x16x32_bf16 v[112:115], v[80:83], a[36:39], v[112:115]
    ds_write_b128 v30, v[172:175] offset:4096
    s_waitcnt vmcnt(13)
    ds_read_b64_tr_b16 a[80:81], v22 offset:0
    ds_read_b64_tr_b16 a[82:83], v22 offset:512
    ds_read_b64_tr_b16 a[84:85], v23 offset:0
    ds_read_b64_tr_b16 a[86:87], v23 offset:512
    ds_read_b64_tr_b16 a[88:89], v24 offset:0
    ds_read_b64_tr_b16 a[90:91], v24 offset:512
    ds_read_b64_tr_b16 a[92:93], v25 offset:0
    ds_read_b64_tr_b16 a[94:95], v25 offset:512
    s_waitcnt lgkmcnt(0)
    s_barrier
    v_mfma_f32_16x16x32_bf16 v[40:43], a[80:83], v[176:179], 0
    s_waitcnt vmcnt(9)
    ds_read_b64_tr_b16 a[96:97], v22 offset:4096
    ds_read_b64_tr_b16 a[98:99], v22 offset:4608
    v_mfma_f32_16x16x32_bf16 v[44:47], a[80:83], v[196:199], 0
    buffer_load_dwordx4 v17, s[8:11], s99 offen offset:1024 sc1 lds
    v_mfma_f32_16x16x32_bf16 v[48:51], a[80:83], v[216:219], 0
    ds_read_b128 v[116:119], v31 offset:0
    ds_read_b128 v[120:123], v31 offset:1024
    v_mfma_f32_16x16x32_bf16 v[52:55], a[84:87], v[176:179], 0
    ds_read_b64_tr_b16 a[100:101], v23 offset:4096
    ds_read_b64_tr_b16 a[102:103], v23 offset:4608
    v_mfma_f32_16x16x32_bf16 v[56:59], a[84:87], v[196:199], 0
    ds_read_b128 v[124:127], v31 offset:2048
    ds_read_b128 v[128:131], v31 offset:3072
    v_mfma_f32_16x16x32_bf16 v[60:63], a[84:87], v[216:219], 0
    buffer_load_dwordx4 v16, s[8:11], s99 offen offset:2048 sc1 lds
    v_mfma_f32_16x16x32_bf16 v[80:83], a[88:91], v[176:179], 0
    ds_read_b64_tr_b16 a[104:105], v24 offset:4096
    ds_read_b64_tr_b16 a[106:107], v24 offset:4608
    v_mfma_f32_16x16x32_bf16 v[84:87], a[88:91], v[196:199], 0
    ds_read_b128 v[132:135], v31 offset:4096
    ds_read_b128 v[136:139], v31 offset:5120
    v_mfma_f32_16x16x32_bf16 v[88:91], a[88:91], v[216:219], 0
    ds_read_b128 v[140:143], v31 offset:6144
    ds_read_b128 v[144:147], v31 offset:7168
    v_mfma_f32_16x16x32_bf16 v[92:95], a[92:95], v[176:179], 0
    ds_read_b64_tr_b16 a[108:109], v25 offset:4096
    ds_read_b64_tr_b16 a[110:111], v25 offset:4608
    buffer_load_dwordx4 v17, s[8:11], s99 offen offset:3072 sc1 lds
    v_mfma_f32_16x16x32_bf16 v[64:67], a[92:95], v[196:199], 0
    ds_read_b128 v[148:151], v31 offset:8192
    ds_read_b128 v[152:155], v31 offset:9216
    v_mfma_f32_16x16x32_bf16 v[68:71], a[92:95], v[216:219], 0
    ds_read_b128 v[156:159], v31 offset:10240
    ds_read_b128 v[160:163], v31 offset:11264
    s_waitcnt lgkmcnt(4)
    v_mfma_f32_16x16x32_bf16 v[40:43], a[96:99], v[180:183], v[40:43]
    s_lshl_b32 s57, s84, 6
    s_add_u32 s57, s57, s97
    s_lshl_b32 s58, s50, 2
    s_add_u32 s57, s57, s58
    v_lshrrev_b32 v18, 4, v0
    v_add_u32 v18, s57, v18
    v_mul_u32_u24 v18, 1280, v18
    s_mul_i32 s57, s83, 160
    v_add_u32 v18, s57, v18
    v_and_b32 v36, 15, v0
    v_lshl_add_u32 v38, v36, 1, v18
    v_lshl_add_u32 v18, v36, 2, v18
    s_mov_b32 s74, 0
    s_mov_b32 s75, 1310720
    s_mov_b32 s76, 40960
    s_mov_b32 s77, 1351680
    s_waitcnt vmcnt(8)
    ds_read_b64_tr_b16 a[80:81], v22 offset:8192
    ds_read_b64_tr_b16 a[82:83], v22 offset:8704
    v_mfma_f32_16x16x32_bf16 v[44:47], a[96:99], v[200:203], v[44:47]
    buffer_load_dword v236, v18, s[4:7], s74 offen offset:0
    buffer_load_dword v240, v18, s[4:7], s74 offen offset:64
    buffer_load_ushort v244, v38, s[4:7], s74 offen offset:128
    v_mfma_f32_16x16x32_bf16 v[48:51], a[96:99], v[220:223], v[48:51]
    ds_read_b128 v[164:167], v31 offset:12288
    ds_read_b128 v[168:171], v31 offset:13312
    v_mfma_f32_16x16x32_bf16 v[52:55], a[100:103], v[180:183], v[52:55]
    ds_read_b64_tr_b16 a[84:85], v23 offset:8192
    ds_read_b64_tr_b16 a[86:87], v23 offset:8704
    v_mfma_f32_16x16x32_bf16 v[56:59], a[100:103], v[200:203], v[56:59]
    buffer_load_dword v237, v18, s[4:7], s75 offen offset:0
    buffer_load_dword v241, v18, s[4:7], s75 offen offset:64
    buffer_load_ushort v245, v38, s[4:7], s75 offen offset:128
    v_mfma_f32_16x16x32_bf16 v[60:63], a[100:103], v[220:223], v[60:63]
    ds_read_b128 v[172:175], v31 offset:14336
    v_mul_f32 v4, 0xbfb8aa3b, v4
    v_mfma_f32_16x16x32_bf16 v[80:83], a[104:107], v[180:183], v[80:83]
    ds_read_b64_tr_b16 a[88:89], v24 offset:8192
    ds_read_b64_tr_b16 a[90:91], v24 offset:8704
    v_mfma_f32_16x16x32_bf16 v[84:87], a[104:107], v[200:203], v[84:87]
    buffer_load_dword v238, v18, s[4:7], s76 offen offset:0
    buffer_load_dword v242, v18, s[4:7], s76 offen offset:64
    buffer_load_ushort v246, v38, s[4:7], s76 offen offset:128
    v_mfma_f32_16x16x32_bf16 v[88:91], a[104:107], v[220:223], v[88:91]
    v_mul_f32 v5, 0xbfb8aa3b, v5
    v_mul_f32 v6, 0xbfb8aa3b, v6
    v_mfma_f32_16x16x32_bf16 v[92:95], a[108:111], v[180:183], v[92:95]
    ds_read_b64_tr_b16 a[92:93], v25 offset:8192
    ds_read_b64_tr_b16 a[94:95], v25 offset:8704
    v_mfma_f32_16x16x32_bf16 v[64:67], a[108:111], v[200:203], v[64:67]
    buffer_load_dword v239, v18, s[4:7], s77 offen offset:0
    buffer_load_dword v243, v18, s[4:7], s77 offen offset:64
    buffer_load_ushort v247, v38, s[4:7], s77 offen offset:128
    v_mfma_f32_16x16x32_bf16 v[68:71], a[108:111], v[220:223], v[68:71]
    v_mul_f32 v7, 0xbfb8aa3b, v7
    s_waitcnt lgkmcnt(0)
    v_mfma_f32_16x16x32_bf16 v[40:43], a[80:83], v[184:187], v[40:43]
    s_waitcnt vmcnt(16)
    ds_read_b64_tr_b16 a[96:97], v22 offset:12288
    ds_read_b64_tr_b16 a[98:99], v22 offset:12800
    v_mfma_f32_16x16x32_bf16 v[44:47], a[80:83], v[204:207], v[44:47]
    v_add_f32 v96, v96, v116
    v_add_f32 v97, v97, v117
    v_mfma_f32_16x16x32_bf16 v[48:51], a[80:83], v[224:227], v[48:51]
    v_add_f32 v98, v98, v118
    v_add_f32 v99, v99, v119
    v_mfma_f32_16x16x32_bf16 v[52:55], a[84:87], v[184:187], v[52:55]
    ds_read_b64_tr_b16 a[100:101], v23 offset:12288
    ds_read_b64_tr_b16 a[102:103], v23 offset:12800
    v_mfma_f32_16x16x32_bf16 v[56:59], a[84:87], v[204:207], v[56:59]
    v_add_f32 v100, v100, v120
    v_add_f32 v101, v101, v121
    v_mfma_f32_16x16x32_bf16 v[60:63], a[84:87], v[224:227], v[60:63]
    v_add_f32 v102, v102, v122
    v_add_f32 v103, v103, v123
    v_mfma_f32_16x16x32_bf16 v[80:83], a[88:91], v[184:187], v[80:83]
    ds_read_b64_tr_b16 a[104:105], v24 offset:12288
    ds_read_b64_tr_b16 a[106:107], v24 offset:12800
    v_mfma_f32_16x16x32_bf16 v[84:87], a[88:91], v[204:207], v[84:87]
    v_add_f32 v104, v104, v124
    v_add_f32 v105, v105, v125
    v_mfma_f32_16x16x32_bf16 v[88:91], a[88:91], v[224:227], v[88:91]
    v_add_f32 v106, v106, v126
    v_add_f32 v107, v107, v127
    v_mfma_f32_16x16x32_bf16 v[92:95], a[92:95], v[184:187], v[92:95]
    ds_read_b64_tr_b16 a[108:109], v25 offset:12288
    ds_read_b64_tr_b16 a[110:111], v25 offset:12800
    v_mfma_f32_16x16x32_bf16 v[64:67], a[92:95], v[204:207], v[64:67]
    v_add_f32 v108, v108, v128
    v_add_f32 v109, v109, v129
    v_mfma_f32_16x16x32_bf16 v[68:71], a[92:95], v[224:227], v[68:71]
    v_add_f32 v110, v110, v130
    v_add_f32 v111, v111, v131
    s_waitcnt lgkmcnt(0)
    v_mfma_f32_16x16x32_bf16 v[40:43], a[96:99], v[188:191], v[40:43]
    s_waitcnt vmcnt(12)
    ds_read_b64_tr_b16 a[80:81], v22 offset:16384
    ds_read_b64_tr_b16 a[82:83], v22 offset:16896
    v_mfma_f32_16x16x32_bf16 v[44:47], a[96:99], v[208:211], v[44:47]
    v_add_f32 v112, v112, v132
    v_add_f32 v113, v113, v133
    v_mfma_f32_16x16x32_bf16 v[48:51], a[96:99], v[228:231], v[48:51]
    v_add_f32 v114, v114, v134
    v_add_f32 v115, v115, v135
    v_mfma_f32_16x16x32_bf16 v[52:55], a[100:103], v[188:191], v[52:55]
    ds_read_b64_tr_b16 a[84:85], v23 offset:16384
    ds_read_b64_tr_b16 a[86:87], v23 offset:16896
    v_mfma_f32_16x16x32_bf16 v[56:59], a[100:103], v[208:211], v[56:59]
    v_add_f32 v96, v96, v136
    v_mfma_f32_16x16x32_bf16 v[60:63], a[100:103], v[228:231], v[60:63]
    v_add_f32 v97, v97, v137
    v_add_f32 v98, v98, v138
    v_mfma_f32_16x16x32_bf16 v[80:83], a[104:107], v[188:191], v[80:83]
    ds_read_b64_tr_b16 a[88:89], v24 offset:16384
    ds_read_b64_tr_b16 a[90:91], v24 offset:16896
    v_mfma_f32_16x16x32_bf16 v[84:87], a[104:107], v[208:211], v[84:87]
    v_add_f32 v99, v99, v139
    v_add_f32 v100, v100, v140
    v_mfma_f32_16x16x32_bf16 v[88:91], a[104:107], v[228:231], v[88:91]
    v_add_f32 v101, v101, v141
    v_add_f32 v102, v102, v142
    v_mfma_f32_16x16x32_bf16 v[92:95], a[108:111], v[188:191], v[92:95]
    ds_read_b64_tr_b16 a[92:93], v25 offset:16384
    ds_read_b64_tr_b16 a[94:95], v25 offset:16896
    v_mfma_f32_16x16x32_bf16 v[64:67], a[108:111], v[208:211], v[64:67]
    v_add_f32 v103, v103, v143
    v_add_f32 v104, v104, v144
    v_mfma_f32_16x16x32_bf16 v[68:71], a[108:111], v[228:231], v[68:71]
    v_add_f32 v105, v105, v145
    v_add_f32 v106, v106, v146
    s_waitcnt lgkmcnt(0)
    v_mfma_f32_16x16x32_bf16 v[52:55], a[84:87], v[192:195], v[52:55]
    v_add_f32 v107, v107, v147
    v_add_f32 v108, v108, v148
    v_mfma_f32_16x16x32_bf16 v[56:59], a[84:87], v[212:215], v[56:59]
    v_add_f32 v109, v109, v149
    v_add_f32 v110, v110, v150
    v_mfma_f32_16x16x32_bf16 v[60:63], a[84:87], v[232:235], v[60:63]
    v_add_f32 v111, v111, v151
    v_add_f32 v112, v112, v152
    v_mfma_f32_16x16x32_bf16 v[80:83], a[88:91], v[192:195], v[80:83]
    v_add_f32 v113, v113, v153
    v_add_f32 v114, v114, v154
    v_mfma_f32_16x16x32_bf16 v[84:87], a[88:91], v[212:215], v[84:87]
    v_add_f32 v115, v115, v155
    v_mfma_f32_16x16x32_bf16 v[88:91], a[88:91], v[232:235], v[88:91]
    v_add_f32 v96, v96, v156
    v_add_f32 v97, v97, v157
    v_mfma_f32_16x16x32_bf16 v[92:95], a[92:95], v[192:195], v[92:95]
    v_add_f32 v98, v98, v158
    v_add_f32 v99, v99, v159
    v_mfma_f32_16x16x32_bf16 v[64:67], a[92:95], v[212:215], v[64:67]
    v_add_f32 v100, v100, v160
    v_add_f32 v101, v101, v161
    v_mfma_f32_16x16x32_bf16 v[68:71], a[92:95], v[232:235], v[68:71]
    v_add_f32 v102, v102, v162
    v_add_f32 v103, v103, v163
    v_mfma_f32_16x16x32_bf16 v[40:43], a[80:83], v[192:195], v[40:43]
    v_add_f32 v104, v104, v164
    v_add_f32 v105, v105, v165
    v_mfma_f32_16x16x32_bf16 v[44:47], a[80:83], v[212:215], v[44:47]
    v_add_f32 v106, v106, v166
    v_add_f32 v107, v107, v167
    v_mfma_f32_16x16x32_bf16 v[48:51], a[80:83], v[232:235], v[48:51]
    v_add_f32 v108, v108, v168
    v_add_f32 v109, v109, v169
    v_add_f32 v110, v110, v170
    v_add_f32 v111, v111, v171
    v_add_f32 v112, v112, v172
    v_add_f32 v113, v113, v173
    v_add_f32 v114, v114, v174
    v_add_f32 v115, v115, v175
    ds_write_b128 v32, v[52:55] offset:0
    v_pk_mul_f32 v[96:97], v[96:97], v[4:5]
    v_pk_mul_f32 v[98:99], v[98:99], v[6:7]
    v_pk_mul_f32 v[100:101], v[100:101], v[4:5]
    v_pk_mul_f32 v[102:103], v[102:103], v[6:7]
    v_pk_mul_f32 v[104:105], v[104:105], v[4:5]
    ds_write_b128 v32, v[56:59] offset:1024
    v_pk_mul_f32 v[106:107], v[106:107], v[6:7]
    v_pk_mul_f32 v[108:109], v[108:109], v[4:5]
    v_pk_mul_f32 v[110:111], v[110:111], v[6:7]
    v_pk_mul_f32 v[112:113], v[112:113], v[4:5]
    v_pk_mul_f32 v[114:115], v[114:115], v[6:7]
    ds_write_b128 v32, v[60:63] offset:2048
    v_exp_f32 v136, v96
    v_exp_f32 v137, v97
    v_exp_f32 v138, v98
    v_exp_f32 v139, v99
    v_exp_f32 v140, v100
    ds_write_b128 v32, v[80:83] offset:3072
    v_exp_f32 v141, v101
    v_exp_f32 v142, v102
    v_exp_f32 v143, v103
    v_exp_f32 v144, v104
    v_exp_f32 v145, v105
    ds_write_b128 v32, v[84:87] offset:4096
    v_exp_f32 v146, v106
    v_exp_f32 v147, v107
    v_exp_f32 v148, v108
    v_exp_f32 v149, v109
    v_exp_f32 v150, v110
    ds_write_b128 v32, v[88:91] offset:5120
    v_exp_f32 v151, v111
    v_exp_f32 v152, v112
    v_exp_f32 v153, v113
    v_exp_f32 v154, v114
    v_exp_f32 v155, v115
    ds_write_b128 v32, v[92:95] offset:6144
    v_pk_add_f32 v[136:137], v[136:137], 1.0 op_sel_hi:[1,0]
    v_pk_add_f32 v[138:139], v[138:139], 1.0 op_sel_hi:[1,0]
    v_pk_add_f32 v[140:141], v[140:141], 1.0 op_sel_hi:[1,0]
    v_pk_add_f32 v[142:143], v[142:143], 1.0 op_sel_hi:[1,0]
    v_pk_add_f32 v[144:145], v[144:145], 1.0 op_sel_hi:[1,0]
    ds_write_b128 v32, v[64:67] offset:7168
    v_pk_add_f32 v[146:147], v[146:147], 1.0 op_sel_hi:[1,0]
    v_pk_add_f32 v[148:149], v[148:149], 1.0 op_sel_hi:[1,0]
    v_pk_add_f32 v[150:151], v[150:151], 1.0 op_sel_hi:[1,0]
    v_pk_add_f32 v[152:153], v[152:153], 1.0 op_sel_hi:[1,0]
    v_pk_add_f32 v[154:155], v[154:155], 1.0 op_sel_hi:[1,0]
    ds_write_b128 v32, v[68:71] offset:8192
    v_rcp_f32 v136, v136
    v_rcp_f32 v137, v137
    v_rcp_f32 v138, v138
    v_rcp_f32 v139, v139
    v_rcp_f32 v140, v140
    s_waitcnt lgkmcnt(0)
    s_barrier
    ds_read_b128 v[52:55], v33 offset:0
    ds_read_b128 v[56:59], v33 offset:1024
    ds_read_b128 v[60:63], v33 offset:2048
    ds_read_b128 v[80:83], v34 offset:0
    ds_read_b128 v[84:87], v34 offset:1024
    ds_read_b128 v[88:91], v34 offset:2048
    ds_read_b128 v[92:95], v35 offset:0
    ds_read_b128 v[64:67], v35 offset:1024
    ds_read_b128 v[68:71], v35 offset:2048
    v_rcp_f32 v141, v141
    v_rcp_f32 v142, v142
    v_rcp_f32 v143, v143
    v_rcp_f32 v144, v144
    v_rcp_f32 v145, v145
    v_rcp_f32 v146, v146
    v_rcp_f32 v147, v147
    v_rcp_f32 v148, v148
    v_rcp_f32 v149, v149
    v_rcp_f32 v150, v150
    v_rcp_f32 v151, v151
    v_rcp_f32 v152, v152
    v_rcp_f32 v153, v153
    v_rcp_f32 v154, v154
    v_rcp_f32 v155, v155
    v_pk_mul_f32 v[96:97], v[96:97], v[136:137]
    v_pk_mul_f32 v[98:99], v[98:99], v[138:139]
    v_pk_mul_f32 v[100:101], v[100:101], v[140:141]
    v_pk_mul_f32 v[102:103], v[102:103], v[142:143]
    v_pk_mul_f32 v[104:105], v[104:105], v[144:145]
    v_pk_mul_f32 v[106:107], v[106:107], v[146:147]
    v_pk_mul_f32 v[108:109], v[108:109], v[148:149]
    v_pk_mul_f32 v[110:111], v[110:111], v[150:151]
    v_pk_mul_f32 v[112:113], v[112:113], v[152:153]
    v_pk_mul_f32 v[114:115], v[114:115], v[154:155]
    s_waitcnt vmcnt(0)
    v_lshlrev_b32 v116, 16, v236
    v_and_b32 v120, 0xffff0000, v236
    v_lshlrev_b32 v117, 16, v237
    v_and_b32 v121, 0xffff0000, v237
    v_lshlrev_b32 v118, 16, v238
    v_and_b32 v122, 0xffff0000, v238
    v_lshlrev_b32 v119, 16, v239
    v_and_b32 v123, 0xffff0000, v239
    v_lshlrev_b32 v124, 16, v240
    v_and_b32 v128, 0xffff0000, v240
    v_lshlrev_b32 v125, 16, v241
    v_and_b32 v129, 0xffff0000, v241
    v_lshlrev_b32 v126, 16, v242
    v_and_b32 v130, 0xffff0000, v242
    v_lshlrev_b32 v127, 16, v243
    v_and_b32 v131, 0xffff0000, v243
    v_lshlrev_b32 v132, 16, v244
    v_lshlrev_b32 v133, 16, v245
    v_lshlrev_b32 v134, 16, v246
    v_lshlrev_b32 v135, 16, v247
    s_cmp_ge_u32 s50, 2
    s_cselect_b64 s[88:89], -1, 0
    s_waitcnt lgkmcnt(0)
    v_pk_add_f32 v[40:41], v[40:41], v[52:53]
    v_pk_add_f32 v[80:81], v[80:81], v[92:93]
    v_pk_add_f32 v[42:43], v[42:43], v[54:55]
    v_pk_add_f32 v[82:83], v[82:83], v[94:95]
    v_pk_add_f32 v[44:45], v[44:45], v[56:57]
    v_pk_add_f32 v[84:85], v[84:85], v[64:65]
    v_pk_add_f32 v[46:47], v[46:47], v[58:59]
    v_pk_add_f32 v[86:87], v[86:87], v[66:67]
    v_pk_add_f32 v[48:49], v[48:49], v[60:61]
    v_pk_add_f32 v[88:89], v[88:89], v[68:69]
    v_pk_add_f32 v[50:51], v[50:51], v[62:63]
    v_pk_add_f32 v[90:91], v[90:91], v[70:71]
    v_pk_add_f32 v[48:49], v[48:49], v[88:89]
    v_pk_add_f32 v[50:51], v[50:51], v[90:91]
    s_mov_b64 exec, s[88:89]
    v_swap_b32 v40, v80
    v_swap_b32 v41, v81
    v_swap_b32 v42, v82
    v_swap_b32 v43, v83
    v_swap_b32 v44, v84
    v_swap_b32 v45, v85
    v_swap_b32 v46, v86
    v_swap_b32 v47, v87
    s_mov_b64 exec, -1
    v_pk_fma_f32 v[116:117], v[40:41], v[96:97], v[116:117]
    v_pk_fma_f32 v[120:121], v[80:81], v[100:101], v[120:121]
    v_pk_fma_f32 v[118:119], v[42:43], v[98:99], v[118:119]
    v_pk_fma_f32 v[122:123], v[82:83], v[102:103], v[122:123]
    v_cvt_pk_bf16_f32 v160, v116, v120
    v_cvt_pk_bf16_f32 v161, v117, v121
    v_cvt_pk_bf16_f32 v162, v118, v122
    v_cvt_pk_bf16_f32 v163, v119, v123
    buffer_store_dword v160, v18, s[28:31], s74 offen offset:0
    buffer_store_dword v161, v18, s[28:31], s75 offen offset:0
    buffer_store_dword v162, v18, s[28:31], s76 offen offset:0
    buffer_store_dword v163, v18, s[28:31], s77 offen offset:0
    v_pk_fma_f32 v[124:125], v[44:45], v[104:105], v[124:125]
    v_pk_fma_f32 v[128:129], v[84:85], v[108:109], v[128:129]
    v_pk_fma_f32 v[126:127], v[46:47], v[106:107], v[126:127]
    v_pk_fma_f32 v[130:131], v[86:87], v[110:111], v[130:131]
    v_cvt_pk_bf16_f32 v164, v124, v128
    v_cvt_pk_bf16_f32 v165, v125, v129
    v_cvt_pk_bf16_f32 v166, v126, v130
    v_cvt_pk_bf16_f32 v167, v127, v131
    buffer_store_dword v164, v18, s[28:31], s74 offen offset:64
    buffer_store_dword v165, v18, s[28:31], s75 offen offset:64
    buffer_store_dword v166, v18, s[28:31], s76 offen offset:64
    buffer_store_dword v167, v18, s[28:31], s77 offen offset:64
    v_pk_fma_f32 v[132:133], v[48:49], v[112:113], v[132:133]
    v_pk_fma_f32 v[134:135], v[50:51], v[114:115], v[134:135]
    v_cvt_pk_bf16_f32 v168, v132, v132
    v_cvt_pk_bf16_f32 v169, v133, v133
    v_cvt_pk_bf16_f32 v170, v134, v134
    v_cvt_pk_bf16_f32 v171, v135, v135
    buffer_store_short v168, v38, s[28:31], s74 offen offset:128
    buffer_store_short v169, v38, s[28:31], s75 offen offset:128
    buffer_store_short v170, v38, s[28:31], s76 offen offset:128
    buffer_store_short v171, v38, s[28:31], s77 offen offset:128
    s_cmp_eq_u32 s2, 0
    s_cselect_b32 s88, s80, 0
    s_mov_b32 s89, 0
    v_mov_b32 v1, 0
    s_mov_b32 s59, 17825792
    v_mov_b32 v2, s55
    s_mov_b64 exec, s[88:89]
    buffer_store_dword v2, v1, s[8:11], s59 offen sc1
    s_mov_b64 exec, -1
    s_endpgm
L_again_2:
    s_mov_b32 s98, 0
L_loop_3:
    s_sleep 6
    buffer_load_dwordx2 v[10:11], v1, s[8:11], s42 offen sc1
    s_add_u32 s98, s98, 1
    s_waitcnt vmcnt(0)
    v_cmp_ne_u32 vcc, s55, v10
    v_cmp_ne_u32 s[88:89], s55, v11
    s_nop 0
    s_or_b64 vcc, vcc, s[88:89]
    s_cmp_lt_u32 s98, 0x40000
    s_cselect_b64 vcc, vcc, 0
    s_cbranch_vccnz L_loop_3
    s_nop 4
    s_branch L_ok_1
L_again_5:
    s_mov_b32 s98, 0
L_loop_6:
    s_sleep 6
    buffer_load_dword v2, v1, s[8:11], s43 offen sc1
    s_add_u32 s98, s98, 1
    s_waitcnt vmcnt(0)
    v_cmp_ne_u32 vcc, s55, v2
    s_cmp_lt_u32 s98, 0x40000
    s_cselect_b64 vcc, vcc, 0
    s_cbranch_vccnz L_loop_6
    s_nop 4
    s_branch L_ok_4
L_again_8:
    s_mov_b32 s98, 0
L_loop_9:
    s_sleep 6
    buffer_load_dword v27, v26, s[8:11], s42 offen sc1
    s_add_u32 s98, s98, 1
    s_waitcnt vmcnt(0)
    v_cmp_ne_u32 vcc, s55, v27
    s_cmp_lt_u32 s98, 0x40000
    s_cselect_b64 vcc, vcc, 0
    s_cbranch_vccnz L_loop_9
    s_nop 4
    s_branch L_ok_7
L_zspec_10:
    v_cvt_pk_bf16_f32 v160, v144, v152
    v_cvt_pk_bf16_f32 v162, v128, v136
    v_cvt_pk_bf16_f32 v161, v145, v153
    v_cvt_pk_bf16_f32 v163, v129, v137
    v_cvt_pk_bf16_f32 v164, v144, v152
    v_cvt_pk_bf16_f32 v166, v132, v140
    v_cvt_pk_bf16_f32 v165, v145, v153
    v_cvt_pk_bf16_f32 v167, v133, v141
    v_cvt_pk_bf16_f32 v168, v146, v154
    v_cvt_pk_bf16_f32 v170, v130, v138
    v_cvt_pk_bf16_f32 v169, v147, v155
    v_cvt_pk_bf16_f32 v171, v131, v139
    v_cvt_pk_bf16_f32 v172, v146, v154
    v_cvt_pk_bf16_f32 v174, v134, v142
    v_cvt_pk_bf16_f32 v173, v147, v155
    v_cvt_pk_bf16_f32 v175, v135, v143
    s_nop 1
    s_branch L_zdone_11
L_again_13:
    s_mov_b32 s98, 0
L_loop_14:
    s_sleep 6
    buffer_load_dword v15, v37, s[8:11], s42 offen sc1
    s_add_u32 s98, s98, 1
    s_waitcnt vmcnt(0)
    v_cmp_ne_u32 vcc, s55, v15
    s_cmp_lt_u32 s98, 0x40000
    s_cselect_b64 vcc, vcc, 0
    s_cbranch_vccnz L_loop_14
    s_nop 4
    s_branch L_ok_12
L_again_16:
    s_mov_b32 s98, 0
L_loop_17:
    s_sleep 6
    buffer_load_dword v27, v26, s[8:11], s43 offen sc1
    s_add_u32 s98, s98, 1
    s_waitcnt vmcnt(0)
    v_cmp_ne_u32 vcc, s55, v27
    s_cmp_lt_u32 s98, 0x40000
    s_cselect_b64 vcc, vcc, 0
    s_cbranch_vccnz L_loop_17
    s_nop 4
    s_branch L_ok_15
L_again_19:
    s_mov_b32 s98, 0
L_loop_20:
    s_sleep 6
    buffer_load_dword v15, v37, s[8:11], s43 offen sc1
    s_add_u32 s98, s98, 1
    s_waitcnt vmcnt(0)
    v_cmp_ne_u32 vcc, s55, v15
    s_cmp_lt_u32 s98, 0x40000
    s_cselect_b64 vcc, vcc, 0
    s_cbranch_vccnz L_loop_20
    s_nop 4
    s_branch L_ok_18
L_again_22:
    s_mov_b32 s98, 0
L_loop_23:
    s_sleep 6
    buffer_load_dwordx4 v[252:255], v19, s[8:11], s42 offen sc1
    s_add_u32 s98, s98, 1
    s_waitcnt vmcnt(0)
    v_cmp_ne_u32 vcc, s55, v252
    v_cmp_ne_u32 s[88:89], s55, v253
    s_nop 0
    s_or_b64 vcc, vcc, s[88:89]
    v_cmp_ne_u32 s[88:89], s55, v254
    s_nop 0
    s_or_b64 vcc, vcc, s[88:89]
    v_cmp_ne_u32 s[88:89], s55, v255
    s_nop 0
    s_or_b64 vcc, vcc, s[88:89]
    s_cmp_lt_u32 s98, 0x40000
    s_cselect_b64 vcc, vcc, 0
    s_cbranch_vccnz L_loop_23
    s_nop 4
    s_branch L_ok_21
L_gpath:
    s_mul_i32 s54, s53, 3
    s_add_u32 s54, s54, s52
    s_sub_u32 s54, s54, 5
    s_mul_i32 s62, s51, 6
    s_add_u32 s62, s62, s54
    s_lshl_b32 s66, s62, 1
    s_add_u32 s66, s66, s50
    s_add_u32 s57, s62, 192
    s_cmp_eq_u32 s50, 2
    s_cselect_b32 s66, s57, s66
    s_cmp_eq_u32 s50, 3
    s_cselect_b32 s66, 216, s66
    s_mul_i32 s67, s50, 10240
    s_add_u32 s67, s67, 0
    v_lshlrev_b32 v48, 4, v0
    s_lshr_b32 s68, s66, 2
    s_and_b32 s69, s66, 3
    s_lshl_b32 s57, s68, 5
    s_lshr_b32 s58, s69, 1
    s_lshl_b32 s58, s58, 4
    s_add_u32 s57, s57, s58
    s_and_b32 s58, s69, 1
    s_lshl_b32 s58, s58, 2
    s_add_u32 s57, s57, s58
    s_mul_i32 s63, s57, 1280
    s_mul_hi_u32 s90, s62, 1431655766
    s_mul_i32 s57, s90, 3
    s_sub_u32 s57, s62, s57
    s_mul_i32 s91, s57, 14
    s_min_u32 s91, s91, 26
    s_and_b32 s93, s90, 3
    s_lshr_b32 s92, s90, 2
    s_lshl_b32 s64, s92, 2
    s_add_u32 s64, s64, s50
    s_mul_i32 s64, s64, 41088
    v_lshrrev_b32 v1, 4, v0
    s_lshl_b32 s57, s93, 4
    v_add_u32 v1, s57, v1
    v_mul_u32_u24 v1, 642, v1
    s_lshl_b32 s57, s91, 4
    s_add_u32 s57, s57, 2
    v_add_u32 v1, s57, v1
    v_and_b32 v2, 15, v0
    v_lshrrev_b32 v4, 5, v0
    v_xor_b32 v2, v2, v4
    v_xor_b32 v4, 0, v2
    v_min_u32 v4, 13, v4
    v_lshl_add_u32 v4, v4, 4, v1
    v_add_u32 v54, 0, v4
    v_xor_b32 v4, 2, v2
    v_min_u32 v4, 13, v4
    v_lshl_add_u32 v4, v4, 4, v1
    v_add_u32 v55, 2568, v4
    v_xor_b32 v4, 4, v2
    v_min_u32 v4, 13, v4
    v_lshl_add_u32 v4, v4, 4, v1
    v_add_u32 v56, 5136, v4
    v_xor_b32 v4, 6, v2
    v_min_u32 v4, 13, v4
    v_lshl_add_u32 v4, v4, 4, v1
    v_add_u32 v57, 7704, v4
    s_waitcnt lgkmcnt(0)
    s_mov_b32 s24, s42
    s_mov_b32 s25, s43
    s_mov_b32 s26, 2211840
    s_mov_b32 s27, 0x20000
    s_mov_b32 s16, s34
    s_mov_b32 s17, s35
    s_mov_b32 s18, 1314816
    s_mov_b32 s19, 0x20000
    s_mov_b32 s20, s36
    s_mov_b32 s21, s37
    s_mov_b32 s22, 1314816
    s_mov_b32 s23, 0x20000
    s_cmp_ge_u32 s66, 216
    s_cbranch_scc1 L_nojob_24
    s_add_u32 m0, s67, 0
    s_add_u32 s58, s63, 0
    buffer_load_dwordx4 v48, s[24:27], s58 offen nt lds
    s_add_u32 m0, s67, 1024
    s_add_u32 s58, s63, 1024
    buffer_load_dwordx4 v48, s[24:27], s58 offen nt lds
    s_add_u32 m0, s67, 2048
    s_add_u32 s58, s63, 2048
    buffer_load_dwordx4 v48, s[24:27], s58 offen nt lds
    s_add_u32 m0, s67, 3072
    s_add_u32 s58, s63, 3072
    buffer_load_dwordx4 v48, s[24:27], s58 offen nt lds
    s_add_u32 m0, s67, 4096
    s_add_u32 s58, s63, 4096
    buffer_load_dwordx4 v48, s[24:27], s58 offen nt lds
    s_add_u32 m0, s67, 5120
    s_add_u32 s58, s63, 10240
    buffer_load_dwordx4 v48, s[24:27], s58 offen nt lds
    s_add_u32 m0, s67, 6144
    s_add_u32 s58, s63, 11264
    buffer_load_dwordx4 v48, s[24:27], s58 offen nt lds
    s_add_u32 m0, s67, 7168
    s_add_u32 s58, s63, 12288
    buffer_load_dwordx4 v48, s[24:27], s58 offen nt lds
    s_add_u32 m0, s67, 8192
    s_add_u32 s58, s63, 13312
    buffer_load_dwordx4 v48, s[24:27], s58 offen nt lds
    s_add_u32 m0, s67, 9216
    s_add_u32 s58, s63, 14336
    buffer_load_dwordx4 v48, s[24:27], s58 offen nt lds
L_nojob_24:
    s_mov_b32 s8, s48
    s_add_u32 m0, s56, 20480
    s_mov_b32 s9, s49
    buffer_load_dwordx4 v54, s[16:19], s64 offen lds
    s_mov_b32 s10, 18874368
    s_mov_b32 s11, 0x20000
    s_mov_b32 s12, s40
    s_mov_b32 s13, s41
    s_mov_b32 s14, 2211840
    s_mov_b32 s15, 0x20000
    s_mov_b32 s28, s44
    s_mov_b32 s29, s45
    s_mov_b32 s30, 2621440
    s_add_u32 m0, s56, 21504
    s_mov_b32 s31, 0x20000
    buffer_load_dwordx4 v55, s[16:19], s64 offen lds
    s_mov_b32 s4, s32
    s_mov_b32 s5, s33
    s_mov_b32 s6, 2621440
    s_mov_b32 s7, 0x20000
    s_mov_b32 s36, s66
    s_mov_b32 s37, s67
    s_mov_b32 s38, s68
    s_mov_b32 s39, s69
    s_mov_b32 s35, s62
    s_mov_b32 s34, s64
    s_and_b32 s59, s51, 3
    s_lshl_b32 s57, s52, 1
    s_mul_i32 s58, s59, 3
    s_add_u32 s57, s57, s58
    s_mul_i32 s58, s57, 26
    s_add_u32 m0, s56, 22528
    s_lshr_b32 s58, s58, 8
    buffer_load_dwordx4 v56, s[16:19], s34 offen lds
    s_mul_i32 s58, s58, 10
    s_sub_u32 s96, s57, s58
    s_lshl_b32 s60, s96, 7
    s_lshr_b32 s57, s51, 1
    s_lshl_b32 s57, s57, 7
    s_and_b32 s58, s51, 1
    s_lshl_b32 s58, s58, 4
    s_add_u32 s97, s57, s58
    s_lshr_b32 s57, s50, 1
    s_add_u32 m0, s56, 23552
    s_lshl_b32 s57, s57, 6
    buffer_load_dwordx4 v57, s[16:19], s34 offen lds
    s_and_b32 s58, s50, 1
    s_lshl_b32 s58, s58, 3
    s_add_u32 s57, s57, s58
    s_add_u32 s57, s57, s97
    v_bfe_u32 v1, v0, 3, 1
    v_lshlrev_b32 v1, 10, v1
    v_bfe_u32 v2, v0, 4, 1
    v_lshl_add_u32 v1, v2, 5, v1
    v_lshrrev_b32 v2, 5, v0
    s_add_u32 m0, s56, 24576
    v_add3_u32 v1, v1, v2, s57
    buffer_load_dwordx4 v54, s[20:23], s34 offen lds
    v_mul_u32_u24 v1, 1280, v1
    v_and_b32 v2, 7, v0
    v_lshrrev_b32 v4, 4, v0
    v_xor_b32 v2, v2, v4
    v_lshl_add_u32 v8, v2, 4, v1
    v_xor_b32 v9, 64, v8
    v_add_u32 v10, 3072, v8
    v_add_u32 v11, 4608, v9
    v_add_u32 v9, 1536, v9
    s_add_u32 m0, s56, 25600
    s_add_u32 s61, s60, 128
    buffer_load_dwordx4 v55, s[20:23], s34 offen lds
    s_cmp_eq_u32 s61, 1280
    s_cselect_b32 s61, 0, s61
    s_add_u32 s62, s61, 128
    s_cmp_eq_u32 s62, 1280
    s_cselect_b32 s62, 0, s62
    s_add_u32 s63, s62, 128
    s_cmp_eq_u32 s63, 1280
    s_cselect_b32 s63, 0, s63
    s_add_u32 s64, s63, 128
    s_add_u32 m0, s56, 26624
    s_cmp_eq_u32 s64, 1280
    s_cselect_b32 s64, 0, s64
    buffer_load_dwordx4 v56, s[20:23], s34 offen lds
    s_add_u32 s65, s64, 128
    s_cmp_eq_u32 s65, 1280
    s_cselect_b32 s65, 0, s65
    s_add_u32 s66, s65, 128
    s_cmp_eq_u32 s66, 1280
    s_cselect_b32 s66, 0, s66
    s_add_u32 s67, s66, 128
    s_cmp_eq_u32 s67, 1280
    s_cselect_b32 s67, 0, s67
    s_add_u32 m0, s56, 27648
    s_add_u32 s68, s67, 128
    buffer_load_dwordx4 v57, s[20:23], s34 offen lds
    s_cmp_eq_u32 s68, 1280
    s_cselect_b32 s68, 0, s68
    s_add_u32 s69, s68, 128
    s_cmp_eq_u32 s69, 1280
    s_cselect_b32 s69, 0, s69
    s_add_u32 s40, s94, L_tab-L_pc
    s_addc_u32 s41, s95, 0
    s_and_b32 s84, s52, 1
    s_lshr_b32 s83, s52, 1
    v_mov_b32 v35, 0
    s_mov_b32 s99, 17825792
    s_lshl_b32 s57, s53, 2
    buffer_load_dword v35, v35, s[8:11], s99 offen sc1
    s_add_u32 s83, s83, s57
    s_lshl_b32 s82, s51, 1
    s_add_u32 s82, s82, s84
    s_cmp_eq_u32 s50, 0
    s_cselect_b32 s80, 1, 0
    s_cselect_b64 s[0:1], -1, 0
    s_mov_b32 s81, 0
    s_mov_b32 s85, 0x05040100
    s_mov_b32 s86, 0x07060302
    s_mov_b32 s87, 0x3f803f80
    v_and_b32 v1, 31, v0
    v_lshrrev_b32 v2, 5, v0
    s_lshr_b32 s57, s50, 1
    s_lshl_b32 s57, s57, 2
    v_add_u32 v2, s57, v2
    v_bfe_u32 v7, v0, 1, 3
    v_xor_b32 v2, v2, v7
    v_lshlrev_b32 v2, 4, v2
    v_lshl_add_u32 v2, v1, 7, v2
    v_add_u32 v12, s56, v2
    v_xor_b32 v13, 32, v12
    v_xor_b32 v14, 64, v12
    v_xor_b32 v15, 0x60, v12
    v_mov_b32 v29, 0
    v_mov_b32 v30, 0
    v_mov_b32 v31, 0
    v_mov_b32 v32, 0
    s_mul_i32 s70, s60, 1728
    s_mul_i32 s71, s61, 1728
    s_mul_i32 s72, s62, 1728
    s_mul_i32 s73, s63, 1728
    s_mul_i32 s74, s64, 1728
    s_mul_i32 s75, s65, 1728
    s_mul_i32 s76, s66, 1728
    s_mul_i32 s77, s67, 1728
    s_mul_i32 s78, s68, 1728
    s_mul_i32 s79, s69, 1728
    s_mov_b32 s94, s35
    s_movk_i32 s57, 80
    s_movk_i32 s58, 64
    v_add_u32 v2, 0, v0
    v_mul_u32_u24 v4, 52429, v2
    v_lshrrev_b32 v4, 22, v4
    v_mul_lo_u32 v4, v4, s57
    v_sub_u32 v4, v2, v4
    v_and_b32 v49, 31, v4
    v_sub_u32 v7, v2, v49
    v_lshrrev_b32 v50, 1, v49
    v_add_u32 v7, v7, v50
    v_and_b32 v49, 1, v49
    v_lshl_add_u32 v7, v49, 4, v7
    v_cmp_gt_u32 vcc, s58, v4
    s_nop 1
    v_cndmask_b32 v7, v2, v7, vcc
    v_lshl_add_u32 v232, v7, 4, s37
    v_add_u32 v2, 64, v0
    v_mul_u32_u24 v4, 52429, v2
    v_lshrrev_b32 v4, 22, v4
    v_mul_lo_u32 v4, v4, s57
    v_sub_u32 v4, v2, v4
    v_and_b32 v49, 31, v4
    v_sub_u32 v7, v2, v49
    v_lshrrev_b32 v50, 1, v49
    v_add_u32 v7, v7, v50
    v_and_b32 v49, 1, v49
    v_lshl_add_u32 v7, v49, 4, v7
    v_cmp_gt_u32 vcc, s58, v4
    s_nop 1
    v_cndmask_b32 v7, v2, v7, vcc
    v_lshl_add_u32 v233, v7, 4, s37
    v_add_u32 v2, 128, v0
    v_mul_u32_u24 v4, 52429, v2
    v_lshrrev_b32 v4, 22, v4
    v_mul_lo_u32 v4, v4, s57
    v_sub_u32 v4, v2, v4
    v_and_b32 v49, 31, v4
    v_sub_u32 v7, v2, v49
    v_lshrrev_b32 v50, 1, v49
    v_add_u32 v7, v7, v50
    v_and_b32 v49, 1, v49
    v_lshl_add_u32 v7, v49, 4, v7
    v_cmp_gt_u32 vcc, s58, v4
    s_nop 1
    v_cndmask_b32 v7, v2, v7, vcc
    v_lshl_add_u32 v234, v7, 4, s37
    v_add_u32 v2, 192, v0
    v_mul_u32_u24 v4, 52429, v2
    v_lshrrev_b32 v4, 22, v4
    v_mul_lo_u32 v4, v4, s57
    v_sub_u32 v4, v2, v4
    v_and_b32 v49, 31, v4
    v_sub_u32 v7, v2, v49
    v_lshrrev_b32 v50, 1, v49
    v_add_u32 v7, v7, v50
    v_and_b32 v49, 1, v49
    v_lshl_add_u32 v7, v49, 4, v7
    v_cmp_gt_u32 vcc, s58, v4
    s_nop 1
    v_cndmask_b32 v7, v2, v7, vcc
    v_lshl_add_u32 v235, v7, 4, s37
    v_add_u32 v2, 256, v0
    v_mul_u32_u24 v4, 52429, v2
    v_lshrrev_b32 v4, 22, v4
    v_mul_lo_u32 v4, v4, s57
    v_sub_u32 v4, v2, v4
    v_and_b32 v49, 31, v4
    v_sub_u32 v7, v2, v49
    v_lshrrev_b32 v50, 1, v49
    v_add_u32 v7, v7, v50
    v_and_b32 v49, 1, v49
    v_lshl_add_u32 v7, v49, 4, v7
    v_cmp_gt_u32 vcc, s58, v4
    s_nop 1
    v_cndmask_b32 v7, v2, v7, vcc
    v_lshl_add_u32 v236, v7, 4, s37
    v_add_u32 v2, 320, v0
    v_mul_u32_u24 v4, 52429, v2
    v_lshrrev_b32 v4, 22, v4
    v_mul_lo_u32 v4, v4, s57
    v_sub_u32 v4, v2, v4
    v_and_b32 v49, 31, v4
    v_sub_u32 v7, v2, v49
    v_lshrrev_b32 v50, 1, v49
    v_add_u32 v7, v7, v50
    v_and_b32 v49, 1, v49
    v_lshl_add_u32 v7, v49, 4, v7
    v_cmp_gt_u32 vcc, s58, v4
    s_nop 1
    v_cndmask_b32 v7, v2, v7, vcc
    v_lshl_add_u32 v237, v7, 4, s37
    v_add_u32 v2, 384, v0
    v_mul_u32_u24 v4, 52429, v2
    v_lshrrev_b32 v4, 22, v4
    v_mul_lo_u32 v4, v4, s57
    v_sub_u32 v4, v2, v4
    v_and_b32 v49, 31, v4
    v_sub_u32 v7, v2, v49
    v_lshrrev_b32 v50, 1, v49
    v_add_u32 v7, v7, v50
    v_and_b32 v49, 1, v49
    v_lshl_add_u32 v7, v49, 4, v7
    v_cmp_gt_u32 vcc, s58, v4
    s_nop 1
    v_cndmask_b32 v7, v2, v7, vcc
    v_lshl_add_u32 v238, v7, 4, s37
    v_add_u32 v2, 448, v0
    v_mul_u32_u24 v4, 52429, v2
    v_lshrrev_b32 v4, 22, v4
    v_mul_lo_u32 v4, v4, s57
    v_sub_u32 v4, v2, v4
    v_and_b32 v49, 31, v4
    v_sub_u32 v7, v2, v49
    v_lshrrev_b32 v50, 1, v49
    v_add_u32 v7, v7, v50
    v_and_b32 v49, 1, v49
    v_lshl_add_u32 v7, v49, 4, v7
    v_cmp_gt_u32 vcc, s58, v4
    s_nop 1
    v_cndmask_b32 v7, v2, v7, vcc
    v_lshl_add_u32 v239, v7, 4, s37
    v_add_u32 v2, 512, v0
    v_mul_u32_u24 v4, 52429, v2
    v_lshrrev_b32 v4, 22, v4
    v_mul_lo_u32 v4, v4, s57
    v_sub_u32 v4, v2, v4
    v_and_b32 v49, 31, v4
    v_sub_u32 v7, v2, v49
    v_lshrrev_b32 v50, 1, v49
    v_add_u32 v7, v7, v50
    v_and_b32 v49, 1, v49
    v_lshl_add_u32 v7, v49, 4, v7
    v_cmp_gt_u32 vcc, s58, v4
    s_nop 1
    v_cndmask_b32 v7, v2, v7, vcc
    v_lshl_add_u32 v240, v7, 4, s37
    v_add_u32 v2, 576, v0
    v_mul_u32_u24 v4, 52429, v2
    v_lshrrev_b32 v4, 22, v4
    v_mul_lo_u32 v4, v4, s57
    v_sub_u32 v4, v2, v4
    v_and_b32 v49, 31, v4
    v_sub_u32 v7, v2, v49
    v_lshrrev_b32 v50, 1, v49
    v_add_u32 v7, v7, v50
    v_and_b32 v49, 1, v49
    v_lshl_add_u32 v7, v49, 4, v7
    v_cmp_gt_u32 vcc, s58, v4
    s_nop 1
    v_cndmask_b32 v7, v2, v7, vcc
    v_lshl_add_u32 v241, v7, 4, s37
    s_and_b32 s32, s50, 1
    s_lshr_b32 s33, s50, 1
    s_mul_i32 s33, s33, 7
    s_lshl_b32 s57, s32, 12
    s_lshl_b32 s58, s92, 9
    s_add_u32 s57, s57, s58
    s_lshl_b32 s58, s93, 7
    s_add_u32 s57, s57, s58
    v_and_b32 v1, 7, v0
    v_lshl_add_u32 v1, v1, 4, s57
    v_lshrrev_b32 v2, 3, v0
    s_add_u32 s57, s91, s33
    s_lshl_b32 s57, s57, 3
    s_add_u32 s57, s57, 1
    v_add_u32 v2, s57, v2
    s_movk_i32 s57, 160
    v_add_u32 v4, 0, v2
    v_lshlrev_b32 v7, 1, v4
    v_sub_u32 v49, 641, v7
    v_cmp_gt_u32 vcc, s57, v4
    s_nop 1
    v_cndmask_b32 v7, v49, v7, vcc
    v_cmp_ne_u32 vcc, s57, v4
    s_nop 1
    v_cndmask_b32 v7, 0, v7, vcc
    v_lshl_add_u32 v41, v7, 13, v1
    v_add_u32 v4, 8, v2
    v_lshlrev_b32 v7, 1, v4
    v_sub_u32 v49, 641, v7
    v_cmp_gt_u32 vcc, s57, v4
    s_nop 1
    v_cndmask_b32 v7, v49, v7, vcc
    v_cmp_ne_u32 vcc, s57, v4
    s_nop 1
    v_cndmask_b32 v7, 0, v7, vcc
    v_lshl_add_u32 v42, v7, 13, v1
    v_add_u32 v4, 16, v2
    v_lshlrev_b32 v7, 1, v4
    v_sub_u32 v49, 641, v7
    v_cmp_gt_u32 vcc, s57, v4
    s_nop 1
    v_cndmask_b32 v7, v49, v7, vcc
    v_cmp_ne_u32 vcc, s57, v4
    s_nop 1
    v_cndmask_b32 v7, 0, v7, vcc
    v_lshl_add_u32 v43, v7, 13, v1
    v_add_u32 v4, 24, v2
    v_lshlrev_b32 v7, 1, v4
    v_sub_u32 v49, 641, v7
    v_cmp_gt_u32 vcc, s57, v4
    s_nop 1
    v_cndmask_b32 v7, v49, v7, vcc
    v_cmp_ne_u32 vcc, s57, v4
    s_nop 1
    v_cndmask_b32 v7, 0, v7, vcc
    v_lshl_add_u32 v44, v7, 13, v1
    v_add_u32 v4, 32, v2
    v_lshlrev_b32 v7, 1, v4
    v_sub_u32 v49, 641, v7
    v_cmp_gt_u32 vcc, s57, v4
    s_nop 1
    v_cndmask_b32 v7, v49, v7, vcc
    v_cmp_ne_u32 vcc, s57, v4
    s_nop 1
    v_cndmask_b32 v7, 0, v7, vcc
    v_lshl_add_u32 v45, v7, 13, v1
    v_add_u32 v4, 40, v2
    v_lshlrev_b32 v7, 1, v4
    v_sub_u32 v49, 641, v7
    v_cmp_gt_u32 vcc, s57, v4
    s_nop 1
    v_cndmask_b32 v7, v49, v7, vcc
    v_cmp_ne_u32 vcc, s57, v4
    s_nop 1
    v_cndmask_b32 v7, 0, v7, vcc
    v_lshl_add_u32 v46, v7, 13, v1
    v_add_u32 v4, 48, v2
    v_lshlrev_b32 v7, 1, v4
    v_sub_u32 v49, 641, v7
    v_cmp_gt_u32 vcc, s57, v4
    s_nop 1
    v_cndmask_b32 v7, v49, v7, vcc
    v_cmp_ne_u32 vcc, s57, v4
    s_nop 1
    v_cndmask_b32 v7, 0, v7, vcc
    v_lshl_add_u32 v47, v7, 13, v1
    v_add_u32 v49, s37, v48
    v_bfe_u32 v1, v0, 2, 2
    v_mul_u32_u24 v1, 1280, v1
    v_lshrrev_b32 v2, 4, v0
    v_lshl_add_u32 v1, v2, 5, v1
    v_and_b32 v2, 3, v0
    v_lshl_add_u32 v1, v2, 3, v1
    v_add_u32 v52, s37, v1
    s_mul_i32 s57, s38, 5120
    s_lshl_b32 s58, s39, 8
    s_add_u32 s57, s57, s58
    s_add_u32 s91, s57, 14942208
    v_and_b32 v1, 7, v0
    v_lshrrev_b32 v2, 3, v0
    v_lshlrev_b32 v2, 1, v2
    v_lshl_add_u32 v2, v1, 9, v2
    v_lshl_add_u32 v2, v1, 4, v2
    s_lshl_b32 s57, s32, 8
    s_add_u32 s57, s57, 61440
    v_add_u32 v53, s57, v2
    s_lshl_b32 s33, s33, 4
    s_mov_b32 s90, 2621440
    v_lshrrev_b32 v1, 3, v0
    v_mov_b32 v2, v1
    s_lshl_b32 s57, s50, 4
    s_lshl_b32 s58, s54, 7
    v_add_u32 v2, s57, v2
    v_mul_u32_u24 v2, 3456, v2
    v_bfe_u32 v4, v1, 1, 1
    v_lshlrev_b32 v4, 2, v4
    v_and_b32 v7, 7, v0
    v_xor_b32 v4, v4, v7
    v_lshl_add_u32 v16, v4, 4, v2
    v_add_u32 v16, s58, v16
    v_add_u32 v17, 26624, v16
    v_lshrrev_b32 v1, 5, v0
    v_lshlrev_b32 v1, 3, v1
    v_bfe_u32 v2, v0, 2, 2
    v_add_u32 v1, v1, v2
    v_bfe_u32 v4, v0, 4, 1
    v_lshlrev_b32 v4, 5, v4
    v_and_b32 v7, 3, v0
    v_lshl_add_u32 v4, v7, 3, v4
    v_bfe_u32 v2, v0, 3, 1
    s_and_b32 s58, s50, 1
    v_xor_b32 v2, s58, v2
    v_lshl_add_u32 v2, v2, 6, v4
    v_lshl_add_u32 v2, v1, 7, v2
    s_lshr_b32 s57, s50, 1
    s_mul_i32 s58, s57, 57344
    s_add_u32 s57, s58, 40960
    s_sub_u32 s58, 98304, s58
    v_add_u32 v20, s57, v2
    v_xor_b32 v21, 64, v20
    v_add_u32 v22, s58, v2
    v_xor_b32 v23, 64, v22
    v_bfe_u32 v1, v0, 4, 1
    v_lshlrev_b32 v1, 10, v1
    v_lshrrev_b32 v2, 5, v0
    v_lshl_add_u32 v1, v2, 8, v1
    v_and_b32 v4, 15, v0
    v_lshl_add_u32 v1, v4, 4, v1
    s_and_b32 s58, s50, 1
    s_lshl_b32 s57, s58, 11
    v_add_u32 v19, s57, v1
    s_lshl_b32 s57, s58, 7
    s_add_u32 s57, s57, 155648
    v_and_b32 v4, 31, v0
    v_lshl_add_u32 v27, v4, 2, s57
    v_xor_b32 v28, 0x80, v27
    v_and_b32 v1, 1, v0
    v_lshlrev_b32 v1, 6, v1
    v_lshrrev_b32 v2, 4, v0
    v_lshl_add_u32 v1, v2, 4, v1
    s_lshl_b32 s57, s50, 7
    s_add_u32 s57, s57, 155648
    v_add_u32 v26, s57, v1
    s_add_u32 m0, s56, 0
    s_nop 0
    buffer_load_dwordx4 v8, s[4:7], s60 offen offset:0 lds
    buffer_load_dwordx4 v9, s[4:7], s60 offen offset:1024 lds
    buffer_load_dwordx4 v10, s[4:7], s60 offen offset:2048 lds
    buffer_load_dwordx4 v11, s[4:7], s60 offen offset:3072 lds
    s_waitcnt vmcnt(4)
    v_readfirstlane_b32 s55, v35
    s_nop 0
    s_mul_i32 s55, s55, 0x9E3779B1
    s_add_u32 s55, s55, 0x7F4A7C15
    s_barrier
    s_add_u32 s57, s33, 0
    v_xor_b32 v58, s57, v53
    v_add_u32 v59, 57344, v58
    ds_read_u16 v64, v58 offset:0
    ds_read_u16 v192, v58 offset:4096
    ds_read_u16 v65, v58 offset:28672
    ds_read_u16 v193, v58 offset:32768
    ds_read_u16 v66, v59 offset:0
    ds_read_u16 v194, v59 offset:4096
    ds_read_u16 v67, v59 offset:28672
    ds_read_u16 v195, v59 offset:32768
    s_add_u32 s57, s33, 16
    v_xor_b32 v60, s57, v53
    s_add_u32 m0, s56, 4096
    v_add_u32 v61, 57344, v60
    buffer_load_dwordx4 v8, s[4:7], s61 offen offset:0 lds
    ds_read_u16 v68, v60 offset:0
    ds_read_u16 v196, v60 offset:4096
    ds_read_u16 v69, v60 offset:28672
    ds_read_u16 v197, v60 offset:32768
    ds_read_u16 v70, v61 offset:0
    ds_read_u16 v198, v61 offset:4096
    ds_read_u16 v71, v61 offset:28672
    ds_read_u16 v199, v61 offset:32768
    s_waitcnt lgkmcnt(8)
    v_lshl_or_b32 v64, v192, 16, v64
    v_lshl_or_b32 v65, v193, 16, v65
    v_lshl_or_b32 v66, v194, 16, v66
    buffer_load_dwordx4 v9, s[4:7], s61 offen offset:1024 lds
    v_lshl_or_b32 v67, v195, 16, v67
    s_add_u32 s57, s33, 32
    v_xor_b32 v58, s57, v53
    v_add_u32 v59, 57344, v58
    ds_read_u16 v72, v58 offset:0
    ds_read_u16 v200, v58 offset:4096
    ds_read_u16 v73, v58 offset:28672
    ds_read_u16 v201, v58 offset:32768
    ds_read_u16 v74, v59 offset:0
    ds_read_u16 v202, v59 offset:4096
    ds_read_u16 v75, v59 offset:28672
    ds_read_u16 v203, v59 offset:32768
    s_waitcnt lgkmcnt(8)
    v_lshl_or_b32 v68, v196, 16, v68
    buffer_load_dwordx4 v10, s[4:7], s61 offen offset:2048 lds
    v_lshl_or_b32 v69, v197, 16, v69
    v_lshl_or_b32 v70, v198, 16, v70
    v_lshl_or_b32 v71, v199, 16, v71
    s_add_u32 s57, s33, 48
    v_xor_b32 v60, s57, v53
    v_add_u32 v61, 57344, v60
    ds_read_u16 v76, v60 offset:0
    ds_read_u16 v204, v60 offset:4096
    ds_read_u16 v77, v60 offset:28672
    ds_read_u16 v205, v60 offset:32768
    ds_read_u16 v78, v61 offset:0
    ds_read_u16 v206, v61 offset:4096
    ds_read_u16 v79, v61 offset:28672
    ds_read_u16 v207, v61 offset:32768
    s_waitcnt lgkmcnt(8)
    v_lshl_or_b32 v72, v200, 16, v72
    buffer_load_dwordx4 v11, s[4:7], s61 offen offset:3072 lds
    v_lshl_or_b32 v73, v201, 16, v73
    v_lshl_or_b32 v74, v202, 16, v74
    v_lshl_or_b32 v75, v203, 16, v75
    s_add_u32 s57, s33, 64
    v_xor_b32 v58, s57, v53
    v_add_u32 v59, 57344, v58
    ds_read_u16 v80, v58 offset:0
    ds_read_u16 v208, v58 offset:4096
    ds_read_u16 v81, v58 offset:28672
    ds_read_u16 v209, v58 offset:32768
    ds_read_u16 v82, v59 offset:0
    ds_read_u16 v210, v59 offset:4096
    ds_read_u16 v83, v59 offset:28672
    ds_read_u16 v211, v59 offset:32768
    s_waitcnt lgkmcnt(8)
    v_lshl_or_b32 v76, v204, 16, v76
    s_add_u32 m0, s56, 8192
    v_lshl_or_b32 v77, v205, 16, v77
    buffer_load_dwordx4 v8, s[4:7], s62 offen offset:0 lds
    v_lshl_or_b32 v78, v206, 16, v78
    v_lshl_or_b32 v79, v207, 16, v79
    s_add_u32 s57, s33, 80
    v_xor_b32 v60, s57, v53
    v_add_u32 v61, 57344, v60
    ds_read_u16 v84, v60 offset:0
    ds_read_u16 v212, v60 offset:4096
    ds_read_u16 v85, v60 offset:28672
    ds_read_u16 v213, v60 offset:32768
    ds_read_u16 v86, v61 offset:0
    ds_read_u16 v214, v61 offset:4096
    ds_read_u16 v87, v61 offset:28672
    ds_read_u16 v215, v61 offset:32768
    s_waitcnt lgkmcnt(8)
    v_lshl_or_b32 v80, v208, 16, v80
    buffer_load_dwordx4 v9, s[4:7], s62 offen offset:1024 lds
    v_lshl_or_b32 v81, v209, 16, v81
    v_lshl_or_b32 v82, v210, 16, v82
    v_lshl_or_b32 v83, v211, 16, v83
    s_add_u32 s57, s33, 96
    v_xor_b32 v58, s57, v53
    v_add_u32 v59, 57344, v58
    ds_read_u16 v88, v58 offset:0
    ds_read_u16 v216, v58 offset:4096
    ds_read_u16 v89, v58 offset:28672
    ds_read_u16 v217, v58 offset:32768
    ds_read_u16 v90, v59 offset:0
    ds_read_u16 v218, v59 offset:4096
    ds_read_u16 v91, v59 offset:28672
    ds_read_u16 v219, v59 offset:32768
    s_waitcnt lgkmcnt(8)
    v_lshl_or_b32 v84, v212, 16, v84
    buffer_load_dwordx4 v10, s[4:7], s62 offen offset:2048 lds
    v_lshl_or_b32 v85, v213, 16, v85
    v_lshl_or_b32 v86, v214, 16, v86
    v_lshl_or_b32 v87, v215, 16, v87
    s_waitcnt lgkmcnt(0)
    v_lshl_or_b32 v88, v216, 16, v88
    v_lshl_or_b32 v89, v217, 16, v89
    v_lshl_or_b32 v90, v218, 16, v90
    v_lshl_or_b32 v91, v219, 16, v91
    buffer_load_dwordx4 v11, s[4:7], s62 offen offset:3072 lds
    s_add_u32 m0, s56, 12288
    s_nop 0
    buffer_load_dwordx4 v8, s[4:7], s63 offen offset:0 lds
    buffer_load_dwordx4 v9, s[4:7], s63 offen offset:1024 lds
    buffer_load_dwordx4 v10, s[4:7], s63 offen offset:2048 lds
    buffer_load_dwordx4 v11, s[4:7], s63 offen offset:3072 lds
    s_add_u32 m0, s56, 16384
    s_nop 0
    buffer_load_dwordx4 v8, s[4:7], s64 offen offset:0 lds
    buffer_load_dwordx4 v9, s[4:7], s64 offen offset:1024 lds
    buffer_load_dwordx4 v10, s[4:7], s64 offen offset:2048 lds
    buffer_load_dwordx4 v11, s[4:7], s64 offen offset:3072 lds
    v_mov_b32 v62, 0
    v_mov_b32 v63, 0
    s_cmp_ge_u32 s36, 216
    s_cbranch_scc1 L_nojob2_25
    ds_read_b64_tr_b16 a[0:1], v52 offset:0
    ds_read_b64_tr_b16 a[2:3], v52 offset:5120
    ds_read_b64_tr_b16 a[4:5], v52 offset:128
    ds_read_b64_tr_b16 a[6:7], v52 offset:5248
    ds_read_b64_tr_b16 a[8:9], v52 offset:256
    ds_read_b64_tr_b16 a[10:11], v52 offset:5376
    ds_read_b64_tr_b16 a[12:13], v52 offset:384
    ds_read_b64_tr_b16 a[14:15], v52 offset:5504
    ds_read_b64_tr_b16 a[16:17], v52 offset:512
    ds_read_b64_tr_b16 a[18:19], v52 offset:5632
    ds_read_b64_tr_b16 a[20:21], v52 offset:640
    ds_read_b64_tr_b16 a[22:23], v52 offset:5760
    ds_read_b64_tr_b16 a[24:25], v52 offset:768
    ds_read_b64_tr_b16 a[26:27], v52 offset:5888
    ds_read_b64_tr_b16 a[28:29], v52 offset:896
    ds_read_b64_tr_b16 a[30:31], v52 offset:6016
    ds_read_b64_tr_b16 a[32:33], v52 offset:1024
    ds_read_b64_tr_b16 a[34:35], v52 offset:6144
    ds_read_b64_tr_b16 a[36:37], v52 offset:1152
    ds_read_b64_tr_b16 a[38:39], v52 offset:6272
    s_mov_b32 s57, 271360
    v_and_b32 v1, 15, v0
    v_lshlrev_b32 v1, 4, v1
    v_lshrrev_b32 v2, 4, v0
    v_add_u32 v4, 0, v2
    v_mul_u32_u24 v7, 205, v4
    v_lshrrev_b32 v7, 10, v7
    v_mul_lo_u32 v7, v7, s57
    v_lshl_add_u32 v7, v4, 10, v7
    v_add_u32 v54, v7, v1
    v_add_u32 v4, 4, v2
    v_mul_u32_u24 v7, 205, v4
    v_lshrrev_b32 v7, 10, v7
    v_mul_lo_u32 v7, v7, s57
    v_lshl_add_u32 v7, v4, 10, v7
    v_add_u32 v55, v7, v1
    v_add_u32 v4, 8, v2
    v_mul_u32_u24 v7, 205, v4
    v_lshrrev_b32 v7, 10, v7
    v_mul_lo_u32 v7, v7, s57
    v_lshl_add_u32 v7, v4, 10, v7
    v_add_u32 v56, v7, v1
    v_add_u32 v4, 12, v2
    v_mul_u32_u24 v7, 205, v4
    v_lshrrev_b32 v7, 10, v7
    v_mul_lo_u32 v7, v7, s57
    v_lshl_add_u32 v7, v4, 10, v7
    v_add_u32 v57, v7, v1
    v_add_u32 v4, 16, v2
    v_mul_u32_u24 v7, 205, v4
    s_waitcnt lgkmcnt(0)
    ds_write_b128 v232, a[0:3]
    ds_write_b128 v233, a[4:7]
    ds_write_b128 v234, a[8:11]
    ds_write_b128 v235, a[12:15]
    ds_write_b128 v236, a[16:19]
    ds_write_b128 v237, a[20:23]
    ds_write_b128 v238, a[24:27]
    ds_write_b128 v239, a[28:31]
    ds_write_b128 v240, a[32:35]
    ds_write_b128 v241, a[36:39]
    s_waitcnt lgkmcnt(0)
    ds_read_b128 a[0:3], v49 offset:0
    ds_read_b128 a[4:7], v49 offset:1024
    ds_read_b128 a[8:11], v49 offset:2048
    ds_read_b128 a[12:15], v49 offset:3072
    ds_read_b128 a[16:19], v49 offset:4096
    ds_read_b128 a[20:23], v49 offset:5120
    ds_read_b128 a[24:27], v49 offset:6144
    ds_read_b128 a[28:31], v49 offset:7168
    ds_read_b128 a[32:35], v49 offset:8192
    ds_read_b128 a[36:39], v49 offset:9216
    v_lshrrev_b32 v7, 10, v7
    v_mul_lo_u32 v7, v7, s57
    v_lshl_add_u32 v7, v4, 10, v7
    v_add_u32 v58, v7, v1
    v_add_u32 v4, 20, v2
    v_mul_u32_u24 v7, 205, v4
    v_lshrrev_b32 v7, 10, v7
    v_mul_lo_u32 v7, v7, s57
    v_lshl_add_u32 v7, v4, 10, v7
    v_add_u32 v59, v7, v1
    v_add_u32 v4, 24, v2
    v_mul_u32_u24 v7, 205, v4
    v_lshrrev_b32 v7, 10, v7
    v_mul_lo_u32 v7, v7, s57
    v_lshl_add_u32 v7, v4, 10, v7
    v_add_u32 v60, v7, v1
    v_add_u32 v4, 28, v2
    v_mul_u32_u24 v7, 205, v4
    v_lshrrev_b32 v7, 10, v7
    v_mul_lo_u32 v7, v7, s57
    v_lshl_add_u32 v7, v4, 10, v7
    v_add_u32 v61, v7, v1
    v_add_u32 v4, 32, v2
    v_mul_u32_u24 v7, 205, v4
    v_lshrrev_b32 v7, 10, v7
    v_mul_lo_u32 v7, v7, s57
    v_lshl_add_u32 v7, v4, 10, v7
    v_add_u32 v62, v7, v1
    v_add_u32 v4, 36, v2
    v_mul_u32_u24 v7, 205, v4
    v_lshrrev_b32 v7, 10, v7
    v_mul_lo_u32 v7, v7, s57
    v_lshl_add_u32 v7, v4, 10, v7
    v_add_u32 v63, v7, v1
    s_waitcnt lgkmcnt(0)
L_nojob2_25:
    s_waitcnt vmcnt(0)
    buffer_store_dwordx4 v[64:67], v41, s[8:11], s90 offen sc1
    buffer_store_dwordx4 v[68:71], v42, s[8:11], s90 offen sc1
    buffer_store_dwordx4 v[72:75], v43, s[8:11], s90 offen sc1
    buffer_store_dwordx4 v[76:79], v44, s[8:11], s90 offen sc1
    buffer_store_dwordx4 v[80:83], v45, s[8:11], s90 offen sc1
    buffer_store_dwordx4 v[84:87], v46, s[8:11], s90 offen sc1
    buffer_store_dwordx4 v[88:91], v47, s[8:11], s90 offen sc1
    s_cmp_ge_u32 s36, 216
    s_cbranch_scc1 L_nojob3_26
    buffer_store_dwordx4 a[0:3], v54, s[8:11], s91 offen sc1
    buffer_store_dwordx4 a[4:7], v55, s[8:11], s91 offen sc1
    buffer_store_dwordx4 a[8:11], v56, s[8:11], s91 offen sc1
    buffer_store_dwordx4 a[12:15], v57, s[8:11], s91 offen sc1
    buffer_store_dwordx4 a[16:19], v58, s[8:11], s91 offen sc1
    buffer_store_dwordx4 a[20:23], v59, s[8:11], s91 offen sc1
    buffer_store_dwordx4 a[24:27], v60, s[8:11], s91 offen sc1
    buffer_store_dwordx4 a[28:31], v61, s[8:11], s91 offen sc1
    buffer_store_dwordx4 a[32:35], v62, s[8:11], s91 offen sc1
    buffer_store_dwordx4 a[36:39], v63, s[8:11], s91 offen sc1
L_nojob3_26:
    v_lshrrev_b32 v1, 4, v0
    v_xor_b32 v1, v1, v0
    v_and_b32 v1, 1, v1
    v_cmp_eq_u32 vcc, 0, v1
    v_mov_b32 v2, s87
    s_nop 0
    v_cndmask_b32 v4, 0, v2, vcc
    v_mov_b32 v5, v4
    v_mov_b32 v6, v4
    v_mov_b32 v7, v4
    ds_read_b128 v[96:99], v12 offset:0
    ds_read_b128 v[100:103], v13 offset:0
    ds_read_b128 v[104:107], v14 offset:0
    ds_read_b128 v[108:111], v15 offset:0
    s_waitcnt lgkmcnt(0)
    v_mfma_f32_16x16x32_bf16 a[204:207], v[4:7], v[96:99], 0
    v_mfma_f32_16x16x32_bf16 a[204:207], v[4:7], v[100:103], a[204:207]
    v_mfma_f32_16x16x32_bf16 a[204:207], v[4:7], v[104:107], a[204:207]
    s_add_u32 m0, s56, 0
    s_nop 0
    buffer_load_dwordx4 v8, s[4:7], s65 offen offset:0 lds
    v_mfma_f32_16x16x32_bf16 a[204:207], v[4:7], v[108:111], a[204:207]
    ds_read_b128 v[112:115], v12 offset:4096
    ds_read_b128 v[116:119], v13 offset:4096
    ds_read_b128 v[120:123], v14 offset:4096
    ds_read_b128 v[124:127], v15 offset:4096
    buffer_load_dwordx4 v9, s[4:7], s65 offen offset:1024 lds
    v_dot2c_f32_bf16 v31, v96, v96
    v_dot2c_f32_bf16 v32, v97, v97
    v_dot2c_f32_bf16 v31, v98, v98
    v_dot2c_f32_bf16 v32, v99, v99
    buffer_load_dwordx4 v10, s[4:7], s65 offen offset:2048 lds
    v_dot2c_f32_bf16 v31, v100, v100
    v_dot2c_f32_bf16 v32, v101, v101
    v_dot2c_f32_bf16 v31, v102, v102
    v_dot2c_f32_bf16 v32, v103, v103
    buffer_load_dwordx4 v11, s[4:7], s65 offen offset:3072 lds
    v_dot2c_f32_bf16 v31, v104, v104
    v_dot2c_f32_bf16 v32, v105, v105
    v_dot2c_f32_bf16 v31, v106, v106
    v_dot2c_f32_bf16 v32, v107, v107
    v_dot2c_f32_bf16 v31, v108, v108
    v_dot2c_f32_bf16 v32, v109, v109
    v_dot2c_f32_bf16 v31, v110, v110
    v_dot2c_f32_bf16 v32, v111, v111
    s_waitcnt lgkmcnt(0)
    v_mfma_f32_16x16x32_bf16 a[204:207], v[4:7], v[112:115], a[204:207]
    s_add_u32 m0, s56, 4096
    s_nop 0
    buffer_load_dwordx4 v8, s[4:7], s66 offen offset:0 lds
    v_mfma_f32_16x16x32_bf16 a[204:207], v[4:7], v[116:119], a[204:207]
    v_mfma_f32_16x16x32_bf16 a[204:207], v[4:7], v[120:123], a[204:207]
    buffer_load_dwordx4 v9, s[4:7], s66 offen offset:1024 lds
    v_mfma_f32_16x16x32_bf16 a[204:207], v[4:7], v[124:127], a[204:207]
    ds_read_b128 v[128:131], v12 offset:8192
    ds_read_b128 v[132:135], v13 offset:8192
    ds_read_b128 v[136:139], v14 offset:8192
    ds_read_b128 v[140:143], v15 offset:8192
    buffer_load_dwordx4 v10, s[4:7], s66 offen offset:2048 lds
    v_dot2c_f32_bf16 v31, v112, v112
    v_dot2c_f32_bf16 v32, v113, v113
    v_dot2c_f32_bf16 v31, v114, v114
    v_dot2c_f32_bf16 v32, v115, v115
    buffer_load_dwordx4 v11, s[4:7], s66 offen offset:3072 lds
    v_dot2c_f32_bf16 v31, v116, v116
    v_dot2c_f32_bf16 v32, v117, v117
    v_dot2c_f32_bf16 v31, v118, v118
    v_dot2c_f32_bf16 v32, v119, v119
    v_dot2c_f32_bf16 v31, v120, v120
    v_dot2c_f32_bf16 v32, v121, v121
    v_dot2c_f32_bf16 v31, v122, v122
    v_dot2c_f32_bf16 v32, v123, v123
    v_dot2c_f32_bf16 v31, v124, v124
    v_dot2c_f32_bf16 v32, v125, v125
    v_dot2c_f32_bf16 v31, v126, v126
    v_dot2c_f32_bf16 v32, v127, v127
    s_waitcnt lgkmcnt(0)
    v_mfma_f32_16x16x32_bf16 a[204:207], v[4:7], v[128:131], a[204:207]
    s_add_u32 m0, s56, 8192
    s_nop 0
    buffer_load_dwordx4 v8, s[4:7], s67 offen offset:0 lds
    v_mfma_f32_16x16x32_bf16 a[204:207], v[4:7], v[132:135], a[204:207]
    v_mfma_f32_16x16x32_bf16 a[204:207], v[4:7], v[136:139], a[204:207]
    buffer_load_dwordx4 v9, s[4:7], s67 offen offset:1024 lds
    v_mfma_f32_16x16x32_bf16 a[204:207], v[4:7], v[140:143], a[204:207]
    ds_read_b128 v[144:147], v12 offset:12288
    ds_read_b128 v[148:151], v13 offset:12288
    ds_read_b128 v[152:155], v14 offset:12288
    ds_read_b128 v[156:159], v15 offset:12288
    buffer_load_dwordx4 v10, s[4:7], s67 offen offset:2048 lds
    v_dot2c_f32_bf16 v31, v128, v128
    v_dot2c_f32_bf16 v32, v129, v129
    v_dot2c_f32_bf16 v31, v130, v130
    v_dot2c_f32_bf16 v32, v131, v131
    buffer_load_dwordx4 v11, s[4:7], s67 offen offset:3072 lds
    v_dot2c_f32_bf16 v31, v132, v132
    v_dot2c_f32_bf16 v32, v133, v133
    v_dot2c_f32_bf16 v31, v134, v134
    v_dot2c_f32_bf16 v32, v135, v135
    v_dot2c_f32_bf16 v31, v136, v136
    v_dot2c_f32_bf16 v32, v137, v137
    v_dot2c_f32_bf16 v31, v138, v138
    v_dot2c_f32_bf16 v32, v139, v139
    v_dot2c_f32_bf16 v31, v140, v140
    v_dot2c_f32_bf16 v32, v141, v141
    v_dot2c_f32_bf16 v31, v142, v142
    v_dot2c_f32_bf16 v32, v143, v143
    s_waitcnt lgkmcnt(0)
    v_mfma_f32_16x16x32_bf16 a[204:207], v[4:7], v[144:147], a[204:207]
    s_add_u32 m0, s56, 12288
    s_nop 0
    buffer_load_dwordx4 v8, s[4:7], s68 offen offset:0 lds
    v_mfma_f32_16x16x32_bf16 a[204:207], v[4:7], v[148:151], a[204:207]
    v_mfma_f32_16x16x32_bf16 a[204:207], v[4:7], v[152:155], a[204:207]
    buffer_load_dwordx4 v9, s[4:7], s68 offen offset:1024 lds
    v_mfma_f32_16x16x32_bf16 a[204:207], v[4:7], v[156:159], a[204:207]
    ds_read_b128 v[160:163], v12 offset:16384
    ds_read_b128 v[164:167], v13 offset:16384
    ds_read_b128 v[168:171], v14 offset:16384
    ds_read_b128 v[172:175], v15 offset:16384
    buffer_load_dwordx4 v10, s[4:7], s68 offen offset:2048 lds
    v_dot2c_f32_bf16 v31, v144, v144
    v_dot2c_f32_bf16 v32, v145, v145
    v_dot2c_f32_bf16 v31, v146, v146
    v_dot2c_f32_bf16 v32, v147, v147
    buffer_load_dwordx4 v11, s[4:7], s68 offen offset:3072 lds
    v_dot2c_f32_bf16 v31, v148, v148
    v_dot2c_f32_bf16 v32, v149, v149
    v_dot2c_f32_bf16 v31, v150, v150
    v_dot2c_f32_bf16 v32, v151, v151
    v_dot2c_f32_bf16 v31, v152, v152
    v_dot2c_f32_bf16 v32, v153, v153
    v_dot2c_f32_bf16 v31, v154, v154
    v_dot2c_f32_bf16 v32, v155, v155
    v_dot2c_f32_bf16 v31, v156, v156
    v_dot2c_f32_bf16 v32, v157, v157
    v_dot2c_f32_bf16 v31, v158, v158
    v_dot2c_f32_bf16 v32, v159, v159
    s_waitcnt lgkmcnt(0)
    v_mfma_f32_16x16x32_bf16 a[204:207], v[4:7], v[160:163], a[204:207]
    s_add_u32 m0, s56, 16384
    s_nop 0
    buffer_load_dwordx4 v8, s[4:7], s69 offen offset:0 lds
    v_mfma_f32_16x16x32_bf16 a[204:207], v[4:7], v[164:167], a[204:207]
    v_mfma_f32_16x16x32_bf16 a[204:207], v[4:7], v[168:171], a[204:207]
    buffer_load_dwordx4 v9, s[4:7], s69 offen offset:1024 lds
    v_mfma_f32_16x16x32_bf16 a[204:207], v[4:7], v[172:175], a[204:207]
    s_waitcnt vmcnt(14)
    ds_read_b128 v[176:179], v12 offset:0
    ds_read_b128 v[180:183], v13 offset:0
    ds_read_b128 v[184:187], v14 offset:0
    ds_read_b128 v[188:191], v15 offset:0
    buffer_load_dwordx4 v10, s[4:7], s69 offen offset:2048 lds
    v_dot2c_f32_bf16 v31, v160, v160
    v_dot2c_f32_bf16 v32, v161, v161
    v_dot2c_f32_bf16 v31, v162, v162
    v_dot2c_f32_bf16 v32, v163, v163
    buffer_load_dwordx4 v11, s[4:7], s69 offen offset:3072 lds
    v_dot2c_f32_bf16 v31, v164, v164
    v_dot2c_f32_bf16 v32, v165, v165
    v_dot2c_f32_bf16 v31, v166, v166
    v_dot2c_f32_bf16 v32, v167, v167
    v_dot2c_f32_bf16 v31, v168, v168
    v_dot2c_f32_bf16 v32, v169, v169
    v_dot2c_f32_bf16 v31, v170, v170
    v_dot2c_f32_bf16 v32, v171, v171
    v_dot2c_f32_bf16 v31, v172, v172
    v_dot2c_f32_bf16 v32, v173, v173
    v_dot2c_f32_bf16 v31, v174, v174
    v_dot2c_f32_bf16 v32, v175, v175
    s_barrier
    v_lshlrev_b32 v3, 9, v0
    s_lshl_b32 s98, s94, 2
    s_add_u32 s98, s98, 17829888
    s_mul_i32 s88, s80, 0xff
    s_mov_b32 s89, 0
    v_mov_b32 v36, s55
    s_mov_b64 exec, s[88:89]
    buffer_store_dword v36, v3, s[8:11], s98 offen sc1
    s_mov_b64 exec, -1
    s_waitcnt lgkmcnt(0)
    v_mfma_f32_16x16x32_bf16 a[204:207], v[4:7], v[176:179], a[204:207]
    s_add_u32 m0, s56, 20480
    s_nop 0
    buffer_load_dwordx4 v16, s[12:15], s70 offen lds
    v_mfma_f32_16x16x32_bf16 a[204:207], v[4:7], v[180:183], a[204:207]
    v_mfma_f32_16x16x32_bf16 a[204:207], v[4:7], v[184:187], a[204:207]
    buffer_load_dwordx4 v17, s[12:15], s70 offen offset:1024 lds
    v_mfma_f32_16x16x32_bf16 a[204:207], v[4:7], v[188:191], a[204:207]
    s_waitcnt vmcnt(15)
    ds_read_b128 v[192:195], v12 offset:4096
    ds_read_b128 v[196:199], v13 offset:4096
    ds_read_b128 v[200:203], v14 offset:4096
    ds_read_b128 v[204:207], v15 offset:4096
    s_add_u32 m0, s56, 22528
    s_nop 0
    buffer_load_dwordx4 v16, s[12:15], s71 offen lds
    v_dot2c_f32_bf16 v31, v176, v176
    v_dot2c_f32_bf16 v32, v177, v177
    v_dot2c_f32_bf16 v31, v178, v178
    buffer_load_dwordx4 v17, s[12:15], s71 offen offset:1024 lds
    v_dot2c_f32_bf16 v32, v179, v179
    v_dot2c_f32_bf16 v31, v180, v180
    v_dot2c_f32_bf16 v32, v181, v181
    v_dot2c_f32_bf16 v31, v182, v182
    v_dot2c_f32_bf16 v32, v183, v183
    v_dot2c_f32_bf16 v31, v184, v184
    v_dot2c_f32_bf16 v32, v185, v185
    v_dot2c_f32_bf16 v31, v186, v186
    v_dot2c_f32_bf16 v32, v187, v187
    v_dot2c_f32_bf16 v31, v188, v188
    v_dot2c_f32_bf16 v32, v189, v189
    v_dot2c_f32_bf16 v31, v190, v190
    v_dot2c_f32_bf16 v32, v191, v191
    s_waitcnt lgkmcnt(0)
    v_mfma_f32_16x16x32_bf16 a[204:207], v[4:7], v[192:195], a[204:207]
    s_add_u32 m0, s56, 24576
    s_nop 0
    buffer_load_dwordx4 v16, s[12:15], s72 offen lds
    v_mfma_f32_16x16x32_bf16 a[204:207], v[4:7], v[196:199], a[204:207]
    v_mfma_f32_16x16x32_bf16 a[204:207], v[4:7], v[200:203], a[204:207]
    buffer_load_dwordx4 v17, s[12:15], s72 offen offset:1024 lds
    v_mfma_f32_16x16x32_bf16 a[204:207], v[4:7], v[204:207], a[204:207]
    s_waitcnt vmcnt(15)
    ds_read_b128 v[208:211], v12 offset:8192
    ds_read_b128 v[212:215], v13 offset:8192
    ds_read_b128 v[216:219], v14 offset:8192
    ds_read_b128 v[220:223], v15 offset:8192
    s_add_u32 m0, s56, 26624
    s_nop 0
    buffer_load_dwordx4 v16, s[12:15], s73 offen lds
    v_dot2c_f32_bf16 v31, v192, v192
    v_dot2c_f32_bf16 v32, v193, v193
    v_dot2c_f32_bf16 v31, v194, v194
    buffer_load_dwordx4 v17, s[12:15], s73 offen offset:1024 lds
    v_dot2c_f32_bf16 v32, v195, v195
    v_dot2c_f32_bf16 v31, v196, v196
    v_dot2c_f32_bf16 v32, v197, v197
    v_dot2c_f32_bf16 v31, v198, v198
    v_dot2c_f32_bf16 v32, v199, v199
    v_dot2c_f32_bf16 v31, v200, v200
    v_dot2c_f32_bf16 v32, v201, v201
    v_dot2c_f32_bf16 v31, v202, v202
    v_dot2c_f32_bf16 v32, v203, v203
    v_dot2c_f32_bf16 v31, v204, v204
    v_dot2c_f32_bf16 v32, v205, v205
    v_dot2c_f32_bf16 v31, v206, v206
    v_dot2c_f32_bf16 v32, v207, v207
    s_waitcnt lgkmcnt(0)
    v_mfma_f32_16x16x32_bf16 a[204:207], v[4:7], v[208:211], a[204:207]
    s_add_u32 m0, s56, 0
    s_nop 0
    buffer_load_dwordx4 v16, s[12:15], s74 offen lds
    v_mfma_f32_16x16x32_bf16 a[204:207], v[4:7], v[212:215], a[204:207]
    v_mfma_f32_16x16x32_bf16 a[204:207], v[4:7], v[216:219], a[204:207]
    buffer_load_dwordx4 v17, s[12:15], s74 offen offset:1024 lds
    v_mfma_f32_16x16x32_bf16 a[204:207], v[4:7], v[220:223], a[204:207]
    s_waitcnt vmcnt(15)
    ds_read_b128 v[224:227], v12 offset:12288
    ds_read_b128 v[228:231], v13 offset:12288
    ds_read_b128 v[232:235], v14 offset:12288
    ds_read_b128 v[236:239], v15 offset:12288
    s_add_u32 m0, s56, 2048
    s_nop 0
    buffer_load_dwordx4 v16, s[12:15], s75 offen lds
    v_dot2c_f32_bf16 v31, v208, v208
    v_dot2c_f32_bf16 v32, v209, v209
    v_dot2c_f32_bf16 v31, v210, v210
    buffer_load_dwordx4 v17, s[12:15], s75 offen offset:1024 lds
    v_dot2c_f32_bf16 v32, v211, v211
    v_dot2c_f32_bf16 v31, v212, v212
    v_dot2c_f32_bf16 v32, v213, v213
    v_dot2c_f32_bf16 v31, v214, v214
    v_dot2c_f32_bf16 v32, v215, v215
    v_dot2c_f32_bf16 v31, v216, v216
    v_dot2c_f32_bf16 v32, v217, v217
    v_dot2c_f32_bf16 v31, v218, v218
    v_dot2c_f32_bf16 v32, v219, v219
    v_dot2c_f32_bf16 v31, v220, v220
    v_dot2c_f32_bf16 v32, v221, v221
    v_dot2c_f32_bf16 v31, v222, v222
    v_dot2c_f32_bf16 v32, v223, v223
    s_waitcnt lgkmcnt(0)
    v_mfma_f32_16x16x32_bf16 a[204:207], v[4:7], v[224:227], a[204:207]
    s_add_u32 m0, s56, 4096
    s_nop 0
    buffer_load_dwordx4 v16, s[12:15], s76 offen lds
    v_mfma_f32_16x16x32_bf16 a[204:207], v[4:7], v[228:231], a[204:207]
    v_mfma_f32_16x16x32_bf16 a[204:207], v[4:7], v[232:235], a[204:207]
    buffer_load_dwordx4 v17, s[12:15], s76 offen offset:1024 lds
    v_mfma_f32_16x16x32_bf16 a[204:207], v[4:7], v[236:239], a[204:207]
    s_waitcnt vmcnt(15)
    ds_read_b128 v[240:243], v12 offset:16384
    ds_read_b128 v[244:247], v13 offset:16384
    ds_read_b128 v[248:251], v14 offset:16384
    ds_read_b128 v[252:255], v15 offset:16384
    s_add_u32 m0, s56, 6144
    s_nop 0
    buffer_load_dwordx4 v16, s[12:15], s77 offen lds
    v_dot2c_f32_bf16 v31, v224, v224
    v_dot2c_f32_bf16 v32, v225, v225
    v_dot2c_f32_bf16 v31, v226, v226
    buffer_load_dwordx4 v17, s[12:15], s77 offen offset:1024 lds
    v_dot2c_f32_bf16 v32, v227, v227
    v_dot2c_f32_bf16 v31, v228, v228
    v_dot2c_f32_bf16 v32, v229, v229
    v_dot2c_f32_bf16 v31, v230, v230
    v_dot2c_f32_bf16 v32, v231, v231
    v_dot2c_f32_bf16 v31, v232, v232
    v_dot2c_f32_bf16 v32, v233, v233
    v_dot2c_f32_bf16 v31, v234, v234
    v_dot2c_f32_bf16 v32, v235, v235
    v_dot2c_f32_bf16 v31, v236, v236
    v_dot2c_f32_bf16 v32, v237, v237
    v_dot2c_f32_bf16 v31, v238, v238
    v_dot2c_f32_bf16 v32, v239, v239
    s_waitcnt lgkmcnt(0)
    v_mfma_f32_16x16x32_bf16 a[204:207], v[4:7], v[240:243], a[204:207]
    s_add_u32 m0, s56, 8192
    s_nop 0
    buffer_load_dwordx4 v16, s[12:15], s78 offen lds
    v_mfma_f32_16x16x32_bf16 a[204:207], v[4:7], v[244:247], a[204:207]
    v_mfma_f32_16x16x32_bf16 a[204:207], v[4:7], v[248:251], a[204:207]
    buffer_load_dwordx4 v17, s[12:15], s78 offen offset:1024 lds
    v_mfma_f32_16x16x32_bf16 a[204:207], v[4:7], v[252:255], a[204:207]
    v_dot2c_f32_bf16 v31, v240, v240
    s_add_u32 m0, s56, 10240
    v_dot2c_f32_bf16 v32, v241, v241
    buffer_load_dwordx4 v16, s[12:15], s79 offen lds
    v_dot2c_f32_bf16 v31, v242, v242
    v_dot2c_f32_bf16 v32, v243, v243
    v_dot2c_f32_bf16 v31, v244, v244
    v_dot2c_f32_bf16 v32, v245, v245
    buffer_load_dwordx4 v17, s[12:15], s79 offen offset:1024 lds
    v_dot2c_f32_bf16 v31, v246, v246
    v_dot2c_f32_bf16 v32, v247, v247
    v_dot2c_f32_bf16 v31, v248, v248
    v_dot2c_f32_bf16 v32, v249, v249
    v_dot2c_f32_bf16 v31, v250, v250
    v_dot2c_f32_bf16 v32, v251, v251
    v_dot2c_f32_bf16 v31, v252, v252
    v_dot2c_f32_bf16 v32, v253, v253
    v_dot2c_f32_bf16 v31, v254, v254
    v_dot2c_f32_bf16 v32, v255, v255
    s_nop 2
    v_add_f32 v31, v31, v32
    v_add_u32 v16, 2048, v16
    v_add_u32 v17, 2048, v17
    v_and_b32 v1, 16, v0
    v_cmp_ne_u32 vcc, 0, v1
    s_add_u32 m0, s56, 12288
    v_mov_b32 v32, v31
    buffer_load_dwordx4 v16, s[12:15], s70 offen lds
    v_and_b32 v1, 31, v0
    s_lshl_b32 s57, s50, 7
    v_permlane32_swap_b32 v31, v32
    v_accvgpr_read_b32 v29, a204
    buffer_load_dwordx4 v17, s[12:15], s70 offen offset:1024 lds
    v_accvgpr_read_b32 v30, a205
    v_add_f32 v31, v31, v32
    s_add_u32 m0, s56, 14336
    v_cndmask_b32 v29, v29, v30, vcc
    buffer_load_dwordx4 v16, s[12:15], s71 offen lds
    v_mul_f32 v33, 0xbacccccd, v29
    v_mul_f32 v31, 0x3acccccd, v31
    v_fma_f32 v31, -v33, v33, v31
    v_max_f32 v31, 0, v31
    buffer_load_dwordx4 v17, s[12:15], s71 offen offset:1024 lds
    v_add_f32 v31, 0x3727c5ac, v31
    v_rsq_f32 v34, v31
    s_add_u32 m0, s56, 16384
    s_add_u32 s57, s57, 156672
    buffer_load_dwordx4 v16, s[12:15], s72 offen lds
    v_lshl_add_u32 v1, v1, 2, s57
    ds_write_b32 v1, v34
    v_cvt_pk_bf16_f32 v12, v33, v33
    v_mov_b32 v14, 0
    buffer_load_dwordx4 v17, s[12:15], s72 offen offset:1024 lds
    v_mov_b32 v15, 0
    v_lshlrev_b32 v13, 16, v12
    s_add_u32 m0, s56, 18432
    v_sub_f32 v13, v33, v13
    buffer_load_dwordx4 v16, s[12:15], s73 offen lds
    v_cvt_pk_bf16_f32 v13, v13, v14
    v_cmp_gt_u32 vcc, 32, v0
    s_nop 1
    v_cndmask_b32 v12, 0, v12, vcc
    buffer_load_dwordx4 v17, s[12:15], s73 offen offset:1024 lds
    v_cndmask_b32 v13, 0, v13, vcc
    s_waitcnt vmcnt(24)
    s_barrier
    ds_read_b64_tr_b16 v[40:41], v20 offset:20480
    ds_read_b64_tr_b16 v[42:43], v20 offset:20992
    ds_read_b64_tr_b16 v[44:45], v21 offset:20480
    ds_read_b64_tr_b16 v[46:47], v21 offset:20992
    ds_read_b64_tr_b16 v[48:49], v20 offset:49152
    ds_read_b64_tr_b16 v[50:51], v20 offset:49664
    ds_read_b64_tr_b16 v[52:53], v21 offset:49152
    ds_read_b64_tr_b16 v[54:55], v21 offset:49664
    ds_read_b64_tr_b16 v[56:57], v22 offset:20480
    ds_read_b64_tr_b16 v[58:59], v22 offset:20992
    ds_read_b64_tr_b16 v[60:61], v23 offset:20480
    ds_read_b64_tr_b16 v[62:63], v23 offset:20992
    s_waitcnt lgkmcnt(8)
    v_mfma_f32_32x32x16_bf16 v[64:79], v[40:43], v[96:99], 0
    ds_read_b64_tr_b16 a[196:197], v22 offset:49152
    ds_read_b64_tr_b16 a[198:199], v22 offset:49664
    s_mul_i32 s59, s50, 3
    s_mul_i32 s57, s82, 54
    s_add_u32 s60, s57, s59
    s_lshl_b32 s60, s60, 12
    v_mfma_f32_32x32x16_bf16 v[80:95], v[44:47], v[96:99], 0
    ds_read_b64_tr_b16 a[200:201], v23 offset:49152
    ds_read_b64_tr_b16 a[202:203], v23 offset:49664
    s_add_u32 s60, s60, 7864320
    s_mul_i32 s57, s83, 54
    s_add_u32 s61, s57, s59
    s_mul_i32 s61, s61, 5120
    v_mfma_f32_16x16x32_bf16 a[204:207], v[40:43], v[4:7], 0
    s_add_u32 s61, s61, 14942208
    s_waitcnt lgkmcnt(8)
    v_mfma_f32_32x32x16_bf16 v[64:79], v[48:51], v[100:103], v[64:79]
    ds_read_b64_tr_b16 v[40:41], v20 offset:22528
    ds_read_b64_tr_b16 v[42:43], v20 offset:23040
    s_add_u32 s35, s60, 131072
    s_add_u32 s39, s61, 163840
    s_lshl_b32 s59, s50, 1
    s_add_u32 s59, s59, 12
    v_mfma_f32_32x32x16_bf16 v[80:95], v[52:55], v[100:103], v[80:95]
    ds_read_b64_tr_b16 v[44:45], v21 offset:22528
    ds_read_b64_tr_b16 v[46:47], v21 offset:23040
    s_lshl_b32 s57, s59, 12
    s_add_u32 s32, s60, s57
    s_mul_i32 s57, s59, 5120
    s_add_u32 s36, s61, s57
    v_mfma_f32_16x16x32_bf16 a[204:207], v[48:51], v[4:7], a[204:207]
    s_waitcnt lgkmcnt(8)
    v_mfma_f32_32x32x16_bf16 v[64:79], v[56:59], v[104:107], v[64:79]
    ds_read_b64_tr_b16 v[48:49], v20 offset:51200
    ds_read_b64_tr_b16 v[50:51], v20 offset:51712
    s_cmp_eq_u32 s50, 3
    s_cselect_b32 s59, 11, 12
    s_lshl_b32 s57, s59, 12
    s_add_u32 s33, s35, s57
    v_mfma_f32_32x32x16_bf16 v[80:95], v[60:63], v[104:107], v[80:95]
    ds_read_b64_tr_b16 v[52:53], v21 offset:51200
    ds_read_b64_tr_b16 v[54:55], v21 offset:51712
    s_mul_i32 s57, s59, 5120
    s_add_u32 s37, s39, s57
    s_add_u32 s34, s33, 8192
    s_waitcnt lgkmcnt(8)
    v_mfma_f32_32x32x16_bf16 v[64:79], a[196:199], v[108:111], v[64:79]
    ds_read_b64_tr_b16 v[56:57], v22 offset:22528
    ds_read_b64_tr_b16 v[58:59], v22 offset:23040
    s_add_u32 s38, s37, 10240
    v_mfma_f32_32x32x16_bf16 v[80:95], a[200:203], v[108:111], v[80:95]
    ds_read_b64_tr_b16 v[60:61], v23 offset:22528
    ds_read_b64_tr_b16 v[62:63], v23 offset:23040
    s_waitcnt lgkmcnt(8)
    v_mfma_f32_32x32x16_bf16 v[64:79], v[40:43], v[112:115], v[64:79]
    ds_read_b64_tr_b16 a[196:197], v22 offset:51200
    ds_read_b64_tr_b16 a[198:199], v22 offset:51712
    s_cmp_ge_u32 s50, 2
    s_cselect_b32 s34, s33, s34
    s_cselect_b32 s38, s37, s38
    s_cselect_b32 s18, 0, 18874368
    v_mfma_f32_32x32x16_bf16 v[80:95], v[44:47], v[112:115], v[80:95]
    ds_read_b64_tr_b16 a[200:201], v23 offset:51200
    ds_read_b64_tr_b16 a[202:203], v23 offset:51712
    s_mov_b32 s16, s8
    s_mov_b32 s17, s9
    s_lshr_b32 s57, s50, 1
    s_lshl_b32 s58, s51, 1
    v_mfma_f32_16x16x32_bf16 a[204:207], v[40:43], v[4:7], a[204:207]
    s_add_u32 s57, s57, s58
    s_waitcnt lgkmcnt(8)
    v_mfma_f32_32x32x16_bf16 v[64:79], v[48:51], v[116:119], v[64:79]
    s_waitcnt vmcnt(20)
    s_barrier
    ds_read_b64_tr_b16 v[40:41], v20 offset:24576
    ds_read_b64_tr_b16 v[42:43], v20 offset:25088
    s_mul_i32 s57, s57, 54
    s_lshl_b32 s58, s54, 1
    v_mfma_f32_32x32x16_bf16 v[80:95], v[52:55], v[116:119], v[80:95]
    s_add_u32 m0, s56, 20480
    ds_read_b64_tr_b16 v[44:45], v21 offset:24576
    ds_read_b64_tr_b16 v[46:47], v21 offset:25088
    buffer_load_dwordx4 v16, s[12:15], s74 offen lds
    v_mfma_f32_16x16x32_bf16 a[204:207], v[48:51], v[4:7], a[204:207]
    s_add_u32 s57, s57, s58
    s_waitcnt lgkmcnt(8)
    v_mfma_f32_32x32x16_bf16 v[64:79], v[56:59], v[120:123], v[64:79]
    ds_read_b64_tr_b16 v[48:49], v20 offset:53248
    ds_read_b64_tr_b16 v[50:51], v20 offset:53760
    s_add_u32 s57, s57, 0
    s_and_b32 s58, s50, 1
    s_xor_b32 s58, s58, 0
    s_add_u32 s57, s57, s58
    v_mfma_f32_32x32x16_bf16 v[80:95], v[60:63], v[120:123], v[80:95]
    ds_read_b64_tr_b16 v[52:53], v21 offset:53248
    ds_read_b64_tr_b16 v[54:55], v21 offset:53760
    buffer_load_dwordx4 v17, s[12:15], s74 offen offset:1024 lds
    s_waitcnt lgkmcnt(8)
    v_mfma_f32_32x32x16_bf16 v[64:79], a[196:199], v[124:127], v[64:79]
    ds_read_b64_tr_b16 v[56:57], v22 offset:24576
    ds_read_b64_tr_b16 v[58:59], v22 offset:25088
    s_lshl_b32 s57, s57, 12
    s_add_u32 s90, s57, 7864320
    s_lshl_b32 s57, s51, 5
    s_lshl_b32 s58, s53, 3
    v_mfma_f32_32x32x16_bf16 v[80:95], a[200:203], v[124:127], v[80:95]
    ds_read_b64_tr_b16 v[60:61], v23 offset:24576
    ds_read_b64_tr_b16 v[62:63], v23 offset:25088
    s_add_u32 s57, s57, s58
    s_add_u32 s57, s57, s52
    s_lshl_b32 s57, s57, 2
    s_waitcnt lgkmcnt(8)
    v_mfma_f32_32x32x16_bf16 v[64:79], v[40:43], v[128:131], v[64:79]
    ds_read_b64_tr_b16 a[196:197], v22 offset:53248
    ds_read_b64_tr_b16 a[198:199], v22 offset:53760
    v_mov_b32 v38, s57
    s_xor_b32 s91, s90, 4096
    s_add_u32 s92, s90, 131072
    s_add_u32 s93, s91, 131072
    v_mfma_f32_32x32x16_bf16 v[80:95], v[44:47], v[128:131], v[80:95]
    v_min_u32 v1, 47, v0
    v_lshlrev_b32 v1, 3, v1
    s_and_b32 s42, s2, 7
    s_lshl_b32 s42, s42, 9
    s_add_u32 s42, s42, 17829888
    ds_read_b64_tr_b16 a[200:201], v23 offset:53248
    ds_read_b64_tr_b16 a[202:203], v23 offset:53760
    s_mov_b64 exec, s[0:1]
    buffer_load_dwordx2 v[10:11], v1, s[8:11], s42 offen sc1
    s_mov_b64 exec, -1
    v_mfma_f32_16x16x32_bf16 a[204:207], v[40:43], v[4:7], a[204:207]
    s_waitcnt lgkmcnt(8)
    v_mfma_f32_32x32x16_bf16 v[64:79], v[48:51], v[132:135], v[64:79]
    ds_read_b64_tr_b16 v[40:41], v20 offset:26624
    ds_read_b64_tr_b16 v[42:43], v20 offset:27136
    v_mfma_f32_32x32x16_bf16 v[80:95], v[52:55], v[132:135], v[80:95]
    ds_read_b64_tr_b16 v[44:45], v21 offset:26624
    ds_read_b64_tr_b16 v[46:47], v21 offset:27136
    v_mfma_f32_16x16x32_bf16 a[204:207], v[48:51], v[4:7], a[204:207]
    s_waitcnt lgkmcnt(8)
    v_mfma_f32_32x32x16_bf16 v[64:79], v[56:59], v[136:139], v[64:79]
    ds_read_b64_tr_b16 v[48:49], v20 offset:55296
    ds_read_b64_tr_b16 v[50:51], v20 offset:55808
    v_mfma_f32_32x32x16_bf16 v[80:95], v[60:63], v[136:139], v[80:95]
    ds_read_b64_tr_b16 v[52:53], v21 offset:55296
    ds_read_b64_tr_b16 v[54:55], v21 offset:55808
    s_waitcnt lgkmcnt(8)
    v_mfma_f32_32x32x16_bf16 v[64:79], a[196:199], v[140:143], v[64:79]
    ds_read_b64_tr_b16 v[56:57], v22 offset:26624
    ds_read_b64_tr_b16 v[58:59], v22 offset:27136
    v_mfma_f32_32x32x16_bf16 v[80:95], a[200:203], v[140:143], v[80:95]
    ds_read_b64_tr_b16 v[60:61], v23 offset:26624
    ds_read_b64_tr_b16 v[62:63], v23 offset:27136
    s_waitcnt lgkmcnt(8)
    v_mfma_f32_32x32x16_bf16 v[64:79], v[40:43], v[144:147], v[64:79]
    ds_read_b64_tr_b16 a[196:197], v22 offset:55296
    ds_read_b64_tr_b16 a[198:199], v22 offset:55808
    v_mfma_f32_32x32x16_bf16 v[80:95], v[44:47], v[144:147], v[80:95]
    ds_read_b64_tr_b16 a[200:201], v23 offset:55296
    ds_read_b64_tr_b16 a[202:203], v23 offset:55808
    v_mfma_f32_16x16x32_bf16 a[204:207], v[40:43], v[4:7], a[204:207]
    s_waitcnt lgkmcnt(8)
    v_mfma_f32_32x32x16_bf16 v[64:79], v[48:51], v[148:151], v[64:79]
    s_waitcnt vmcnt(19)
    s_barrier
    ds_read_b64_tr_b16 v[40:41], v20 offset:0
    ds_read_b64_tr_b16 v[42:43], v20 offset:512
    v_mfma_f32_32x32x16_bf16 v[80:95], v[52:55], v[148:151], v[80:95]
    s_add_u32 m0, s56, 22528
    ds_read_b64_tr_b16 v[44:45], v21 offset:0
    ds_read_b64_tr_b16 v[46:47], v21 offset:512
    buffer_load_dwordx4 v16, s[12:15], s75 offen lds
    v_mfma_f32_16x16x32_bf16 a[204:207], v[48:51], v[4:7], a[204:207]
    s_waitcnt lgkmcnt(8)
    v_mfma_f32_32x32x16_bf16 v[64:79], v[56:59], v[152:155], v[64:79]
    ds_read_b64_tr_b16 v[48:49], v20 offset:28672
    ds_read_b64_tr_b16 v[50:51], v20 offset:29184
    v_mfma_f32_32x32x16_bf16 v[80:95], v[60:63], v[152:155], v[80:95]
    ds_read_b64_tr_b16 v[52:53], v21 offset:28672
    ds_read_b64_tr_b16 v[54:55], v21 offset:29184
    buffer_load_dwordx4 v17, s[12:15], s75 offen offset:1024 lds
    s_waitcnt lgkmcnt(8)
    v_mfma_f32_32x32x16_bf16 v[64:79], a[196:199], v[156:159], v[64:79]
    ds_read_b64_tr_b16 v[56:57], v22 offset:0
    ds_read_b64_tr_b16 v[58:59], v22 offset:512
    v_mfma_f32_32x32x16_bf16 v[80:95], a[200:203], v[156:159], v[80:95]
    s_add_u32 m0, s56, 24576
    ds_read_b64_tr_b16 v[60:61], v23 offset:0
    ds_read_b64_tr_b16 v[62:63], v23 offset:512
    buffer_load_dwordx4 v16, s[12:15], s76 offen lds
    s_waitcnt lgkmcnt(8)
    v_mfma_f32_32x32x16_bf16 v[64:79], v[40:43], v[160:163], v[64:79]
    ds_read_b64_tr_b16 a[196:197], v22 offset:28672
    ds_read_b64_tr_b16 a[198:199], v22 offset:29184
    v_mfma_f32_32x32x16_bf16 v[80:95], v[44:47], v[160:163], v[80:95]
    ds_read_b64_tr_b16 a[200:201], v23 offset:28672
    ds_read_b64_tr_b16 a[202:203], v23 offset:29184
    buffer_load_dwordx4 v17, s[12:15], s76 offen offset:1024 lds
    v_mfma_f32_16x16x32_bf16 a[204:207], v[40:43], v[4:7], a[204:207]
    s_waitcnt lgkmcnt(8)
    v_mfma_f32_32x32x16_bf16 v[64:79], v[48:51], v[164:167], v[64:79]
    ds_read_b64_tr_b16 v[40:41], v20 offset:2048
    ds_read_b64_tr_b16 v[42:43], v20 offset:2560
    v_mfma_f32_32x32x16_bf16 v[80:95], v[52:55], v[164:167], v[80:95]
    ds_read_b64_tr_b16 v[44:45], v21 offset:2048
    ds_read_b64_tr_b16 v[46:47], v21 offset:2560
    v_mfma_f32_16x16x32_bf16 a[204:207], v[48:51], v[4:7], a[204:207]
    s_waitcnt lgkmcnt(8)
    v_mfma_f32_32x32x16_bf16 v[64:79], v[56:59], v[168:171], v[64:79]
    ds_read_b64_tr_b16 v[48:49], v20 offset:30720
    ds_read_b64_tr_b16 v[50:51], v20 offset:31232
    v_mfma_f32_32x32x16_bf16 v[80:95], v[60:63], v[168:171], v[80:95]
    ds_read_b64_tr_b16 v[52:53], v21 offset:30720
    ds_read_b64_tr_b16 v[54:55], v21 offset:31232
    s_waitcnt lgkmcnt(8)
    v_mfma_f32_32x32x16_bf16 v[64:79], a[196:199], v[172:175], v[64:79]
    ds_read_b64_tr_b16 v[56:57], v22 offset:2048
    ds_read_b64_tr_b16 v[58:59], v22 offset:2560
    v_mfma_f32_32x32x16_bf16 v[80:95], a[200:203], v[172:175], v[80:95]
    ds_read_b64_tr_b16 v[60:61], v23 offset:2048
    ds_read_b64_tr_b16 v[62:63], v23 offset:2560
    s_waitcnt lgkmcnt(8)
    v_mfma_f32_32x32x16_bf16 v[64:79], v[40:43], v[176:179], v[64:79]
    ds_read_b64_tr_b16 a[196:197], v22 offset:30720
    ds_read_b64_tr_b16 a[198:199], v22 offset:31232
    v_mfma_f32_32x32x16_bf16 v[80:95], v[44:47], v[176:179], v[80:95]
    ds_read_b64_tr_b16 a[200:201], v23 offset:30720
    ds_read_b64_tr_b16 a[202:203], v23 offset:31232
    v_mfma_f32_16x16x32_bf16 a[204:207], v[40:43], v[4:7], a[204:207]
    s_waitcnt lgkmcnt(8)
    v_mfma_f32_32x32x16_bf16 v[64:79], v[48:51], v[180:183], v[64:79]
    s_waitcnt vmcnt(19)
    s_waitcnt vmcnt(4)
    v_cmp_ne_u32 vcc, s55, v10
    v_cmp_ne_u32 s[88:89], s55, v11
    s_nop 0
    s_or_b64 vcc, vcc, s[88:89]
    s_and_b64 vcc, vcc, s[0:1]
    s_cbranch_vccnz L_again_28
L_ok_27:
    s_barrier
    v_lshlrev_b32 v8, 4, v0
    v_add_u32 v9, 4096, v8
    ds_read_b64_tr_b16 v[40:41], v20 offset:4096
    ds_read_b64_tr_b16 v[42:43], v20 offset:4608
    v_mfma_f32_32x32x16_bf16 v[80:95], v[52:55], v[180:183], v[80:95]
    s_add_u32 m0, s56, 26624
    ds_read_b64_tr_b16 v[44:45], v21 offset:4096
    ds_read_b64_tr_b16 v[46:47], v21 offset:4608
    buffer_load_dwordx4 v16, s[12:15], s77 offen lds
    v_mfma_f32_16x16x32_bf16 a[204:207], v[48:51], v[4:7], a[204:207]
    s_waitcnt lgkmcnt(8)
    v_mfma_f32_32x32x16_bf16 v[64:79], v[56:59], v[184:187], v[64:79]
    ds_read_b64_tr_b16 v[48:49], v20 offset:32768
    ds_read_b64_tr_b16 v[50:51], v20 offset:33280
    v_mfma_f32_32x32x16_bf16 v[80:95], v[60:63], v[184:187], v[80:95]
    ds_read_b64_tr_b16 v[52:53], v21 offset:32768
    ds_read_b64_tr_b16 v[54:55], v21 offset:33280
    buffer_load_dwordx4 v17, s[12:15], s77 offen offset:1024 lds
    s_waitcnt lgkmcnt(8)
    v_mfma_f32_32x32x16_bf16 v[64:79], a[196:199], v[188:191], v[64:79]
    ds_read_b64_tr_b16 v[56:57], v22 offset:4096
    ds_read_b64_tr_b16 v[58:59], v22 offset:4608
    v_mfma_f32_32x32x16_bf16 v[80:95], a[200:203], v[188:191], v[80:95]
    s_add_u32 m0, s56, 0
    ds_read_b64_tr_b16 v[60:61], v23 offset:4096
    ds_read_b64_tr_b16 v[62:63], v23 offset:4608
    buffer_load_dwordx4 v16, s[12:15], s78 offen lds
    s_waitcnt lgkmcnt(8)
    v_mfma_f32_32x32x16_bf16 v[64:79], v[40:43], v[192:195], v[64:79]
    ds_read_b64_tr_b16 a[196:197], v22 offset:32768
    ds_read_b64_tr_b16 a[198:199], v22 offset:33280
    v_mfma_f32_32x32x16_bf16 v[80:95], v[44:47], v[192:195], v[80:95]
    ds_read_b64_tr_b16 a[200:201], v23 offset:32768
    ds_read_b64_tr_b16 a[202:203], v23 offset:33280
    buffer_load_dwordx4 v17, s[12:15], s78 offen offset:1024 lds
    v_mfma_f32_16x16x32_bf16 a[204:207], v[40:43], v[4:7], a[204:207]
    s_waitcnt lgkmcnt(8)
    v_mfma_f32_32x32x16_bf16 v[64:79], v[48:51], v[196:199], v[64:79]
    ds_read_b64_tr_b16 v[40:41], v20 offset:6144
    ds_read_b64_tr_b16 v[42:43], v20 offset:6656
    v_mfma_f32_32x32x16_bf16 v[80:95], v[52:55], v[196:199], v[80:95]
    s_add_u32 s99, s36, 0
    ds_read_b64_tr_b16 v[44:45], v21 offset:6144
    ds_read_b64_tr_b16 v[46:47], v21 offset:6656
    buffer_load_dwordx4 a[0:3], v8, s[8:11], s99 offen offset:0 sc1
    v_mfma_f32_16x16x32_bf16 a[204:207], v[48:51], v[4:7], a[204:207]
    s_waitcnt lgkmcnt(8)
    v_mfma_f32_32x32x16_bf16 v[64:79], v[56:59], v[200:203], v[64:79]
    ds_read_b64_tr_b16 v[48:49], v20 offset:34816
    ds_read_b64_tr_b16 v[50:51], v20 offset:35328
    v_mfma_f32_32x32x16_bf16 v[80:95], v[60:63], v[200:203], v[80:95]
    ds_read_b64_tr_b16 v[52:53], v21 offset:34816
    ds_read_b64_tr_b16 v[54:55], v21 offset:35328
    buffer_load_dwordx4 a[4:7], v8, s[8:11], s99 offen offset:1024 sc1
    s_waitcnt lgkmcnt(8)
    v_mfma_f32_32x32x16_bf16 v[64:79], a[196:199], v[204:207], v[64:79]
    ds_read_b64_tr_b16 v[56:57], v22 offset:6144
    ds_read_b64_tr_b16 v[58:59], v22 offset:6656
    v_mfma_f32_32x32x16_bf16 v[80:95], a[200:203], v[204:207], v[80:95]
    ds_read_b64_tr_b16 v[60:61], v23 offset:6144
    ds_read_b64_tr_b16 v[62:63], v23 offset:6656
    buffer_load_dwordx4 a[8:11], v8, s[8:11], s99 offen offset:2048 sc1
    s_waitcnt lgkmcnt(8)
    v_mfma_f32_32x32x16_bf16 v[64:79], v[40:43], v[208:211], v[64:79]
    ds_read_b64_tr_b16 a[196:197], v22 offset:34816
    ds_read_b64_tr_b16 a[198:199], v22 offset:35328
    v_mfma_f32_32x32x16_bf16 v[80:95], v[44:47], v[208:211], v[80:95]
    ds_read_b64_tr_b16 a[200:201], v23 offset:34816
    ds_read_b64_tr_b16 a[202:203], v23 offset:35328
    buffer_load_dwordx4 a[12:15], v8, s[8:11], s99 offen offset:3072 sc1
    v_mfma_f32_16x16x32_bf16 a[204:207], v[40:43], v[4:7], a[204:207]
    s_waitcnt lgkmcnt(8)
    v_mfma_f32_32x32x16_bf16 v[64:79], v[48:51], v[212:215], v[64:79]
    s_barrier
    ds_read_b64_tr_b16 v[40:41], v20 offset:8192
    ds_read_b64_tr_b16 v[42:43], v20 offset:8704
    v_mfma_f32_32x32x16_bf16 v[80:95], v[52:55], v[212:215], v[80:95]
    s_add_u32 m0, s56, 2048
    ds_read_b64_tr_b16 v[44:45], v21 offset:8192
    ds_read_b64_tr_b16 v[46:47], v21 offset:8704
    buffer_load_dwordx4 v16, s[12:15], s79 offen lds
    v_mfma_f32_16x16x32_bf16 a[204:207], v[48:51], v[4:7], a[204:207]
    s_waitcnt lgkmcnt(8)
    v_mfma_f32_32x32x16_bf16 v[64:79], v[56:59], v[216:219], v[64:79]
    ds_read_b64_tr_b16 v[48:49], v20 offset:36864
    ds_read_b64_tr_b16 v[50:51], v20 offset:37376
    v_mfma_f32_32x32x16_bf16 v[80:95], v[60:63], v[216:219], v[80:95]
    ds_read_b64_tr_b16 v[52:53], v21 offset:36864
    ds_read_b64_tr_b16 v[54:55], v21 offset:37376
    buffer_load_dwordx4 v17, s[12:15], s79 offen offset:1024 lds
    s_waitcnt lgkmcnt(8)
    v_mfma_f32_32x32x16_bf16 v[64:79], a[196:199], v[220:223], v[64:79]
    ds_read_b64_tr_b16 v[56:57], v22 offset:8192
    ds_read_b64_tr_b16 v[58:59], v22 offset:8704
    v_mfma_f32_32x32x16_bf16 v[80:95], a[200:203], v[220:223], v[80:95]
    ds_read_b64_tr_b16 v[60:61], v23 offset:8192
    ds_read_b64_tr_b16 v[62:63], v23 offset:8704
    buffer_load_dwordx4 a[16:19], v9, s[8:11], s99 offen offset:0 sc1
    s_waitcnt lgkmcnt(8)
    v_mfma_f32_32x32x16_bf16 v[64:79], v[40:43], v[224:227], v[64:79]
    ds_read_b64_tr_b16 a[196:197], v22 offset:36864
    ds_read_b64_tr_b16 a[198:199], v22 offset:37376
    v_mfma_f32_32x32x16_bf16 v[80:95], v[44:47], v[224:227], v[80:95]
    s_add_u32 s99, s36, 5120
    ds_read_b64_tr_b16 a[200:201], v23 offset:36864
    ds_read_b64_tr_b16 a[202:203], v23 offset:37376
    buffer_load_dwordx4 a[20:23], v8, s[8:11], s99 offen offset:0 sc1
    v_mfma_f32_16x16x32_bf16 a[204:207], v[40:43], v[4:7], a[204:207]
    s_waitcnt lgkmcnt(8)
    v_mfma_f32_32x32x16_bf16 v[64:79], v[48:51], v[228:231], v[64:79]
    ds_read_b64_tr_b16 v[40:41], v20 offset:10240
    ds_read_b64_tr_b16 v[42:43], v20 offset:10752
    v_mfma_f32_32x32x16_bf16 v[80:95], v[52:55], v[228:231], v[80:95]
    ds_read_b64_tr_b16 v[44:45], v21 offset:10240
    ds_read_b64_tr_b16 v[46:47], v21 offset:10752
    buffer_load_dwordx4 a[24:27], v8, s[8:11], s99 offen offset:1024 sc1
    v_mfma_f32_16x16x32_bf16 a[204:207], v[48:51], v[4:7], a[204:207]
    s_waitcnt lgkmcnt(8)
    v_mfma_f32_32x32x16_bf16 v[64:79], v[56:59], v[232:235], v[64:79]
    ds_read_b64_tr_b16 v[48:49], v20 offset:38912
    ds_read_b64_tr_b16 v[50:51], v20 offset:39424
    v_mfma_f32_32x32x16_bf16 v[80:95], v[60:63], v[232:235], v[80:95]
    ds_read_b64_tr_b16 v[52:53], v21 offset:38912
    ds_read_b64_tr_b16 v[54:55], v21 offset:39424
    buffer_load_dwordx4 a[28:31], v8, s[8:11], s99 offen offset:2048 sc1
    s_waitcnt lgkmcnt(8)
    v_mfma_f32_32x32x16_bf16 v[64:79], a[196:199], v[236:239], v[64:79]
    ds_read_b64_tr_b16 v[56:57], v22 offset:10240
    ds_read_b64_tr_b16 v[58:59], v22 offset:10752
    v_mfma_f32_32x32x16_bf16 v[80:95], a[200:203], v[236:239], v[80:95]
    ds_read_b64_tr_b16 v[60:61], v23 offset:10240
    ds_read_b64_tr_b16 v[62:63], v23 offset:10752
    buffer_load_dwordx4 a[32:35], v8, s[8:11], s99 offen offset:3072 sc1
    s_waitcnt lgkmcnt(8)
    v_mfma_f32_32x32x16_bf16 v[64:79], v[40:43], v[240:243], v[64:79]
    ds_read_b64_tr_b16 a[196:197], v22 offset:38912
    ds_read_b64_tr_b16 a[198:199], v22 offset:39424
    v_mfma_f32_32x32x16_bf16 v[80:95], v[44:47], v[240:243], v[80:95]
    ds_read_b64_tr_b16 a[200:201], v23 offset:38912
    ds_read_b64_tr_b16 a[202:203], v23 offset:39424
    buffer_load_dwordx4 a[36:39], v9, s[8:11], s99 offen offset:0 sc1
    v_mfma_f32_16x16x32_bf16 a[204:207], v[40:43], v[4:7], a[204:207]
    s_waitcnt lgkmcnt(8)
    v_mfma_f32_32x32x16_bf16 v[64:79], v[48:51], v[244:247], v[64:79]
    s_barrier
    ds_read_b64_tr_b16 v[40:41], v20 offset:12288
    ds_read_b64_tr_b16 v[42:43], v20 offset:12800
    v_mfma_f32_32x32x16_bf16 v[80:95], v[52:55], v[244:247], v[80:95]
    s_add_u32 s99, s36, 10240
    ds_read_b64_tr_b16 v[44:45], v21 offset:12288
    ds_read_b64_tr_b16 v[46:47], v21 offset:12800
    buffer_load_dwordx4 a[40:43], v8, s[8:11], s99 offen offset:0 sc1
    v_mfma_f32_16x16x32_bf16 a[204:207], v[48:51], v[4:7], a[204:207]
    s_waitcnt lgkmcnt(8)
    v_mfma_f32_32x32x16_bf16 v[64:79], v[56:59], v[248:251], v[64:79]
    ds_read_b64_tr_b16 v[48:49], v20 offset:40960
    ds_read_b64_tr_b16 v[50:51], v20 offset:41472
    v_mfma_f32_32x32x16_bf16 v[80:95], v[60:63], v[248:251], v[80:95]
    ds_read_b64_tr_b16 v[52:53], v21 offset:40960
    ds_read_b64_tr_b16 v[54:55], v21 offset:41472
    buffer_load_dwordx4 a[44:47], v8, s[8:11], s99 offen offset:1024 sc1
    s_waitcnt lgkmcnt(8)
    v_mfma_f32_32x32x16_bf16 v[64:79], a[196:199], v[252:255], v[64:79]
    ds_read_b64_tr_b16 v[56:57], v22 offset:12288
    ds_read_b64_tr_b16 v[58:59], v22 offset:12800
    v_mfma_f32_32x32x16_bf16 v[80:95], a[200:203], v[252:255], v[80:95]
    ds_read_b64_tr_b16 v[60:61], v23 offset:12288
    ds_read_b64_tr_b16 v[62:63], v23 offset:12800
    s_mov_b32 exec_lo, 0x00030003
    s_mov_b32 exec_hi, 0x00030003
    ds_write_b128 v26, a[204:207] offset:0
    s_mov_b64 exec, -1
    buffer_load_dwordx4 a[48:51], v8, s[8:11], s99 offen offset:2048 sc1
    s_waitcnt lgkmcnt(9)
    v_mfma_f32_32x32x16_bf16 a[208:223], v[40:43], v[96:99], 0
    ds_read_b64_tr_b16 a[196:197], v22 offset:40960
    ds_read_b64_tr_b16 a[198:199], v22 offset:41472
    v_mfma_f32_32x32x16_bf16 a[224:239], v[44:47], v[96:99], 0
    ds_read_b64_tr_b16 a[200:201], v23 offset:40960
    ds_read_b64_tr_b16 a[202:203], v23 offset:41472
    buffer_load_dwordx4 a[52:55], v8, s[8:11], s99 offen offset:3072 sc1
    v_mfma_f32_16x16x32_bf16 a[204:207], v[40:43], v[4:7], 0
    s_waitcnt lgkmcnt(9)
    v_mfma_f32_32x32x16_bf16 a[208:223], v[48:51], v[100:103], a[208:223]
    ds_read_b64_tr_b16 v[40:41], v20 offset:14336
    ds_read_b64_tr_b16 v[42:43], v20 offset:14848
    v_mfma_f32_32x32x16_bf16 a[224:239], v[52:55], v[100:103], a[224:239]
    ds_read_b64_tr_b16 v[44:45], v21 offset:14336
    ds_read_b64_tr_b16 v[46:47], v21 offset:14848
    buffer_load_dwordx4 a[56:59], v9, s[8:11], s99 offen offset:0 sc1
    v_mfma_f32_16x16x32_bf16 a[204:207], v[48:51], v[4:7], a[204:207]
    s_waitcnt lgkmcnt(9)
    v_mfma_f32_32x32x16_bf16 a[208:223], v[56:59], v[104:107], a[208:223]
    ds_read_b64_tr_b16 v[48:49], v20 offset:43008
    ds_read_b64_tr_b16 v[50:51], v20 offset:43520
    v_mfma_f32_32x32x16_bf16 a[224:239], v[60:63], v[104:107], a[224:239]
    s_add_u32 s99, s36, 15360
    ds_read_b64_tr_b16 v[52:53], v21 offset:43008
    ds_read_b64_tr_b16 v[54:55], v21 offset:43520
    buffer_load_dwordx4 a[60:63], v8, s[8:11], s99 offen offset:0 sc1
    s_waitcnt lgkmcnt(8)
    v_mfma_f32_32x32x16_bf16 a[208:223], a[196:199], v[108:111], a[208:223]
    ds_read_b64_tr_b16 v[56:57], v22 offset:14336
    ds_read_b64_tr_b16 v[58:59], v22 offset:14848
    v_mfma_f32_32x32x16_bf16 a[224:239], a[200:203], v[108:111], a[224:239]
    ds_read_b64_tr_b16 v[60:61], v23 offset:14336
    ds_read_b64_tr_b16 v[62:63], v23 offset:14848
    buffer_load_dwordx4 a[64:67], v8, s[8:11], s99 offen offset:1024 sc1
    s_waitcnt lgkmcnt(8)
    v_mfma_f32_32x32x16_bf16 a[208:223], v[40:43], v[112:115], a[208:223]
    ds_read_b64_tr_b16 a[196:197], v22 offset:43008
    ds_read_b64_tr_b16 a[198:199], v22 offset:43520
    v_mfma_f32_32x32x16_bf16 a[224:239], v[44:47], v[112:115], a[224:239]
    ds_read_b64_tr_b16 a[200:201], v23 offset:43008
    ds_read_b64_tr_b16 a[202:203], v23 offset:43520
    buffer_load_dwordx4 a[68:71], v8, s[8:11], s99 offen offset:2048 sc1
    v_mfma_f32_16x16x32_bf16 a[204:207], v[40:43], v[4:7], a[204:207]
    s_waitcnt lgkmcnt(8)
    v_mfma_f32_32x32x16_bf16 a[208:223], v[48:51], v[116:119], a[208:223]
    s_barrier
    ds_read_b64_tr_b16 v[40:41], v20 offset:16384
    ds_read_b64_tr_b16 v[42:43], v20 offset:16896
    ds_read2_b32 v[30:31], v27 offset0:0 offset1:64
    ds_read2_b32 v[32:33], v28 offset0:0 offset1:64
    v_mov_b32 v34, 0
    v_mfma_f32_32x32x16_bf16 a[224:239], v[52:55], v[116:119], a[224:239]
    ds_read_b64_tr_b16 v[44:45], v21 offset:16384
    ds_read_b64_tr_b16 v[46:47], v21 offset:16896
    buffer_load_dwordx4 a[72:75], v8, s[8:11], s99 offen offset:3072 sc1
    v_mfma_f32_16x16x32_bf16 a[204:207], v[48:51], v[4:7], a[204:207]
    v_mov_b32 v35, 0
    s_waitcnt lgkmcnt(10)
    v_mfma_f32_32x32x16_bf16 a[208:223], v[56:59], v[120:123], a[208:223]
    ds_read_b64_tr_b16 v[48:49], v20 offset:45056
    ds_read_b64_tr_b16 v[50:51], v20 offset:45568
    s_waitcnt lgkmcnt(4)
    v_add_f32 v30, v30, v31
    v_cvt_pk_bf16_f32 v31, v30, v14
    v_lshlrev_b32 v3, 16, v31
    v_mfma_f32_32x32x16_bf16 a[224:239], v[60:63], v[120:123], a[224:239]
    ds_read_b64_tr_b16 v[52:53], v21 offset:45056
    ds_read_b64_tr_b16 v[54:55], v21 offset:45568
    buffer_load_dwordx4 a[76:79], v9, s[8:11], s99 offen offset:0 sc1
    v_mfma_f32_32x32x16_bf16 a[208:223], a[196:199], v[124:127], a[208:223]
    ds_read_b64_tr_b16 v[56:57], v22 offset:16384
    ds_read_b64_tr_b16 v[58:59], v22 offset:16896
    v_sub_f32 v3, v30, v3
    v_cvt_pk_bf16_f32 v30, v30, v3
    v_add_f32 v32, v32, v33
    v_cvt_pk_bf16_f32 v33, v32, v14
    v_mfma_f32_32x32x16_bf16 a[224:239], a[200:203], v[124:127], a[224:239]
    s_add_u32 s99, s36, 20480
    ds_read_b64_tr_b16 v[60:61], v23 offset:16384
    ds_read_b64_tr_b16 v[62:63], v23 offset:16896
    buffer_load_dwordx4 a[80:83], v8, s[8:11], s99 offen offset:0 sc1
    s_waitcnt lgkmcnt(8)
    v_lshlrev_b32 v3, 16, v33
    v_sub_f32 v3, v32, v3
    v_cvt_pk_bf16_f32 v32, v32, v3
    s_nop 1
    v_mfma_f32_32x32x16_bf16 v[64:79], v[30:33], v[12:15], v[64:79]
    v_mfma_f32_32x32x16_bf16 v[80:95], v[32:35], v[12:15], v[80:95]
    buffer_load_dwordx4 a[84:87], v8, s[8:11], s99 offen offset:1024 sc1
    v_mfma_f32_32x32x16_bf16 a[208:223], v[40:43], v[128:131], a[208:223]
    ds_read_b64_tr_b16 a[196:197], v22 offset:45056
    ds_read_b64_tr_b16 a[198:199], v22 offset:45568
    v_mfma_f32_32x32x16_bf16 a[224:239], v[44:47], v[128:131], a[224:239]
    ds_read_b64_tr_b16 a[200:201], v23 offset:45056
    ds_read_b64_tr_b16 a[202:203], v23 offset:45568
    buffer_load_dwordx4 a[88:91], v8, s[8:11], s99 offen offset:2048 sc1
    v_mfma_f32_16x16x32_bf16 a[204:207], v[40:43], v[4:7], a[204:207]
    s_waitcnt lgkmcnt(8)
    v_mfma_f32_32x32x16_bf16 a[208:223], v[48:51], v[132:135], a[208:223]
    ds_read_b64_tr_b16 v[40:41], v20 offset:18432
    ds_read_b64_tr_b16 v[42:43], v20 offset:18944
    v_cvt_pk_bf16_f32 v64, v64, v65
    v_cvt_pk_bf16_f32 v65, v66, v67
    v_cvt_pk_bf16_f32 v66, v68, v69
    v_cvt_pk_bf16_f32 v67, v70, v71
    v_mfma_f32_32x32x16_bf16 a[224:239], v[52:55], v[132:135], a[224:239]
    ds_read_b64_tr_b16 v[44:45], v21 offset:18432
    ds_read_b64_tr_b16 v[46:47], v21 offset:18944
    buffer_load_dwordx4 a[92:95], v8, s[8:11], s99 offen offset:3072 sc1
    v_mfma_f32_16x16x32_bf16 a[204:207], v[48:51], v[4:7], a[204:207]
    v_pk_max_i16 v64, v64, 0
    s_waitcnt lgkmcnt(8)
    v_mfma_f32_32x32x16_bf16 a[208:223], v[56:59], v[136:139], a[208:223]
    ds_read_b64_tr_b16 v[48:49], v20 offset:47104
    ds_read_b64_tr_b16 v[50:51], v20 offset:47616
    v_pk_max_i16 v65, v65, 0
    v_pk_max_i16 v66, v66, 0
    v_pk_max_i16 v67, v67, 0
    v_cvt_pk_bf16_f32 v68, v72, v73
    v_mfma_f32_32x32x16_bf16 a[224:239], v[60:63], v[136:139], a[224:239]
    ds_read_b64_tr_b16 v[52:53], v21 offset:47104
    ds_read_b64_tr_b16 v[54:55], v21 offset:47616
    buffer_store_dwordx4 v[64:67], v19, s[8:11], s90 offen offset:0 sc1
    s_waitcnt lgkmcnt(8)
    v_mfma_f32_32x32x16_bf16 a[208:223], a[196:199], v[140:143], a[208:223]
    ds_read_b64_tr_b16 v[56:57], v22 offset:18432
    ds_read_b64_tr_b16 v[58:59], v22 offset:18944
    buffer_load_dwordx4 a[96:99], v9, s[8:11], s99 offen offset:0 sc1
    v_mfma_f32_32x32x16_bf16 a[224:239], a[200:203], v[140:143], a[224:239]
    ds_read_b64_tr_b16 v[60:61], v23 offset:18432
    ds_read_b64_tr_b16 v[62:63], v23 offset:18944
    v_cvt_pk_bf16_f32 v69, v74, v75
    v_cvt_pk_bf16_f32 v70, v76, v77
    v_cvt_pk_bf16_f32 v71, v78, v79
    s_waitcnt lgkmcnt(8)
    v_mfma_f32_32x32x16_bf16 a[208:223], v[40:43], v[144:147], a[208:223]
    s_add_u32 s99, s61, 0
    ds_read_b64_tr_b16 a[196:197], v22 offset:47104
    ds_read_b64_tr_b16 a[198:199], v22 offset:47616
    buffer_load_dwordx4 a[100:103], v8, s[8:11], s99 offen offset:0 sc1
    v_mfma_f32_32x32x16_bf16 a[224:239], v[44:47], v[144:147], a[224:239]
    ds_read_b64_tr_b16 a[200:201], v23 offset:47104
    ds_read_b64_tr_b16 a[202:203], v23 offset:47616
    v_pk_max_i16 v68, v68, 0
    v_pk_max_i16 v69, v69, 0
    v_pk_max_i16 v70, v70, 0
    v_pk_max_i16 v71, v71, 0
    v_mfma_f32_16x16x32_bf16 a[204:207], v[40:43], v[4:7], a[204:207]
    v_cvt_pk_bf16_f32 v80, v80, v81
    s_waitcnt lgkmcnt(8)
    v_mfma_f32_32x32x16_bf16 a[208:223], v[48:51], v[148:151], a[208:223]
    s_waitcnt vmcnt(35)
    s_barrier
    ds_read_b64_tr_b16 v[40:41], v20 offset:20480
    ds_read_b64_tr_b16 v[42:43], v20 offset:20992
    buffer_store_dwordx4 v[68:71], v19, s[8:11], s90 offen offset:512 sc1
    v_mfma_f32_32x32x16_bf16 a[224:239], v[52:55], v[148:151], a[224:239]
    ds_read_b64_tr_b16 v[44:45], v21 offset:20480
    ds_read_b64_tr_b16 v[46:47], v21 offset:20992
    buffer_load_dwordx4 a[104:107], v8, s[8:11], s99 offen offset:1024 sc1
    v_mfma_f32_16x16x32_bf16 a[204:207], v[48:51], v[4:7], a[204:207]
    v_cvt_pk_bf16_f32 v81, v82, v83
    s_waitcnt lgkmcnt(8)
    v_mfma_f32_32x32x16_bf16 a[208:223], v[56:59], v[152:155], a[208:223]
    ds_read_b64_tr_b16 v[48:49], v20 offset:49152
    ds_read_b64_tr_b16 v[50:51], v20 offset:49664
    v_cvt_pk_bf16_f32 v82, v84, v85
    v_cvt_pk_bf16_f32 v83, v86, v87
    v_pk_max_i16 v80, v80, 0
    v_pk_max_i16 v81, v81, 0
    v_mfma_f32_32x32x16_bf16 a[224:239], v[60:63], v[152:155], a[224:239]
    ds_read_b64_tr_b16 v[52:53], v21 offset:49152
    ds_read_b64_tr_b16 v[54:55], v21 offset:49664
    buffer_load_dwordx4 a[108:111], v8, s[8:11], s99 offen offset:2048 sc1
    s_waitcnt lgkmcnt(8)
    v_mfma_f32_32x32x16_bf16 a[208:223], a[196:199], v[156:159], a[208:223]
    ds_read_b64_tr_b16 v[56:57], v22 offset:20480
    ds_read_b64_tr_b16 v[58:59], v22 offset:20992
    v_pk_max_i16 v82, v82, 0
    v_pk_max_i16 v83, v83, 0
    v_cvt_pk_bf16_f32 v84, v88, v89
    v_cvt_pk_bf16_f32 v85, v90, v91
    v_mfma_f32_32x32x16_bf16 a[224:239], a[200:203], v[156:159], a[224:239]
    ds_read_b64_tr_b16 v[60:61], v23 offset:20480
    ds_read_b64_tr_b16 v[62:63], v23 offset:20992
    buffer_store_dwordx4 v[80:83], v19, s[8:11], s91 offen offset:0 sc1
    s_waitcnt lgkmcnt(8)
    v_mfma_f32_32x32x16_bf16 a[208:223], v[40:43], v[160:163], a[208:223]
    ds_read_b64_tr_b16 a[196:197], v22 offset:49152
    ds_read_b64_tr_b16 a[198:199], v22 offset:49664
    buffer_load_dwordx4 a[112:115], v8, s[8:11], s99 offen offset:3072 sc1
    v_mfma_f32_32x32x16_bf16 a[224:239], v[44:47], v[160:163], a[224:239]
    ds_read_b64_tr_b16 a[200:201], v23 offset:49152
    ds_read_b64_tr_b16 a[202:203], v23 offset:49664
    v_cvt_pk_bf16_f32 v86, v92, v93
    v_cvt_pk_bf16_f32 v87, v94, v95
    v_pk_max_i16 v84, v84, 0
    v_pk_max_i16 v85, v85, 0
    v_mfma_f32_16x16x32_bf16 a[204:207], v[40:43], v[4:7], a[204:207]
    v_pk_max_i16 v86, v86, 0
    s_waitcnt lgkmcnt(8)
    v_mfma_f32_32x32x16_bf16 a[208:223], v[48:51], v[164:167], a[208:223]
    ds_read_b64_tr_b16 v[40:41], v20 offset:22528
    ds_read_b64_tr_b16 v[42:43], v20 offset:23040
    buffer_load_dwordx4 a[116:119], v9, s[8:11], s99 offen offset:0 sc1
    v_mfma_f32_32x32x16_bf16 a[224:239], v[52:55], v[164:167], a[224:239]
    ds_read_b64_tr_b16 v[44:45], v21 offset:22528
    ds_read_b64_tr_b16 v[46:47], v21 offset:23040
    v_pk_max_i16 v87, v87, 0
    v_mfma_f32_16x16x32_bf16 a[204:207], v[48:51], v[4:7], a[204:207]
    s_waitcnt lgkmcnt(8)
    v_mfma_f32_32x32x16_bf16 a[208:223], v[56:59], v[168:171], a[208:223]
    ds_read_b64_tr_b16 v[48:49], v20 offset:51200
    ds_read_b64_tr_b16 v[50:51], v20 offset:51712
    buffer_store_dwordx4 v[84:87], v19, s[8:11], s91 offen offset:512 sc1
    v_mfma_f32_32x32x16_bf16 a[224:239], v[60:63], v[168:171], a[224:239]
    s_add_u32 s99, s61, 5120
    ds_read_b64_tr_b16 v[52:53], v21 offset:51200
    ds_read_b64_tr_b16 v[54:55], v21 offset:51712
    buffer_load_dwordx4 a[120:123], v8, s[8:11], s99 offen offset:0 sc1
    s_waitcnt lgkmcnt(8)
    v_mfma_f32_32x32x16_bf16 a[208:223], a[196:199], v[172:175], a[208:223]
    ds_read_b64_tr_b16 v[56:57], v22 offset:22528
    ds_read_b64_tr_b16 v[58:59], v22 offset:23040
    v_mfma_f32_32x32x16_bf16 a[224:239], a[200:203], v[172:175], a[224:239]
    ds_read_b64_tr_b16 v[60:61], v23 offset:22528
    ds_read_b64_tr_b16 v[62:63], v23 offset:23040
    buffer_load_dwordx4 a[124:127], v8, s[8:11], s99 offen offset:1024 sc1
    s_waitcnt lgkmcnt(8)
    v_mfma_f32_32x32x16_bf16 a[208:223], v[40:43], v[176:179], a[208:223]
    ds_read_b64_tr_b16 a[196:197], v22 offset:51200
    ds_read_b64_tr_b16 a[198:199], v22 offset:51712
    v_mfma_f32_32x32x16_bf16 a[224:239], v[44:47], v[176:179], a[224:239]
    ds_read_b64_tr_b16 a[200:201], v23 offset:51200
    ds_read_b64_tr_b16 a[202:203], v23 offset:51712
    buffer_load_dwordx4 a[128:131], v8, s[8:11], s99 offen offset:2048 sc1
    v_mfma_f32_16x16x32_bf16 a[204:207], v[40:43], v[4:7], a[204:207]
    s_waitcnt lgkmcnt(8)
    v_mfma_f32_32x32x16_bf16 a[208:223], v[48:51], v[180:183], a[208:223]
    s_waitcnt vmcnt(41)
    s_barrier
    ds_read_b64_tr_b16 v[40:41], v20 offset:24576
    ds_read_b64_tr_b16 v[42:43], v20 offset:25088
    v_mfma_f32_32x32x16_bf16 a[224:239], v[52:55], v[180:183], a[224:239]
    ds_read_b64_tr_b16 v[44:45], v21 offset:24576
    ds_read_b64_tr_b16 v[46:47], v21 offset:25088
    buffer_load_dwordx4 a[132:135], v8, s[8:11], s99 offen offset:3072 sc1
    v_mfma_f32_16x16x32_bf16 a[204:207], v[48:51], v[4:7], a[204:207]
    s_waitcnt lgkmcnt(8)
    v_mfma_f32_32x32x16_bf16 a[208:223], v[56:59], v[184:187], a[208:223]
    ds_read_b64_tr_b16 v[48:49], v20 offset:53248
    ds_read_b64_tr_b16 v[50:51], v20 offset:53760
    v_mfma_f32_32x32x16_bf16 a[224:239], v[60:63], v[184:187], a[224:239]
    ds_read_b64_tr_b16 v[52:53], v21 offset:53248
    ds_read_b64_tr_b16 v[54:55], v21 offset:53760
    buffer_load_dwordx4 a[136:139], v9, s[8:11], s99 offen offset:0 sc1
    s_waitcnt lgkmcnt(8)
    v_mfma_f32_32x32x16_bf16 a[208:223], a[196:199], v[188:191], a[208:223]
    ds_read_b64_tr_b16 v[56:57], v22 offset:24576
    ds_read_b64_tr_b16 v[58:59], v22 offset:25088
    v_mfma_f32_32x32x16_bf16 a[224:239], a[200:203], v[188:191], a[224:239]
    s_add_u32 s99, s61, 10240
    ds_read_b64_tr_b16 v[60:61], v23 offset:24576
    ds_read_b64_tr_b16 v[62:63], v23 offset:25088
    buffer_load_dwordx4 a[140:143], v8, s[8:11], s99 offen offset:0 sc1
    s_waitcnt lgkmcnt(8)
    v_mfma_f32_32x32x16_bf16 a[208:223], v[40:43], v[192:195], a[208:223]
    ds_read_b64_tr_b16 a[196:197], v22 offset:53248
    ds_read_b64_tr_b16 a[198:199], v22 offset:53760
    v_mfma_f32_32x32x16_bf16 a[224:239], v[44:47], v[192:195], a[224:239]
    ds_read_b64_tr_b16 a[200:201], v23 offset:53248
    ds_read_b64_tr_b16 a[202:203], v23 offset:53760
    buffer_load_dwordx4 a[144:147], v8, s[8:11], s99 offen offset:1024 sc1
    v_mfma_f32_16x16x32_bf16 a[204:207], v[40:43], v[4:7], a[204:207]
    s_waitcnt lgkmcnt(8)
    v_mfma_f32_32x32x16_bf16 a[208:223], v[48:51], v[196:199], a[208:223]
    ds_read_b64_tr_b16 v[40:41], v20 offset:26624
    ds_read_b64_tr_b16 v[42:43], v20 offset:27136
    v_mfma_f32_32x32x16_bf16 a[224:239], v[52:55], v[196:199], a[224:239]
    ds_read_b64_tr_b16 v[44:45], v21 offset:26624
    ds_read_b64_tr_b16 v[46:47], v21 offset:27136
    buffer_load_dwordx4 a[148:151], v8, s[8:11], s99 offen offset:2048 sc1
    v_mfma_f32_16x16x32_bf16 a[204:207], v[48:51], v[4:7], a[204:207]
    s_waitcnt lgkmcnt(8)
    v_mfma_f32_32x32x16_bf16 a[208:223], v[56:59], v[200:203], a[208:223]
    ds_read_b64_tr_b16 v[48:49], v20 offset:55296
    ds_read_b64_tr_b16 v[50:51], v20 offset:55808
    v_mfma_f32_32x32x16_bf16 a[224:239], v[60:63], v[200:203], a[224:239]
    ds_read_b64_tr_b16 v[52:53], v21 offset:55296
    ds_read_b64_tr_b16 v[54:55], v21 offset:55808
    buffer_load_dwordx4 a[152:155], v8, s[8:11], s99 offen offset:3072 sc1
    s_waitcnt lgkmcnt(8)
    v_mfma_f32_32x32x16_bf16 a[208:223], a[196:199], v[204:207], a[208:223]
    ds_read_b64_tr_b16 v[56:57], v22 offset:26624
    ds_read_b64_tr_b16 v[58:59], v22 offset:27136
    v_mfma_f32_32x32x16_bf16 a[224:239], a[200:203], v[204:207], a[224:239]
    ds_read_b64_tr_b16 v[60:61], v23 offset:26624
    ds_read_b64_tr_b16 v[62:63], v23 offset:27136
    buffer_load_dwordx4 a[156:159], v9, s[8:11], s99 offen offset:0 sc1
    s_waitcnt lgkmcnt(8)
    v_mfma_f32_32x32x16_bf16 a[208:223], v[40:43], v[208:211], a[208:223]
    ds_read_b64_tr_b16 a[196:197], v22 offset:55296
    ds_read_b64_tr_b16 a[198:199], v22 offset:55808
    v_mfma_f32_32x32x16_bf16 a[224:239], v[44:47], v[208:211], a[224:239]
    s_add_u32 s99, s37, 0
    ds_read_b64_tr_b16 a[200:201], v23 offset:55296
    ds_read_b64_tr_b16 a[202:203], v23 offset:55808
    buffer_load_dwordx4 a[160:163], v8, s[8:11], s99 offen offset:0 sc1
    v_mfma_f32_16x16x32_bf16 a[204:207], v[40:43], v[4:7], a[204:207]
    s_waitcnt lgkmcnt(8)
    v_mfma_f32_32x32x16_bf16 a[208:223], v[48:51], v[212:215], a[208:223]
    s_waitcnt vmcnt(41)
    s_waitcnt vmcnt(11)
    s_barrier
    s_mov_b32 s98, 17838080
    v_mov_b32 v36, s55
    s_mov_b64 exec, s[80:81]
    buffer_store_dword v36, v38, s[8:11], s98 offen sc1
    s_mov_b64 exec, -1
    ds_read_b64_tr_b16 v[40:41], v20 offset:0
    ds_read_b64_tr_b16 v[42:43], v20 offset:512
    v_mfma_f32_32x32x16_bf16 a[224:239], v[52:55], v[212:215], a[224:239]
    ds_read_b64_tr_b16 v[44:45], v21 offset:0
    ds_read_b64_tr_b16 v[46:47], v21 offset:512
    buffer_load_dwordx4 a[164:167], v8, s[8:11], s99 offen offset:1024 sc1
    v_mfma_f32_16x16x32_bf16 a[204:207], v[48:51], v[4:7], a[204:207]
    s_waitcnt lgkmcnt(8)
    v_mfma_f32_32x32x16_bf16 a[208:223], v[56:59], v[216:219], a[208:223]
    ds_read_b64_tr_b16 v[48:49], v20 offset:28672
    ds_read_b64_tr_b16 v[50:51], v20 offset:29184
    v_mfma_f32_32x32x16_bf16 a[224:239], v[60:63], v[216:219], a[224:239]
    ds_read_b64_tr_b16 v[52:53], v21 offset:28672
    ds_read_b64_tr_b16 v[54:55], v21 offset:29184
    buffer_load_dwordx4 a[168:171], v8, s[8:11], s99 offen offset:2048 sc1
    s_waitcnt lgkmcnt(8)
    v_mfma_f32_32x32x16_bf16 a[208:223], a[196:199], v[220:223], a[208:223]
    ds_read_b64_tr_b16 v[56:57], v22 offset:0
    ds_read_b64_tr_b16 v[58:59], v22 offset:512
    v_mfma_f32_32x32x16_bf16 a[224:239], a[200:203], v[220:223], a[224:239]
    ds_read_b64_tr_b16 v[60:61], v23 offset:0
    ds_read_b64_tr_b16 v[62:63], v23 offset:512
    buffer_load_dwordx4 a[172:175], v8, s[8:11], s99 offen offset:3072 sc1
    s_waitcnt lgkmcnt(8)
    v_mfma_f32_32x32x16_bf16 a[208:223], v[40:43], v[224:227], a[208:223]
    ds_read_b64_tr_b16 a[196:197], v22 offset:28672
    ds_read_b64_tr_b16 a[198:199], v22 offset:29184
    v_mfma_f32_32x32x16_bf16 a[224:239], v[44:47], v[224:227], a[224:239]
    ds_read_b64_tr_b16 a[200:201], v23 offset:28672
    ds_read_b64_tr_b16 a[202:203], v23 offset:29184
    buffer_load_dwordx4 a[176:179], v9, s[8:11], s99 offen offset:0 sc1
    v_mfma_f32_16x16x32_bf16 a[204:207], v[40:43], v[4:7], a[204:207]
    s_waitcnt lgkmcnt(8)
    v_mfma_f32_32x32x16_bf16 a[208:223], v[48:51], v[228:231], a[208:223]
    ds_read_b64_tr_b16 v[40:41], v20 offset:2048
    ds_read_b64_tr_b16 v[42:43], v20 offset:2560
    v_mfma_f32_32x32x16_bf16 a[224:239], v[52:55], v[228:231], a[224:239]
    ds_read_b64_tr_b16 v[44:45], v21 offset:2048
    ds_read_b64_tr_b16 v[46:47], v21 offset:2560
    v_mfma_f32_16x16x32_bf16 a[204:207], v[48:51], v[4:7], a[204:207]
    s_waitcnt lgkmcnt(8)
    v_mfma_f32_32x32x16_bf16 a[208:223], v[56:59], v[232:235], a[208:223]
    ds_read_b64_tr_b16 v[48:49], v20 offset:30720
    ds_read_b64_tr_b16 v[50:51], v20 offset:31232
    v_mfma_f32_32x32x16_bf16 a[224:239], v[60:63], v[232:235], a[224:239]
    v_and_b32 v1, 15, v0
    v_lshlrev_b32 v1, 2, v1
    s_lshl_b32 s43, s51, 7
    s_add_u32 s43, s43, 17838080
    ds_read_b64_tr_b16 v[52:53], v21 offset:30720
    ds_read_b64_tr_b16 v[54:55], v21 offset:31232
    s_mov_b64 exec, s[0:1]
    buffer_load_dword v10, v1, s[8:11], s43 offen sc1
    s_mov_b64 exec, -1
    s_waitcnt lgkmcnt(8)
    v_mfma_f32_32x32x16_bf16 a[208:223], a[196:199], v[236:239], a[208:223]
    ds_read_b64_tr_b16 v[56:57], v22 offset:2048
    ds_read_b64_tr_b16 v[58:59], v22 offset:2560
    v_mfma_f32_32x32x16_bf16 a[224:239], a[200:203], v[236:239], a[224:239]
    ds_read_b64_tr_b16 v[60:61], v23 offset:2048
    ds_read_b64_tr_b16 v[62:63], v23 offset:2560
    s_waitcnt lgkmcnt(8)
    v_mfma_f32_32x32x16_bf16 a[208:223], v[40:43], v[240:243], a[208:223]
    ds_read_b64_tr_b16 a[196:197], v22 offset:30720
    ds_read_b64_tr_b16 a[198:199], v22 offset:31232
    v_mfma_f32_32x32x16_bf16 a[224:239], v[44:47], v[240:243], a[224:239]
    ds_read_b64_tr_b16 a[200:201], v23 offset:30720
    ds_read_b64_tr_b16 a[202:203], v23 offset:31232
    v_mfma_f32_16x16x32_bf16 a[204:207], v[40:43], v[4:7], a[204:207]
    s_waitcnt lgkmcnt(8)
    v_mfma_f32_32x32x16_bf16 a[208:223], v[48:51], v[244:247], a[208:223]
    v_mfma_f32_32x32x16_bf16 a[224:239], v[52:55], v[244:247], a[224:239]
    v_mfma_f32_16x16x32_bf16 a[204:207], v[48:51], v[4:7], a[204:207]
    s_waitcnt lgkmcnt(4)
    v_mfma_f32_32x32x16_bf16 a[208:223], v[56:59], v[248:251], a[208:223]
    v_mfma_f32_32x32x16_bf16 a[224:239], v[60:63], v[248:251], a[224:239]
    s_waitcnt lgkmcnt(0)
    v_mfma_f32_32x32x16_bf16 a[208:223], a[196:199], v[252:255], a[208:223]
    v_mfma_f32_32x32x16_bf16 a[224:239], a[200:203], v[252:255], a[224:239]
    s_mov_b32 exec_lo, 0x00030003
    s_mov_b32 exec_hi, 0x00030003
    ds_write_b128 v26, a[204:207] offset:512
    s_mov_b64 exec, -1
    s_waitcnt lgkmcnt(0)
    s_barrier
    ds_read2_b32 v[30:31], v27 offset0:128 offset1:192
    ds_read2_b32 v[32:33], v28 offset0:128 offset1:192
    v_mov_b32 v34, 0
    v_mov_b32 v35, 0
    v_lshlrev_b32 v20, 4, v0
    v_add_u32 v21, 4096, v20
    s_lshl_b32 s57, s50, 10
    v_add_u32 v22, s57, v20
    v_xor_b32 v23, 0x400, v22
    v_xor_b32 v24, 0x800, v22
    v_xor_b32 v25, 0xc00, v22
    s_waitcnt lgkmcnt(0)
    v_add_f32 v30, v30, v31
    v_cvt_pk_bf16_f32 v31, v30, v14
    v_lshlrev_b32 v3, 16, v31
    v_sub_f32 v3, v30, v3
    v_cvt_pk_bf16_f32 v30, v30, v3
    v_add_f32 v32, v32, v33
    v_cvt_pk_bf16_f32 v33, v32, v14
    v_lshlrev_b32 v3, 16, v33
    v_sub_f32 v3, v32, v3
    v_cvt_pk_bf16_f32 v32, v32, v3
    s_nop 1
    v_mfma_f32_32x32x16_bf16 a[208:223], v[30:33], v[12:15], a[208:223]
    v_mfma_f32_32x32x16_bf16 a[224:239], v[32:35], v[12:15], a[224:239]
    s_nop 10
    v_accvgpr_read_b32 v64, a208
    v_accvgpr_read_b32 v65, a209
    v_accvgpr_read_b32 v66, a210
    v_accvgpr_read_b32 v67, a211
    v_accvgpr_read_b32 v68, a212
    v_accvgpr_read_b32 v69, a213
    v_accvgpr_read_b32 v70, a214
    v_accvgpr_read_b32 v71, a215
    v_cvt_pk_bf16_f32 v64, v64, v65
    v_cvt_pk_bf16_f32 v65, v66, v67
    v_cvt_pk_bf16_f32 v66, v68, v69
    v_cvt_pk_bf16_f32 v67, v70, v71
    v_pk_max_i16 v64, v64, 0
    v_pk_max_i16 v65, v65, 0
    v_pk_max_i16 v66, v66, 0
    v_pk_max_i16 v67, v67, 0
    buffer_store_dwordx4 v[64:67], v19, s[8:11], s92 offen offset:0 sc1
    v_accvgpr_read_b32 v72, a216
    v_accvgpr_read_b32 v73, a217
    v_accvgpr_read_b32 v74, a218
    v_accvgpr_read_b32 v75, a219
    v_accvgpr_read_b32 v76, a220
    v_accvgpr_read_b32 v77, a221
    v_accvgpr_read_b32 v78, a222
    v_accvgpr_read_b32 v79, a223
    v_cvt_pk_bf16_f32 v68, v72, v73
    v_cvt_pk_bf16_f32 v69, v74, v75
    v_cvt_pk_bf16_f32 v70, v76, v77
    v_cvt_pk_bf16_f32 v71, v78, v79
    v_pk_max_i16 v68, v68, 0
    v_pk_max_i16 v69, v69, 0
    v_pk_max_i16 v70, v70, 0
    v_pk_max_i16 v71, v71, 0
    buffer_store_dwordx4 v[68:71], v19, s[8:11], s92 offen offset:512 sc1
    v_accvgpr_read_b32 v80, a224
    v_accvgpr_read_b32 v81, a225
    v_accvgpr_read_b32 v82, a226
    v_accvgpr_read_b32 v83, a227
    v_accvgpr_read_b32 v84, a228
    v_accvgpr_read_b32 v85, a229
    v_accvgpr_read_b32 v86, a230
    v_accvgpr_read_b32 v87, a231
    v_cvt_pk_bf16_f32 v80, v80, v81
    v_cvt_pk_bf16_f32 v81, v82, v83
    v_cvt_pk_bf16_f32 v82, v84, v85
    v_cvt_pk_bf16_f32 v83, v86, v87
    v_pk_max_i16 v80, v80, 0
    v_pk_max_i16 v81, v81, 0
    v_pk_max_i16 v82, v82, 0
    v_pk_max_i16 v83, v83, 0
    buffer_store_dwordx4 v[80:83], v19, s[8:11], s93 offen offset:0 sc1
    v_accvgpr_read_b32 v88, a232
    v_accvgpr_read_b32 v89, a233
    v_accvgpr_read_b32 v90, a234
    v_accvgpr_read_b32 v91, a235
    v_accvgpr_read_b32 v92, a236
    v_accvgpr_read_b32 v93, a237
    v_accvgpr_read_b32 v94, a238
    v_accvgpr_read_b32 v95, a239
    v_cvt_pk_bf16_f32 v84, v88, v89
    v_cvt_pk_bf16_f32 v85, v90, v91
    v_cvt_pk_bf16_f32 v86, v92, v93
    v_cvt_pk_bf16_f32 v87, v94, v95
    v_pk_max_i16 v84, v84, 0
    v_pk_max_i16 v85, v85, 0
    v_pk_max_i16 v86, v86, 0
    v_pk_max_i16 v87, v87, 0
    buffer_store_dwordx4 v[84:87], v19, s[8:11], s93 offen offset:512 sc1
    s_waitcnt vmcnt(4)
    v_cmp_ne_u32 vcc, s55, v10
    s_nop 0
    s_and_b64 vcc, vcc, s[0:1]
    s_cbranch_vccnz L_again_31
L_ok_30:
    s_barrier
    v_bfe_u32 v26, v0, 1, 3
    s_add_u32 s47, s32, 0
    v_min_u32 v26, 4, v26
    buffer_load_dwordx4 v[40:43], v22, s[8:11], s47 offen sc1
    v_and_b32 v27, 1, v0
    v_lshlrev_b32 v27, 3, v27
    v_add_lshl_u32 v26, v26, v27, 2
    v_bfe_u32 v37, v0, 1, 2
    v_min_u32 v37, 2, v37
    v_add3_u32 v37, v37, v27, 5
    v_lshlrev_b32 v37, 2, v37
    s_lshl_b32 s42, s51, 7
    s_add_u32 s43, s42, 17842176
    s_add_u32 s42, s42, 17838080
    v_and_b32 v3, 15, v0
    buffer_load_dwordx4 v[44:47], v23, s[8:11], s47 offen sc1
    s_lshr_b32 s44, s50, 1
    s_mul_i32 s95, s83, 80
    v_lshl_add_u32 v4, v3, 1, s95
    v_add_u32 v4, s44, v4
    v_add_u32 v6, 32, v4
    v_add3_u32 v3, v3, 64, s95
    s_movk_i32 s95, 320
    v_cmp_le_u32 vcc, s95, v4
    v_subrev_u32 v7, 640, v4
    s_nop 0
    v_cndmask_b32 v7, v4, v7, vcc
    buffer_load_dwordx4 v[48:51], v24, s[8:11], s47 offen sc1
    v_cvt_f32_i32 v7, v7
    v_mul_f32 v8, 0x3acccccd, v7
    v_cmp_le_u32 vcc, s95, v6
    v_subrev_u32 v7, 640, v6
    s_nop 0
    v_cndmask_b32 v7, v6, v7, vcc
    v_cvt_f32_i32 v7, v7
    v_mul_f32 v9, 0x3acccccd, v7
    v_cmp_le_u32 vcc, s95, v3
    v_subrev_u32 v7, 640, v3
    s_nop 0
    buffer_load_dwordx4 v[52:55], v25, s[8:11], s47 offen sc1
    v_cndmask_b32 v7, v3, v7, vcc
    v_cvt_f32_i32 v7, v7
    v_mul_f32 v10, 0x3acccccd, v7
    v_lshrrev_b32 v4, 4, v0
    v_lshlrev_b32 v4, 2, v4
    s_and_b32 s95, s50, 1
    s_mul_i32 s95, s95, 80
    v_add_u32 v4, s95, v4
    v_cvt_f32_u32 v4, v4
    s_add_u32 s47, s32, 4096
    v_mul_f32 v11, v4, v8
    buffer_load_dwordx4 v[80:83], v22, s[8:11], s47 offen sc1
    v_mul_f32 v12, v4, v9
    v_mul_f32 v13, v4, v10
    v_and_b32 v4, 1, v0
    v_cmp_eq_u32 vcc, s44, v4
    s_nop 1
    v_cndmask_b32 v14, 0, -1, vcc
    buffer_load_dwordx4 v[84:87], v23, s[8:11], s47 offen sc1
    buffer_load_dwordx4 v[88:91], v24, s[8:11], s47 offen sc1
    buffer_load_dwordx4 v[92:95], v25, s[8:11], s47 offen sc1
    s_waitcnt vmcnt(8)
    s_barrier
    s_mov_b32 s98, 17842176
    v_mov_b32 v36, s55
    s_mov_b64 exec, s[80:81]
    buffer_store_dword v36, v38, s[8:11], s98 offen sc1
    s_mov_b64 exec, -1
    s_waitcnt vmcnt(5)
    v_mfma_f32_16x16x32_bf16 v[96:99], v[40:43], a[0:3], 0
    v_mul_f32 v2, 0x41800000, v8
    v_mfma_f32_16x16x32_bf16 v[100:103], v[40:43], a[4:7], 0
    v_cos_f32 v2, v2
    v_mfma_f32_16x16x32_bf16 v[104:107], v[40:43], a[8:11], 0
    v_fmamk_f32 v64, v8, 0x00000000, v11
    v_mfma_f32_16x16x32_bf16 v[108:111], v[40:43], a[12:15], 0
    v_sin_f32 v68, v64
    v_mfma_f32_16x16x32_bf16 v[112:115], v[40:43], a[16:19], 0
    s_add_u32 s47, s32, 8192
    buffer_load_dwordx4 a[240:243], v22, s[8:11], s47 offen sc1
    v_mfma_f32_16x16x32_bf16 v[116:119], v[44:47], a[0:3], 0
    v_cos_f32 v64, v64
    v_mfma_f32_16x16x32_bf16 v[120:123], v[44:47], a[4:7], 0
    v_fmamk_f32 v65, v8, 0x3f800000, v11
    v_mfma_f32_16x16x32_bf16 v[124:127], v[44:47], a[8:11], 0
    buffer_load_dwordx4 a[244:247], v23, s[8:11], s47 offen sc1
    v_mfma_f32_16x16x32_bf16 v[128:131], v[44:47], a[12:15], 0
    v_sin_f32 v69, v65
    v_mfma_f32_16x16x32_bf16 v[132:135], v[44:47], a[16:19], 0
    v_cos_f32 v65, v65
    v_mfma_f32_16x16x32_bf16 v[136:139], v[48:51], a[0:3], 0
    v_fmamk_f32 v66, v8, 0x40000000, v11
    v_mfma_f32_16x16x32_bf16 v[140:143], v[48:51], a[4:7], 0
    buffer_load_dwordx4 a[248:251], v24, s[8:11], s47 offen sc1
    v_mfma_f32_16x16x32_bf16 v[144:147], v[48:51], a[8:11], 0
    v_sin_f32 v70, v66
    v_mfma_f32_16x16x32_bf16 v[148:151], v[48:51], a[12:15], 0
    v_cos_f32 v66, v66
    v_mfma_f32_16x16x32_bf16 v[152:155], v[48:51], a[16:19], 0
    v_fmamk_f32 v67, v8, 0x40400000, v11
    v_mfma_f32_16x16x32_bf16 v[156:159], v[52:55], a[0:3], 0
    buffer_load_dwordx4 a[252:255], v25, s[8:11], s47 offen sc1
    v_mfma_f32_16x16x32_bf16 v[160:163], v[52:55], a[4:7], 0
    v_sin_f32 v71, v67
    v_mfma_f32_16x16x32_bf16 v[164:167], v[52:55], a[8:11], 0
    v_cos_f32 v67, v67
    v_mfma_f32_16x16x32_bf16 v[168:171], v[52:55], a[12:15], 0
    v_add_f32 v2, v2, v2
    v_cvt_pk_bf16_f32 v176, v64, -v68
    v_mfma_f32_16x16x32_bf16 v[172:175], v[52:55], a[16:19], 0
    s_add_u32 s47, s32, 12288
    buffer_load_dwordx4 v[56:59], v22, s[8:11], s47 offen sc1
    s_waitcnt vmcnt(6)
    v_mfma_f32_16x16x32_bf16 v[96:99], v[80:83], a[20:23], v[96:99]
    v_cvt_pk_bf16_f32 v177, v65, -v69
    v_cvt_pk_bf16_f32 v178, v66, -v70
    v_mfma_f32_16x16x32_bf16 v[100:103], v[80:83], a[24:27], v[100:103]
    v_cvt_pk_bf16_f32 v179, v67, -v71
    v_fmamk_f32 v72, v8, 0x41800000, v11
    v_mfma_f32_16x16x32_bf16 v[104:107], v[80:83], a[28:31], v[104:107]
    buffer_load_dwordx4 v[60:63], v23, s[8:11], s47 offen sc1
    v_mfma_f32_16x16x32_bf16 v[108:111], v[80:83], a[32:35], v[108:111]
    v_sin_f32 v76, v72
    v_mfma_f32_16x16x32_bf16 v[112:115], v[80:83], a[36:39], v[112:115]
    v_cos_f32 v72, v72
    v_mfma_f32_16x16x32_bf16 v[116:119], v[84:87], a[20:23], v[116:119]
    v_fmamk_f32 v73, v8, 0x41880000, v11
    v_mfma_f32_16x16x32_bf16 v[120:123], v[84:87], a[24:27], v[120:123]
    buffer_load_dwordx4 v[28:31], v24, s[8:11], s47 offen sc1
    v_mfma_f32_16x16x32_bf16 v[124:127], v[84:87], a[28:31], v[124:127]
    v_sin_f32 v77, v73
    v_mfma_f32_16x16x32_bf16 v[128:131], v[84:87], a[32:35], v[128:131]
    v_cos_f32 v73, v73
    v_mfma_f32_16x16x32_bf16 v[132:135], v[84:87], a[36:39], v[132:135]
    v_fmamk_f32 v74, v8, 0x41900000, v11
    v_mfma_f32_16x16x32_bf16 v[136:139], v[88:91], a[20:23], v[136:139]
    buffer_load_dwordx4 v[32:35], v25, s[8:11], s47 offen sc1
    v_mfma_f32_16x16x32_bf16 v[140:143], v[88:91], a[24:27], v[140:143]
    v_sin_f32 v78, v74
    v_mfma_f32_16x16x32_bf16 v[144:147], v[88:91], a[28:31], v[144:147]
    v_cos_f32 v74, v74
    v_mfma_f32_16x16x32_bf16 v[148:151], v[88:91], a[32:35], v[148:151]
    v_fmamk_f32 v75, v8, 0x41980000, v11
    v_mfma_f32_16x16x32_bf16 v[152:155], v[88:91], a[36:39], v[152:155]
    s_add_u32 s47, s32, 16384
    buffer_load_dwordx4 v[224:227], v22, s[8:11], s47 offen sc1
    v_mfma_f32_16x16x32_bf16 v[156:159], v[92:95], a[20:23], v[156:159]
    v_sin_f32 v79, v75
    v_mfma_f32_16x16x32_bf16 v[160:163], v[92:95], a[24:27], v[160:163]
    v_cos_f32 v75, v75
    v_mfma_f32_16x16x32_bf16 v[164:167], v[92:95], a[28:31], v[164:167]
    buffer_load_dwordx4 v[228:231], v23, s[8:11], s47 offen sc1
    v_mfma_f32_16x16x32_bf16 v[168:171], v[92:95], a[32:35], v[168:171]
    v_cvt_pk_bf16_f32 v180, v72, -v76
    v_cvt_pk_bf16_f32 v181, v73, -v77
    v_mfma_f32_16x16x32_bf16 v[172:175], v[92:95], a[36:39], v[172:175]
    v_cvt_pk_bf16_f32 v182, v74, -v78
    v_cvt_pk_bf16_f32 v183, v75, -v79
    s_waitcnt vmcnt(6)
    v_mfma_f32_16x16x32_bf16 v[96:99], a[240:243], a[40:43], v[96:99]
    v_fma_f32 v64, v2, v72, -v64
    v_fma_f32 v68, v2, v76, -v68
    v_mfma_f32_16x16x32_bf16 v[100:103], a[240:243], a[44:47], v[100:103]
    buffer_load_dwordx4 v[232:235], v24, s[8:11], s47 offen sc1
    v_mfma_f32_16x16x32_bf16 v[104:107], a[240:243], a[48:51], v[104:107]
    v_fma_f32 v65, v2, v73, -v65
    v_fma_f32 v69, v2, v77, -v69
    v_mfma_f32_16x16x32_bf16 v[108:111], a[240:243], a[52:55], v[108:111]
    v_fma_f32 v66, v2, v74, -v66
    v_fma_f32 v70, v2, v78, -v70
    v_mfma_f32_16x16x32_bf16 v[112:115], a[240:243], a[56:59], v[112:115]
    v_fma_f32 v67, v2, v75, -v67
    v_fma_f32 v71, v2, v79, -v71
    v_mfma_f32_16x16x32_bf16 v[116:119], a[244:247], a[40:43], v[116:119]
    buffer_load_dwordx4 v[236:239], v25, s[8:11], s47 offen sc1
    v_mfma_f32_16x16x32_bf16 v[120:123], a[244:247], a[44:47], v[120:123]
    v_cvt_pk_bf16_f32 v184, v64, -v68
    v_cvt_pk_bf16_f32 v185, v65, -v69
    v_mfma_f32_16x16x32_bf16 v[124:127], a[244:247], a[48:51], v[124:127]
    v_cvt_pk_bf16_f32 v186, v66, -v70
    v_cvt_pk_bf16_f32 v187, v67, -v71
    v_mfma_f32_16x16x32_bf16 v[128:131], a[244:247], a[52:55], v[128:131]
    v_fma_f32 v72, v2, v64, -v72
    v_fma_f32 v76, v2, v68, -v76
    v_mfma_f32_16x16x32_bf16 v[132:135], a[244:247], a[56:59], v[132:135]
    s_add_u32 s47, s60, 0
    buffer_load_dwordx4 v[240:243], v22, s[8:11], s47 offen sc1
    v_mfma_f32_16x16x32_bf16 v[136:139], a[248:251], a[40:43], v[136:139]
    v_fma_f32 v73, v2, v65, -v73
    v_fma_f32 v77, v2, v69, -v77
    v_mfma_f32_16x16x32_bf16 v[140:143], a[248:251], a[44:47], v[140:143]
    v_fma_f32 v74, v2, v66, -v74
    v_fma_f32 v78, v2, v70, -v78
    v_mfma_f32_16x16x32_bf16 v[144:147], a[248:251], a[48:51], v[144:147]
    buffer_load_dwordx4 v[244:247], v23, s[8:11], s47 offen sc1
    v_mfma_f32_16x16x32_bf16 v[148:151], a[248:251], a[52:55], v[148:151]
    v_fma_f32 v75, v2, v67, -v75
    v_fma_f32 v79, v2, v71, -v79
    v_mfma_f32_16x16x32_bf16 v[152:155], a[248:251], a[56:59], v[152:155]
    v_cvt_pk_bf16_f32 v188, v72, -v76
    v_cvt_pk_bf16_f32 v189, v73, -v77
    v_mfma_f32_16x16x32_bf16 v[156:159], a[252:255], a[40:43], v[156:159]
    v_cvt_pk_bf16_f32 v190, v74, -v78
    v_cvt_pk_bf16_f32 v191, v75, -v79
    v_mfma_f32_16x16x32_bf16 v[160:163], a[252:255], a[44:47], v[160:163]
    buffer_load_dwordx4 v[248:251], v24, s[8:11], s47 offen sc1
    v_mfma_f32_16x16x32_bf16 v[164:167], a[252:255], a[48:51], v[164:167]
    v_fma_f32 v64, v2, v72, -v64
    v_fma_f32 v68, v2, v76, -v68
    v_mfma_f32_16x16x32_bf16 v[168:171], a[252:255], a[52:55], v[168:171]
    v_fma_f32 v65, v2, v73, -v65
    v_fma_f32 v69, v2, v77, -v69
    v_mfma_f32_16x16x32_bf16 v[172:175], a[252:255], a[56:59], v[172:175]
    v_fma_f32 v66, v2, v74, -v66
    v_fma_f32 v70, v2, v78, -v70
    s_waitcnt vmcnt(7)
    v_mfma_f32_16x16x32_bf16 v[96:99], v[56:59], a[60:63], v[96:99]
    s_mov_b64 exec, s[0:1]
    buffer_load_dword v27, v26, s[8:11], s43 offen sc1
    s_mov_b64 exec, -1
    v_mfma_f32_16x16x32_bf16 v[100:103], v[56:59], a[64:67], v[100:103]
    v_fma_f32 v67, v2, v75, -v67
    v_fma_f32 v71, v2, v79, -v71
    v_mfma_f32_16x16x32_bf16 v[104:107], v[56:59], a[68:71], v[104:107]
    v_cvt_pk_bf16_f32 v192, v64, -v68
    v_cvt_pk_bf16_f32 v193, v65, -v69
    v_mfma_f32_16x16x32_bf16 v[108:111], v[56:59], a[72:75], v[108:111]
    v_cvt_pk_bf16_f32 v194, v66, -v70
    v_cvt_pk_bf16_f32 v195, v67, -v71
    v_mfma_f32_16x16x32_bf16 v[112:115], v[56:59], a[76:79], v[112:115]
    buffer_load_dwordx4 v[252:255], v25, s[8:11], s47 offen sc1
    v_mfma_f32_16x16x32_bf16 v[116:119], v[60:63], a[60:63], v[116:119]
    v_mul_f32 v2, 0x41800000, v9
    v_mfma_f32_16x16x32_bf16 v[120:123], v[60:63], a[64:67], v[120:123]
    v_cos_f32 v2, v2
    v_mfma_f32_16x16x32_bf16 v[124:127], v[60:63], a[68:71], v[124:127]
    v_fmamk_f32 v64, v9, 0x00000000, v12
    v_mfma_f32_16x16x32_bf16 v[128:131], v[60:63], a[72:75], v[128:131]
    s_add_u32 s47, s60, 4096
    buffer_load_dwordx4 v[40:43], v22, s[8:11], s47 offen sc1
    v_mfma_f32_16x16x32_bf16 v[132:135], v[60:63], a[76:79], v[132:135]
    v_sin_f32 v68, v64
    v_mfma_f32_16x16x32_bf16 v[136:139], v[28:31], a[60:63], v[136:139]
    v_cos_f32 v64, v64
    v_mfma_f32_16x16x32_bf16 v[140:143], v[28:31], a[64:67], v[140:143]
    buffer_load_dwordx4 v[44:47], v23, s[8:11], s47 offen sc1
    v_mfma_f32_16x16x32_bf16 v[144:147], v[28:31], a[68:71], v[144:147]
    v_fmamk_f32 v65, v9, 0x3f800000, v12
    v_mfma_f32_16x16x32_bf16 v[148:151], v[28:31], a[72:75], v[148:151]
    v_sin_f32 v69, v65
    v_mfma_f32_16x16x32_bf16 v[152:155], v[28:31], a[76:79], v[152:155]
    v_cos_f32 v65, v65
    v_mfma_f32_16x16x32_bf16 v[156:159], v[32:35], a[60:63], v[156:159]
    buffer_load_dwordx4 v[48:51], v24, s[8:11], s47 offen sc1
    v_mfma_f32_16x16x32_bf16 v[160:163], v[32:35], a[64:67], v[160:163]
    v_fmamk_f32 v66, v9, 0x40000000, v12
    v_mfma_f32_16x16x32_bf16 v[164:167], v[32:35], a[68:71], v[164:167]
    v_sin_f32 v70, v66
    v_mfma_f32_16x16x32_bf16 v[168:171], v[32:35], a[72:75], v[168:171]
    v_cos_f32 v66, v66
    v_mfma_f32_16x16x32_bf16 v[172:175], v[32:35], a[76:79], v[172:175]
    buffer_load_dwordx4 v[52:55], v25, s[8:11], s47 offen sc1
    s_waitcnt vmcnt(9)
    v_mfma_f32_16x16x32_bf16 v[96:99], v[224:227], a[80:83], v[96:99]
    v_fmamk_f32 v67, v9, 0x40400000, v12
    v_mfma_f32_16x16x32_bf16 v[100:103], v[224:227], a[84:87], v[100:103]
    v_sin_f32 v71, v67
    v_mfma_f32_16x16x32_bf16 v[104:107], v[224:227], a[88:91], v[104:107]
    v_cos_f32 v67, v67
    v_mfma_f32_16x16x32_bf16 v[108:111], v[224:227], a[92:95], v[108:111]
    s_add_u32 s47, s60, 8192
    buffer_load_dwordx4 v[80:83], v22, s[8:11], s47 offen sc1
    v_mfma_f32_16x16x32_bf16 v[112:115], v[224:227], a[96:99], v[112:115]
    v_add_f32 v2, v2, v2
    v_cvt_pk_bf16_f32 v196, v64, -v68
    v_mfma_f32_16x16x32_bf16 v[116:119], v[228:231], a[80:83], v[116:119]
    v_cvt_pk_bf16_f32 v197, v65, -v69
    v_cvt_pk_bf16_f32 v198, v66, -v70
    v_mfma_f32_16x16x32_bf16 v[120:123], v[228:231], a[84:87], v[120:123]
    buffer_load_dwordx4 v[84:87], v23, s[8:11], s47 offen sc1
    v_mfma_f32_16x16x32_bf16 v[124:127], v[228:231], a[88:91], v[124:127]
    v_cvt_pk_bf16_f32 v199, v67, -v71
    v_fmamk_f32 v72, v9, 0x41800000, v12
    v_mfma_f32_16x16x32_bf16 v[128:131], v[228:231], a[92:95], v[128:131]
    v_sin_f32 v76, v72
    v_mfma_f32_16x16x32_bf16 v[132:135], v[228:231], a[96:99], v[132:135]
    v_cos_f32 v72, v72
    v_mfma_f32_16x16x32_bf16 v[136:139], v[232:235], a[80:83], v[136:139]
    buffer_load_dwordx4 v[88:91], v24, s[8:11], s47 offen sc1
    v_mfma_f32_16x16x32_bf16 v[140:143], v[232:235], a[84:87], v[140:143]
    v_fmamk_f32 v73, v9, 0x41880000, v12
    v_mfma_f32_16x16x32_bf16 v[144:147], v[232:235], a[88:91], v[144:147]
    v_sin_f32 v77, v73
    v_mfma_f32_16x16x32_bf16 v[148:151], v[232:235], a[92:95], v[148:151]
    v_cos_f32 v73, v73
    v_mfma_f32_16x16x32_bf16 v[152:155], v[232:235], a[96:99], v[152:155]
    buffer_load_dwordx4 v[92:95], v25, s[8:11], s47 offen sc1
    v_mfma_f32_16x16x32_bf16 v[156:159], v[236:239], a[80:83], v[156:159]
    v_fmamk_f32 v74, v9, 0x41900000, v12
    v_mfma_f32_16x16x32_bf16 v[160:163], v[236:239], a[84:87], v[160:163]
    v_sin_f32 v78, v74
    v_mfma_f32_16x16x32_bf16 v[164:167], v[236:239], a[88:91], v[164:167]
    v_cos_f32 v74, v74
    v_mfma_f32_16x16x32_bf16 v[168:171], v[236:239], a[92:95], v[168:171]
    s_add_u32 s99, s37, 5120
    buffer_load_dwordx4 a[180:183], v20, s[8:11], s99 offen offset:0 sc1
    v_mfma_f32_16x16x32_bf16 v[172:175], v[236:239], a[96:99], v[172:175]
    v_fmamk_f32 v75, v9, 0x41980000, v12
    s_waitcnt vmcnt(10)
    v_cmp_ne_u32 vcc, s55, v27
    s_nop 0
    s_and_b64 vcc, vcc, s[0:1]
    s_cbranch_vccnz L_again_34
L_ok_33:
    s_barrier
    s_waitcnt vmcnt(9)
    v_mfma_f32_16x16x32_bf16 v[96:99], v[240:243], a[100:103], v[96:99]
    v_sin_f32 v79, v75
    v_mfma_f32_16x16x32_bf16 v[100:103], v[240:243], a[104:107], v[100:103]
    s_add_u32 s47, s33, 0
    buffer_load_dwordx4 a[240:243], v22, s[8:11], s47 offen sc1
    v_mfma_f32_16x16x32_bf16 v[104:107], v[240:243], a[108:111], v[104:107]
    v_cos_f32 v75, v75
    v_mfma_f32_16x16x32_bf16 v[108:111], v[240:243], a[112:115], v[108:111]
    v_cvt_pk_bf16_f32 v200, v72, -v76
    v_cvt_pk_bf16_f32 v201, v73, -v77
    v_mfma_f32_16x16x32_bf16 v[112:115], v[240:243], a[116:119], v[112:115]
    buffer_load_dwordx4 a[244:247], v23, s[8:11], s47 offen sc1
    v_mfma_f32_16x16x32_bf16 v[116:119], v[244:247], a[100:103], v[116:119]
    v_cvt_pk_bf16_f32 v202, v74, -v78
    v_cvt_pk_bf16_f32 v203, v75, -v79
    v_mfma_f32_16x16x32_bf16 v[120:123], v[244:247], a[104:107], v[120:123]
    v_fma_f32 v64, v2, v72, -v64
    v_fma_f32 v68, v2, v76, -v68
    v_mfma_f32_16x16x32_bf16 v[124:127], v[244:247], a[108:111], v[124:127]
    v_fma_f32 v65, v2, v73, -v65
    v_fma_f32 v69, v2, v77, -v69
    v_mfma_f32_16x16x32_bf16 v[128:131], v[244:247], a[112:115], v[128:131]
    buffer_load_dwordx4 a[248:251], v24, s[8:11], s47 offen sc1
    v_mfma_f32_16x16x32_bf16 v[132:135], v[244:247], a[116:119], v[132:135]
    v_fma_f32 v66, v2, v74, -v66
    v_fma_f32 v70, v2, v78, -v70
    v_mfma_f32_16x16x32_bf16 v[136:139], v[248:251], a[100:103], v[136:139]
    v_fma_f32 v67, v2, v75, -v67
    v_fma_f32 v71, v2, v79, -v71
    v_mfma_f32_16x16x32_bf16 v[140:143], v[248:251], a[104:107], v[140:143]
    v_cvt_pk_bf16_f32 v204, v64, -v68
    v_cvt_pk_bf16_f32 v205, v65, -v69
    v_mfma_f32_16x16x32_bf16 v[144:147], v[248:251], a[108:111], v[144:147]
    buffer_load_dwordx4 a[252:255], v25, s[8:11], s47 offen sc1
    v_mfma_f32_16x16x32_bf16 v[148:151], v[248:251], a[112:115], v[148:151]
    v_cvt_pk_bf16_f32 v206, v66, -v70
    v_cvt_pk_bf16_f32 v207, v67, -v71
    v_mfma_f32_16x16x32_bf16 v[152:155], v[248:251], a[116:119], v[152:155]
    v_fma_f32 v72, v2, v64, -v72
    v_fma_f32 v76, v2, v68, -v76
    v_mfma_f32_16x16x32_bf16 v[156:159], v[252:255], a[100:103], v[156:159]
    v_fma_f32 v73, v2, v65, -v73
    v_fma_f32 v77, v2, v69, -v77
    v_mfma_f32_16x16x32_bf16 v[160:163], v[252:255], a[104:107], v[160:163]
    s_add_u32 s47, s33, 4096
    buffer_load_dwordx4 v[56:59], v22, s[8:11], s47 offen sc1
    v_mfma_f32_16x16x32_bf16 v[164:167], v[252:255], a[108:111], v[164:167]
    v_fma_f32 v74, v2, v66, -v74
    v_fma_f32 v78, v2, v70, -v78
    v_mfma_f32_16x16x32_bf16 v[168:171], v[252:255], a[112:115], v[168:171]
    v_fma_f32 v75, v2, v67, -v75
    v_fma_f32 v79, v2, v71, -v79
    v_mfma_f32_16x16x32_bf16 v[172:175], v[252:255], a[116:119], v[172:175]
    buffer_load_dwordx4 v[60:63], v23, s[8:11], s47 offen sc1
    s_waitcnt vmcnt(11)
    v_mfma_f32_16x16x32_bf16 v[96:99], v[40:43], a[120:123], v[96:99]
    v_cvt_pk_bf16_f32 v208, v72, -v76
    v_cvt_pk_bf16_f32 v209, v73, -v77
    v_mfma_f32_16x16x32_bf16 v[100:103], v[40:43], a[124:127], v[100:103]
    v_cvt_pk_bf16_f32 v210, v74, -v78
    v_cvt_pk_bf16_f32 v211, v75, -v79
    v_mfma_f32_16x16x32_bf16 v[104:107], v[40:43], a[128:131], v[104:107]
    v_fma_f32 v64, v2, v72, -v64
    v_fma_f32 v68, v2, v76, -v68
    v_mfma_f32_16x16x32_bf16 v[108:111], v[40:43], a[132:135], v[108:111]
    s_mov_b64 exec, s[0:1]
    buffer_load_dword v15, v37, s[8:11], s43 offen sc1
    s_mov_b64 exec, -1
    v_mfma_f32_16x16x32_bf16 v[112:115], v[40:43], a[136:139], v[112:115]
    v_fma_f32 v65, v2, v73, -v65
    v_fma_f32 v69, v2, v77, -v69
    v_mfma_f32_16x16x32_bf16 v[116:119], v[44:47], a[120:123], v[116:119]
    v_fma_f32 v66, v2, v74, -v66
    v_fma_f32 v70, v2, v78, -v70
    v_mfma_f32_16x16x32_bf16 v[120:123], v[44:47], a[124:127], v[120:123]
    v_fma_f32 v67, v2, v75, -v67
    v_fma_f32 v71, v2, v79, -v71
    v_mfma_f32_16x16x32_bf16 v[124:127], v[44:47], a[128:131], v[124:127]
    buffer_load_dwordx4 v[28:31], v24, s[8:11], s47 offen sc1
    v_mfma_f32_16x16x32_bf16 v[128:131], v[44:47], a[132:135], v[128:131]
    v_cvt_pk_bf16_f32 v212, v64, -v68
    v_cvt_pk_bf16_f32 v213, v65, -v69
    v_mfma_f32_16x16x32_bf16 v[132:135], v[44:47], a[136:139], v[132:135]
    v_cvt_pk_bf16_f32 v214, v66, -v70
    v_cvt_pk_bf16_f32 v215, v67, -v71
    v_mfma_f32_16x16x32_bf16 v[136:139], v[48:51], a[120:123], v[136:139]
    v_mul_f32 v2, 0x41800000, v10
    v_mfma_f32_16x16x32_bf16 v[140:143], v[48:51], a[124:127], v[140:143]
    buffer_load_dwordx4 v[32:35], v25, s[8:11], s47 offen sc1
    v_mfma_f32_16x16x32_bf16 v[144:147], v[48:51], a[128:131], v[144:147]
    v_cos_f32 v2, v2
    v_mfma_f32_16x16x32_bf16 v[148:151], v[48:51], a[132:135], v[148:151]
    v_fmamk_f32 v64, v10, 0x00000000, v13
    v_mfma_f32_16x16x32_bf16 v[152:155], v[48:51], a[136:139], v[152:155]
    v_sin_f32 v68, v64
    v_mfma_f32_16x16x32_bf16 v[156:159], v[52:55], a[120:123], v[156:159]
    s_mov_b32 s47, s34
    buffer_load_dwordx4 a[40:43], v22, s[16:19], s47 offen sc1
    v_mfma_f32_16x16x32_bf16 v[160:163], v[52:55], a[124:127], v[160:163]
    v_cos_f32 v64, v64
    v_mfma_f32_16x16x32_bf16 v[164:167], v[52:55], a[128:131], v[164:167]
    v_fmamk_f32 v65, v10, 0x3f800000, v13
    v_mfma_f32_16x16x32_bf16 v[168:171], v[52:55], a[132:135], v[168:171]
    buffer_load_dwordx4 a[44:47], v23, s[16:19], s47 offen sc1
    v_mfma_f32_16x16x32_bf16 v[172:175], v[52:55], a[136:139], v[172:175]
    v_sin_f32 v69, v65
    s_waitcnt vmcnt(12)
    v_mfma_f32_16x16x32_bf16 v[96:99], v[80:83], a[140:143], v[96:99]
    v_cos_f32 v65, v65
    v_mfma_f32_16x16x32_bf16 v[100:103], v[80:83], a[144:147], v[100:103]
    v_fmamk_f32 v66, v10, 0x40000000, v13
    v_mfma_f32_16x16x32_bf16 v[104:107], v[80:83], a[148:151], v[104:107]
    buffer_load_dwordx4 a[48:51], v24, s[16:19], s47 offen sc1
    v_mfma_f32_16x16x32_bf16 v[108:111], v[80:83], a[152:155], v[108:111]
    v_sin_f32 v70, v66
    v_mfma_f32_16x16x32_bf16 v[112:115], v[80:83], a[156:159], v[112:115]
    v_cos_f32 v66, v66
    v_mfma_f32_16x16x32_bf16 v[116:119], v[84:87], a[140:143], v[116:119]
    v_fmamk_f32 v67, v10, 0x40400000, v13
    v_mfma_f32_16x16x32_bf16 v[120:123], v[84:87], a[144:147], v[120:123]
    buffer_load_dwordx4 a[52:55], v25, s[16:19], s47 offen sc1
    v_mfma_f32_16x16x32_bf16 v[124:127], v[84:87], a[148:151], v[124:127]
    v_sin_f32 v71, v67
    v_mfma_f32_16x16x32_bf16 v[128:131], v[84:87], a[152:155], v[128:131]
    v_cos_f32 v67, v67
    v_mfma_f32_16x16x32_bf16 v[132:135], v[84:87], a[156:159], v[132:135]
    v_add_f32 v2, v2, v2
    v_cvt_pk_bf16_f32 v216, v64, -v68
    v_mfma_f32_16x16x32_bf16 v[136:139], v[88:91], a[140:143], v[136:139]
    buffer_load_dwordx4 a[184:187], v20, s[8:11], s99 offen offset:1024 sc1
    v_mfma_f32_16x16x32_bf16 v[140:143], v[88:91], a[144:147], v[140:143]
    v_cvt_pk_bf16_f32 v217, v65, -v69
    v_cvt_pk_bf16_f32 v218, v66, -v70
    v_mfma_f32_16x16x32_bf16 v[144:147], v[88:91], a[148:151], v[144:147]
    v_cvt_pk_bf16_f32 v219, v67, -v71
    v_and_b32 v216, v14, v216
    v_mfma_f32_16x16x32_bf16 v[148:151], v[88:91], a[152:155], v[148:151]
    v_and_b32 v217, v14, v217
    v_and_b32 v218, v14, v218
    v_mfma_f32_16x16x32_bf16 v[152:155], v[88:91], a[156:159], v[152:155]
    buffer_load_dwordx4 a[188:191], v20, s[8:11], s99 offen offset:2048 sc1
    v_mfma_f32_16x16x32_bf16 v[156:159], v[92:95], a[140:143], v[156:159]
    v_and_b32 v219, v14, v219
    v_fmamk_f32 v72, v10, 0x41800000, v13
    v_mfma_f32_16x16x32_bf16 v[160:163], v[92:95], a[144:147], v[160:163]
    v_sin_f32 v76, v72
    v_mfma_f32_16x16x32_bf16 v[164:167], v[92:95], a[148:151], v[164:167]
    v_cos_f32 v72, v72
    v_mfma_f32_16x16x32_bf16 v[168:171], v[92:95], a[152:155], v[168:171]
    buffer_load_dwordx4 a[192:195], v20, s[8:11], s99 offen offset:3072 sc1
    v_mfma_f32_16x16x32_bf16 v[172:175], v[92:95], a[156:159], v[172:175]
    v_fmamk_f32 v73, v10, 0x41880000, v13
    s_waitcnt vmcnt(9)
    v_cmp_ne_u32 vcc, s55, v15
    s_nop 0
    s_and_b64 vcc, vcc, s[0:1]
    s_cbranch_vccnz L_again_37
L_ok_36:
    s_barrier
    v_mfma_f32_16x16x32_bf16 v[96:99], a[240:243], a[160:163], v[96:99]
    v_sin_f32 v77, v73
    v_mfma_f32_16x16x32_bf16 v[100:103], a[240:243], a[164:167], v[100:103]
    v_cos_f32 v73, v73
    v_mfma_f32_16x16x32_bf16 v[104:107], a[240:243], a[168:171], v[104:107]
    s_add_u32 s47, s35, 0
    buffer_load_dwordx4 a[60:63], v22, s[8:11], s47 offen sc1
    v_mfma_f32_16x16x32_bf16 v[108:111], a[240:243], a[172:175], v[108:111]
    v_fmamk_f32 v74, v10, 0x41900000, v13
    v_mfma_f32_16x16x32_bf16 v[112:115], a[240:243], a[176:179], v[112:115]
    v_sin_f32 v78, v74
    v_mfma_f32_16x16x32_bf16 v[116:119], a[244:247], a[160:163], v[116:119]
    buffer_load_dwordx4 a[64:67], v23, s[8:11], s47 offen sc1
    v_mfma_f32_16x16x32_bf16 v[120:123], a[244:247], a[164:167], v[120:123]
    v_cos_f32 v74, v74
    v_mfma_f32_16x16x32_bf16 v[124:127], a[244:247], a[168:171], v[124:127]
    v_fmamk_f32 v75, v10, 0x41980000, v13
    v_mfma_f32_16x16x32_bf16 v[128:131], a[244:247], a[172:175], v[128:131]
    v_sin_f32 v79, v75
    v_mfma_f32_16x16x32_bf16 v[132:135], a[244:247], a[176:179], v[132:135]
    buffer_load_dwordx4 a[68:71], v24, s[8:11], s47 offen sc1
    v_mfma_f32_16x16x32_bf16 v[136:139], a[248:251], a[160:163], v[136:139]
    v_cos_f32 v75, v75
    v_mfma_f32_16x16x32_bf16 v[140:143], a[248:251], a[164:167], v[140:143]
    v_cvt_pk_bf16_f32 v220, v72, -v76
    v_cvt_pk_bf16_f32 v221, v73, -v77
    v_mfma_f32_16x16x32_bf16 v[144:147], a[248:251], a[168:171], v[144:147]
    v_cvt_pk_bf16_f32 v222, v74, -v78
    v_cvt_pk_bf16_f32 v223, v75, -v79
    v_mfma_f32_16x16x32_bf16 v[148:151], a[248:251], a[172:175], v[148:151]
    buffer_load_dwordx4 a[72:75], v25, s[8:11], s47 offen sc1
    v_mfma_f32_16x16x32_bf16 v[152:155], a[248:251], a[176:179], v[152:155]
    v_and_b32 v220, v14, v220
    v_and_b32 v221, v14, v221
    v_mfma_f32_16x16x32_bf16 v[156:159], a[252:255], a[160:163], v[156:159]
    v_and_b32 v222, v14, v222
    v_and_b32 v223, v14, v223
    v_mfma_f32_16x16x32_bf16 v[160:163], a[252:255], a[164:167], v[160:163]
    v_fma_f32 v64, v2, v72, -v64
    v_fma_f32 v68, v2, v76, -v68
    v_mfma_f32_16x16x32_bf16 v[164:167], a[252:255], a[168:171], v[164:167]
    s_add_u32 s47, s35, 4096
    buffer_load_dwordx4 v[40:43], v22, s[8:11], s47 offen sc1
    v_mfma_f32_16x16x32_bf16 v[168:171], a[252:255], a[172:175], v[168:171]
    v_fma_f32 v65, v2, v73, -v65
    v_fma_f32 v69, v2, v77, -v69
    v_mfma_f32_16x16x32_bf16 v[172:175], a[252:255], a[176:179], v[172:175]
    v_fma_f32 v66, v2, v74, -v66
    v_fma_f32 v70, v2, v78, -v70
    s_waitcnt vmcnt(12)
    v_min_u32 v19, 39, v0
    v_lshlrev_b32 v19, 4, v19
    s_and_b32 s42, s2, 7
    s_lshl_b32 s42, s42, 10
    s_add_u32 s42, s42, 17846272
    s_mov_b64 exec, s[0:1]
    buffer_load_dwordx4 v[252:255], v19, s[8:11], s42 offen sc1
    s_mov_b64 exec, -1
    buffer_load_dwordx4 v[44:47], v23, s[8:11], s47 offen sc1
    buffer_load_dwordx4 v[48:51], v24, s[8:11], s47 offen sc1
    buffer_load_dwordx4 v[52:55], v25, s[8:11], s47 offen sc1
    s_add_u32 s47, s35, 8192
    buffer_load_dwordx4 v[80:83], v22, s[8:11], s47 offen sc1
    buffer_load_dwordx4 v[84:87], v23, s[8:11], s47 offen sc1
    buffer_load_dwordx4 v[88:91], v24, s[8:11], s47 offen sc1
    buffer_load_dwordx4 v[92:95], v25, s[8:11], s47 offen sc1
    buffer_load_dwordx4 a[196:199], v21, s[8:11], s99 offen offset:0 sc1
    s_waitcnt vmcnt(0)
    v_mfma_f32_16x16x32_bf16 v[96:99], v[56:59], a[180:183], v[96:99]
    v_fma_f32 v67, v2, v75, -v67
    v_fma_f32 v71, v2, v79, -v71
    v_mfma_f32_16x16x32_bf16 v[100:103], v[56:59], a[184:187], v[100:103]
    v_cvt_pk_bf16_f32 v224, v64, -v68
    v_cvt_pk_bf16_f32 v225, v65, -v69
    v_mfma_f32_16x16x32_bf16 v[104:107], v[56:59], a[188:191], v[104:107]
    v_cvt_pk_bf16_f32 v226, v66, -v70
    v_cvt_pk_bf16_f32 v227, v67, -v71
    v_mfma_f32_16x16x32_bf16 v[108:111], v[56:59], a[192:195], v[108:111]
    v_and_b32 v224, v14, v224
    v_and_b32 v225, v14, v225
    v_mfma_f32_16x16x32_bf16 v[112:115], v[56:59], a[196:199], v[112:115]
    s_mov_b32 s99, s38
    buffer_load_dwordx4 a[200:203], v20, s[8:11], s99 offen offset:0 sc1
    v_mfma_f32_16x16x32_bf16 v[116:119], v[60:63], a[180:183], v[116:119]
    v_and_b32 v226, v14, v226
    v_and_b32 v227, v14, v227
    v_mfma_f32_16x16x32_bf16 v[120:123], v[60:63], a[184:187], v[120:123]
    v_fma_f32 v72, v2, v64, -v72
    v_fma_f32 v76, v2, v68, -v76
    v_mfma_f32_16x16x32_bf16 v[124:127], v[60:63], a[188:191], v[124:127]
    buffer_load_dwordx4 a[204:207], v20, s[8:11], s99 offen offset:1024 sc1
    v_mfma_f32_16x16x32_bf16 v[128:131], v[60:63], a[192:195], v[128:131]
    v_fma_f32 v73, v2, v65, -v73
    v_fma_f32 v77, v2, v69, -v77
    v_mfma_f32_16x16x32_bf16 v[132:135], v[60:63], a[196:199], v[132:135]
    v_fma_f32 v74, v2, v66, -v74
    v_fma_f32 v78, v2, v70, -v78
    v_mfma_f32_16x16x32_bf16 v[136:139], v[28:31], a[180:183], v[136:139]
    v_fma_f32 v75, v2, v67, -v75
    v_fma_f32 v79, v2, v71, -v79
    v_mfma_f32_16x16x32_bf16 v[140:143], v[28:31], a[184:187], v[140:143]
    buffer_load_dwordx4 a[208:211], v20, s[8:11], s99 offen offset:2048 sc1
    v_mfma_f32_16x16x32_bf16 v[144:147], v[28:31], a[188:191], v[144:147]
    v_cvt_pk_bf16_f32 v228, v72, -v76
    v_cvt_pk_bf16_f32 v229, v73, -v77
    v_mfma_f32_16x16x32_bf16 v[148:151], v[28:31], a[192:195], v[148:151]
    v_cvt_pk_bf16_f32 v230, v74, -v78
    v_cvt_pk_bf16_f32 v231, v75, -v79
    v_mfma_f32_16x16x32_bf16 v[152:155], v[28:31], a[196:199], v[152:155]
    v_and_b32 v228, v14, v228
    v_and_b32 v229, v14, v229
    v_mfma_f32_16x16x32_bf16 v[156:159], v[32:35], a[180:183], v[156:159]
    buffer_load_dwordx4 a[212:215], v20, s[8:11], s99 offen offset:3072 sc1
    v_mfma_f32_16x16x32_bf16 v[160:163], v[32:35], a[184:187], v[160:163]
    v_and_b32 v230, v14, v230
    v_and_b32 v231, v14, v231
    v_mfma_f32_16x16x32_bf16 v[164:167], v[32:35], a[188:191], v[164:167]
    v_fma_f32 v64, v2, v72, -v64
    v_fma_f32 v68, v2, v76, -v68
    v_mfma_f32_16x16x32_bf16 v[168:171], v[32:35], a[192:195], v[168:171]
    v_fma_f32 v65, v2, v73, -v65
    v_fma_f32 v69, v2, v77, -v69
    v_mfma_f32_16x16x32_bf16 v[172:175], v[32:35], a[196:199], v[172:175]
    buffer_load_dwordx4 a[216:219], v21, s[8:11], s99 offen offset:0 sc1
    s_waitcnt vmcnt(0)
    v_mfma_f32_16x16x32_bf16 v[116:119], a[44:47], a[200:203], v[116:119]
    s_xor_b32 s66, s50, 1
    s_mul_i32 s66, s66, 15360
    v_mfma_f32_16x16x32_bf16 v[120:123], a[44:47], a[204:207], v[120:123]
    s_add_u32 s66, s66, 81920
    v_add_u32 v28, s66, v20
    v_mfma_f32_16x16x32_bf16 v[124:127], a[44:47], a[208:211], v[124:127]
    s_xor_b32 s66, s50, 2
    s_mul_i32 s66, s66, 15360
    v_mfma_f32_16x16x32_bf16 v[128:131], a[44:47], a[212:215], v[128:131]
    s_add_u32 s99, s39, 0
    buffer_load_dwordx4 a[220:223], v20, s[8:11], s99 offen offset:0 sc1
    v_mfma_f32_16x16x32_bf16 v[132:135], a[44:47], a[216:219], v[132:135]
    s_add_u32 s66, s66, 87040
    v_add_u32 v29, s66, v20
    buffer_load_dwordx4 a[224:227], v20, s[8:11], s99 offen offset:1024 sc1
    buffer_load_dwordx4 a[228:231], v20, s[8:11], s99 offen offset:2048 sc1
    buffer_load_dwordx4 a[232:235], v20, s[8:11], s99 offen offset:3072 sc1
    buffer_load_dwordx4 a[236:239], v21, s[8:11], s99 offen offset:0 sc1
    s_waitcnt vmcnt(0)
    v_mfma_f32_16x16x32_bf16 v[116:119], a[64:67], a[220:223], v[116:119]
    s_xor_b32 s66, s50, 3
    s_mul_i32 s66, s66, 15360
    v_mfma_f32_16x16x32_bf16 v[120:123], a[64:67], a[224:227], v[120:123]
    s_add_u32 s66, s66, 92160
    v_add_u32 v30, s66, v20
    v_mfma_f32_16x16x32_bf16 v[124:127], a[64:67], a[228:231], v[124:127]
    s_mul_i32 s66, s50, 15360
    s_add_u32 s66, s66, 81920
    v_mfma_f32_16x16x32_bf16 v[128:131], a[64:67], a[232:235], v[128:131]
    v_add_u32 v31, s66, v20
    s_lshl_b32 s66, s84, 8
    v_mfma_f32_16x16x32_bf16 v[132:135], a[64:67], a[236:239], v[132:135]
    s_add_u32 s99, s39, 5120
    buffer_load_dwordx4 a[0:3], v20, s[8:11], s99 offen offset:0 sc1
    buffer_load_dwordx4 a[4:7], v20, s[8:11], s99 offen offset:1024 sc1
    buffer_load_dwordx4 a[8:11], v20, s[8:11], s99 offen offset:2048 sc1
    buffer_load_dwordx4 a[12:15], v20, s[8:11], s99 offen offset:3072 sc1
    buffer_load_dwordx4 a[16:19], v21, s[8:11], s99 offen offset:0 sc1
    s_waitcnt vmcnt(0)
    v_mfma_f32_16x16x32_bf16 v[116:119], v[44:47], a[0:3], v[116:119]
    s_lshl_b32 s67, s50, 6
    s_add_u32 s66, s66, s67
    v_mfma_f32_16x16x32_bf16 v[120:123], v[44:47], a[4:7], v[120:123]
    s_add_u32 s66, s66, 156672
    v_lshrrev_b32 v1, 4, v0
    v_mfma_f32_16x16x32_bf16 v[124:127], v[44:47], a[8:11], v[124:127]
    v_lshl_add_u32 v1, v1, 4, s66
    ds_read_b128 v[4:7], v1
    v_mfma_f32_16x16x32_bf16 v[128:131], v[44:47], a[12:15], v[128:131]
    v_fma_f32 v66, v2, v74, -v66
    v_fma_f32 v70, v2, v78, -v70
    v_mfma_f32_16x16x32_bf16 v[132:135], v[44:47], a[16:19], v[132:135]
    s_add_u32 s99, s39, 10240
    buffer_load_dwordx4 a[20:23], v20, s[8:11], s99 offen offset:0 sc1
    buffer_load_dwordx4 a[24:27], v20, s[8:11], s99 offen offset:1024 sc1
    buffer_load_dwordx4 a[28:31], v20, s[8:11], s99 offen offset:2048 sc1
    buffer_load_dwordx4 a[32:35], v20, s[8:11], s99 offen offset:3072 sc1
    buffer_load_dwordx4 a[36:39], v21, s[8:11], s99 offen offset:0 sc1
    s_waitcnt vmcnt(0)
    v_mfma_f32_16x16x32_bf16 v[116:119], v[84:87], a[20:23], v[116:119]
    v_fma_f32 v67, v2, v75, -v67
    v_fma_f32 v71, v2, v79, -v71
    v_mfma_f32_16x16x32_bf16 v[120:123], v[84:87], a[24:27], v[120:123]
    v_cvt_pk_bf16_f32 v232, v64, -v68
    v_cvt_pk_bf16_f32 v233, v65, -v69
    v_mfma_f32_16x16x32_bf16 v[124:127], v[84:87], a[28:31], v[124:127]
    v_cvt_pk_bf16_f32 v234, v66, -v70
    v_cvt_pk_bf16_f32 v235, v67, -v71
    v_mfma_f32_16x16x32_bf16 v[128:131], v[84:87], a[32:35], v[128:131]
    v_and_b32 v232, v14, v232
    v_and_b32 v233, v14, v233
    v_mfma_f32_16x16x32_bf16 v[132:135], v[84:87], a[36:39], v[132:135]
    v_and_b32 v234, v14, v234
    v_and_b32 v235, v14, v235
    v_cmp_ne_u32 vcc, s55, v252
    v_cmp_ne_u32 s[88:89], s55, v253
    s_nop 0
    s_or_b64 vcc, vcc, s[88:89]
    v_cmp_ne_u32 s[88:89], s55, v254
    s_nop 0
    s_or_b64 vcc, vcc, s[88:89]
    v_cmp_ne_u32 s[88:89], s55, v255
    s_nop 0
    s_or_b64 vcc, vcc, s[88:89]
    s_and_b64 vcc, vcc, s[0:1]
    s_cbranch_vccnz L_again_40
L_ok_39:
    s_barrier
    v_lshrrev_b32 v15, 4, v0
    v_and_b32 v16, 1, v15
    v_bfe_u32 v17, v0, 2, 2
    v_xor_b32 v16, v16, v17
    v_lshlrev_b32 v16, 6, v16
    v_lshl_add_u32 v16, v15, 8, v16
    v_and_b32 v17, 3, v0
    v_lshl_add_u32 v16, v17, 4, v16
    v_xor_b32 v17, 0x80, v16
    s_mul_i32 s57, s82, 81920
    s_mul_i32 s45, s50, 20480
    s_add_u32 s57, s57, s45
    s_add_u32 s94, s57, 5242880
    v_mfma_f32_16x16x32_bf16 v[136:139], a[48:51], a[200:203], v[136:139]
    s_add_u32 m0, s45, 0
    s_add_u32 s99, s94, 0
    buffer_load_dwordx4 v16, s[8:11], s99 offen offset:0 sc1 lds
    v_mfma_f32_16x16x32_bf16 v[140:143], a[48:51], a[204:207], v[140:143]
    v_lshrrev_b32 v1, 4, v0
    v_bfe_u32 v25, v0, 3, 1
    v_mfma_f32_16x16x32_bf16 v[144:147], a[48:51], a[208:211], v[144:147]
    v_lshl_add_u32 v3, v1, 2, v25
    v_lshlrev_b32 v3, 8, v3
    v_mfma_f32_16x16x32_bf16 v[148:151], a[48:51], a[212:215], v[148:151]
    ds_write_b128 v28, v[116:119] offset:0
    buffer_load_dwordx4 v17, s[8:11], s99 offen offset:1024 sc1 lds
    v_mfma_f32_16x16x32_bf16 v[152:155], a[48:51], a[216:219], v[152:155]
    v_and_b32 v1, 1, v1
    v_lshl_add_u32 v25, v1, 1, v25
    v_mfma_f32_16x16x32_bf16 v[136:139], a[68:71], a[220:223], v[136:139]
    v_xor_b32 v25, s50, v25
    v_lshl_add_u32 v3, v25, 6, v3
    v_mfma_f32_16x16x32_bf16 v[140:143], a[68:71], a[224:227], v[140:143]
    buffer_load_dwordx4 v16, s[8:11], s99 offen offset:2048 sc1 lds
    v_mfma_f32_16x16x32_bf16 v[144:147], a[68:71], a[228:231], v[144:147]
    ds_write_b128 v28, v[120:123] offset:1024
    v_and_b32 v1, 3, v0
    v_mfma_f32_16x16x32_bf16 v[148:151], a[68:71], a[232:235], v[148:151]
    v_lshl_add_u32 v3, v1, 4, v3
    v_bfe_u32 v1, v0, 2, 1
    v_mfma_f32_16x16x32_bf16 v[152:155], a[68:71], a[236:239], v[152:155]
    v_lshl_add_u32 v3, v1, 3, v3
    s_mul_i32 s66, s50, 20480
    v_mfma_f32_16x16x32_bf16 v[136:139], v[48:51], a[0:3], v[136:139]
    buffer_load_dwordx4 v17, s[8:11], s99 offen offset:3072 sc1 lds
    v_mfma_f32_16x16x32_bf16 v[140:143], v[48:51], a[4:7], v[140:143]
    ds_write_b128 v28, v[124:127] offset:2048
    v_add_u32 v22, s66, v3
    v_mfma_f32_16x16x32_bf16 v[144:147], v[48:51], a[8:11], v[144:147]
    v_xor_b32 v23, 64, v22
    v_xor_b32 v24, 0x80, v22
    v_mfma_f32_16x16x32_bf16 v[148:151], v[48:51], a[12:15], v[148:151]
    v_xor_b32 v25, 0xc0, v22
    v_add_u32 v32, s66, v20
    v_mfma_f32_16x16x32_bf16 v[152:155], v[48:51], a[16:19], v[152:155]
    s_add_u32 m0, s45, 4096
    s_add_u32 s99, s94, 4096
    buffer_load_dwordx4 v16, s[8:11], s99 offen offset:0 sc1 lds
    v_mfma_f32_16x16x32_bf16 v[136:139], v[88:91], a[20:23], v[136:139]
    ds_write_b128 v28, v[128:131] offset:3072
    s_xor_b32 s66, s50, 1
    v_mfma_f32_16x16x32_bf16 v[140:143], v[88:91], a[24:27], v[140:143]
    s_mul_i32 s66, s66, 20480
    s_add_u32 s66, s66, 0
    v_mfma_f32_16x16x32_bf16 v[144:147], v[88:91], a[28:31], v[144:147]
    buffer_load_dwordx4 v17, s[8:11], s99 offen offset:1024 sc1 lds
    v_mfma_f32_16x16x32_bf16 v[148:151], v[88:91], a[32:35], v[148:151]
    v_add_u32 v33, s66, v20
    s_xor_b32 s66, s50, 2
    v_mfma_f32_16x16x32_bf16 v[152:155], v[88:91], a[36:39], v[152:155]
    ds_write_b128 v28, v[132:135] offset:4096
    s_mul_i32 s66, s66, 20480
    v_mfma_f32_16x16x32_bf16 v[156:159], a[52:55], a[200:203], v[156:159]
    s_add_u32 s66, s66, 3072
    v_add_u32 v34, s66, v20
    v_mfma_f32_16x16x32_bf16 v[160:163], a[52:55], a[204:207], v[160:163]
    buffer_load_dwordx4 v16, s[8:11], s99 offen offset:2048 sc1 lds
    v_mfma_f32_16x16x32_bf16 v[164:167], a[52:55], a[208:211], v[164:167]
    s_xor_b32 s66, s50, 3
    s_mul_i32 s66, s66, 20480
    v_mfma_f32_16x16x32_bf16 v[168:171], a[52:55], a[212:215], v[168:171]
    ds_write_b128 v29, v[136:139] offset:0
    s_add_u32 s66, s66, 6144
    v_mfma_f32_16x16x32_bf16 v[172:175], a[52:55], a[216:219], v[172:175]
    v_add_u32 v35, s66, v20
    v_mfma_f32_16x16x32_bf16 v[156:159], a[72:75], a[220:223], v[156:159]
    buffer_load_dwordx4 v17, s[8:11], s99 offen offset:3072 sc1 lds
    v_mfma_f32_16x16x32_bf16 v[160:163], a[72:75], a[224:227], v[160:163]
    s_bitcmp0_b32 s50, 0
    s_cselect_b32 s62, 0xffff, 0
    v_mfma_f32_16x16x32_bf16 v[164:167], a[72:75], a[228:231], v[164:167]
    ds_write_b128 v29, v[140:143] offset:1024
    s_mov_b32 s63, 0
    v_mfma_f32_16x16x32_bf16 v[168:171], a[72:75], a[232:235], v[168:171]
    s_mul_i32 s64, s44, 0x3e800000
    s_lshl_b32 s65, s44, 31
    v_mfma_f32_16x16x32_bf16 v[172:175], a[72:75], a[236:239], v[172:175]
    s_add_u32 m0, s45, 8192
    s_add_u32 s99, s94, 8192
    buffer_load_dwordx4 v16, s[8:11], s99 offen offset:0 sc1 lds
    v_mfma_f32_16x16x32_bf16 v[156:159], v[52:55], a[0:3], v[156:159]
    s_or_b32 s65, s65, 0x3f000000
    v_mov_b32 v64, s64
    v_mfma_f32_16x16x32_bf16 v[160:163], v[52:55], a[4:7], v[160:163]
    ds_write_b128 v29, v[144:147] offset:2048
    v_mov_b32 v65, s65
    v_mfma_f32_16x16x32_bf16 v[164:167], v[52:55], a[8:11], v[164:167]
    buffer_load_dwordx4 v17, s[8:11], s99 offen offset:1024 sc1 lds
    v_mfma_f32_16x16x32_bf16 v[168:171], v[52:55], a[12:15], v[168:171]
    v_fmamk_f32 v66, v8, 0x43200000, v64
    v_fmamk_f32 v67, v9, 0x43200000, v64
    v_mfma_f32_16x16x32_bf16 v[172:175], v[52:55], a[16:19], v[172:175]
    v_fmamk_f32 v68, v10, 0x43200000, v64
    v_mfma_f32_16x16x32_bf16 v[156:159], v[92:95], a[20:23], v[156:159]
    ds_write_b128 v29, v[148:151] offset:3072
    v_mfma_f32_16x16x32_bf16 v[160:163], v[92:95], a[24:27], v[160:163]
    buffer_load_dwordx4 v16, s[8:11], s99 offen offset:2048 sc1 lds
    v_mfma_f32_16x16x32_bf16 v[164:167], v[92:95], a[28:31], v[164:167]
    v_cos_f32 v66, v66
    v_mfma_f32_16x16x32_bf16 v[168:171], v[92:95], a[32:35], v[168:171]
    v_cos_f32 v67, v67
    v_mfma_f32_16x16x32_bf16 v[172:175], v[92:95], a[36:39], v[172:175]
    ds_write_b128 v29, v[152:155] offset:4096
    v_mfma_f32_16x16x32_bf16 v[96:99], a[40:43], a[200:203], v[96:99]
    buffer_load_dwordx4 v17, s[8:11], s99 offen offset:3072 sc1 lds
    v_mfma_f32_16x16x32_bf16 v[100:103], a[40:43], a[204:207], v[100:103]
    v_cos_f32 v68, v68
    v_mfma_f32_16x16x32_bf16 v[104:107], a[40:43], a[208:211], v[104:107]
    v_cvt_pk_bf16_f32 v66, v65, v66
    v_cvt_pk_bf16_f32 v67, v65, v67
    v_mfma_f32_16x16x32_bf16 v[108:111], a[40:43], a[212:215], v[108:111]
    ds_write_b128 v30, v[156:159] offset:0
    v_cvt_pk_bf16_f32 v68, v65, v68
    v_mfma_f32_16x16x32_bf16 v[112:115], a[40:43], a[216:219], v[112:115]
    s_add_u32 m0, s45, 12288
    s_add_u32 s99, s94, 12288
    buffer_load_dwordx4 v16, s[8:11], s99 offen offset:0 sc1 lds
    v_mfma_f32_16x16x32_bf16 v[96:99], a[60:63], a[220:223], v[96:99]
    v_and_b32 v68, v14, v68
    v_cndmask_b32 v176, v176, v66, s[62:63]
    v_mfma_f32_16x16x32_bf16 v[100:103], a[60:63], a[224:227], v[100:103]
    v_cndmask_b32 v196, v196, v67, s[62:63]
    v_cndmask_b32 v216, v216, v68, s[62:63]
    v_mfma_f32_16x16x32_bf16 v[104:107], a[60:63], a[228:231], v[104:107]
    ds_write_b128 v30, v[160:163] offset:1024
    buffer_load_dwordx4 v17, s[8:11], s99 offen offset:1024 sc1 lds
    v_mfma_f32_16x16x32_bf16 v[108:111], a[60:63], a[232:235], v[108:111]
    v_mfma_f32_16x16x32_bf16 v[112:115], a[60:63], a[236:239], v[112:115]
    v_mfma_f32_16x16x32_bf16 v[96:99], v[40:43], a[0:3], v[96:99]
    buffer_load_dwordx4 v16, s[8:11], s99 offen offset:2048 sc1 lds
    v_mfma_f32_16x16x32_bf16 v[100:103], v[40:43], a[4:7], v[100:103]
    ds_write_b128 v30, v[164:167] offset:2048
    v_mfma_f32_16x16x32_bf16 v[104:107], v[40:43], a[8:11], v[104:107]
    v_mfma_f32_16x16x32_bf16 v[108:111], v[40:43], a[12:15], v[108:111]
    v_mfma_f32_16x16x32_bf16 v[112:115], v[40:43], a[16:19], v[112:115]
    buffer_load_dwordx4 v17, s[8:11], s99 offen offset:3072 sc1 lds
    v_mfma_f32_16x16x32_bf16 v[96:99], v[80:83], a[20:23], v[96:99]
    ds_write_b128 v30, v[168:171] offset:3072
    v_mfma_f32_16x16x32_bf16 v[100:103], v[80:83], a[24:27], v[100:103]
    v_mfma_f32_16x16x32_bf16 v[104:107], v[80:83], a[28:31], v[104:107]
    v_mfma_f32_16x16x32_bf16 v[108:111], v[80:83], a[32:35], v[108:111]
    s_add_u32 m0, s45, 16384
    s_add_u32 s99, s94, 16384
    buffer_load_dwordx4 v16, s[8:11], s99 offen offset:0 sc1 lds
    v_mfma_f32_16x16x32_bf16 v[112:115], v[80:83], a[36:39], v[112:115]
    ds_write_b128 v30, v[172:175] offset:4096
    s_waitcnt vmcnt(13)
    ds_read_b64_tr_b16 a[80:81], v22 offset:0
    ds_read_b64_tr_b16 a[82:83], v22 offset:512
    ds_read_b64_tr_b16 a[84:85], v23 offset:0
    ds_read_b64_tr_b16 a[86:87], v23 offset:512
    ds_read_b64_tr_b16 a[88:89], v24 offset:0
    ds_read_b64_tr_b16 a[90:91], v24 offset:512
    ds_read_b64_tr_b16 a[92:93], v25 offset:0
    ds_read_b64_tr_b16 a[94:95], v25 offset:512
    s_waitcnt lgkmcnt(0)
    s_barrier
    v_mfma_f32_16x16x32_bf16 v[40:43], a[80:83], v[176:179], 0
    s_waitcnt vmcnt(9)
    ds_read_b64_tr_b16 a[96:97], v22 offset:4096
    ds_read_b64_tr_b16 a[98:99], v22 offset:4608
    v_mfma_f32_16x16x32_bf16 v[44:47], a[80:83], v[196:199], 0
    buffer_load_dwordx4 v17, s[8:11], s99 offen offset:1024 sc1 lds
    v_mfma_f32_16x16x32_bf16 v[48:51], a[80:83], v[216:219], 0
    ds_read_b128 v[116:119], v31 offset:0
    ds_read_b128 v[120:123], v31 offset:1024
    v_mfma_f32_16x16x32_bf16 v[52:55], a[84:87], v[176:179], 0
    ds_read_b64_tr_b16 a[100:101], v23 offset:4096
    ds_read_b64_tr_b16 a[102:103], v23 offset:4608
    v_mfma_f32_16x16x32_bf16 v[56:59], a[84:87], v[196:199], 0
    ds_read_b128 v[124:127], v31 offset:2048
    ds_read_b128 v[128:131], v31 offset:3072
    v_mfma_f32_16x16x32_bf16 v[60:63], a[84:87], v[216:219], 0
    buffer_load_dwordx4 v16, s[8:11], s99 offen offset:2048 sc1 lds
    v_mfma_f32_16x16x32_bf16 v[80:83], a[88:91], v[176:179], 0
    ds_read_b64_tr_b16 a[104:105], v24 offset:4096
    ds_read_b64_tr_b16 a[106:107], v24 offset:4608
    v_mfma_f32_16x16x32_bf16 v[84:87], a[88:91], v[196:199], 0
    ds_read_b128 v[132:135], v31 offset:4096
    ds_read_b128 v[136:139], v31 offset:5120
    v_mfma_f32_16x16x32_bf16 v[88:91], a[88:91], v[216:219], 0
    ds_read_b128 v[140:143], v31 offset:6144
    ds_read_b128 v[144:147], v31 offset:7168
    v_mfma_f32_16x16x32_bf16 v[92:95], a[92:95], v[176:179], 0
    ds_read_b64_tr_b16 a[108:109], v25 offset:4096
    ds_read_b64_tr_b16 a[110:111], v25 offset:4608
    buffer_load_dwordx4 v17, s[8:11], s99 offen offset:3072 sc1 lds
    v_mfma_f32_16x16x32_bf16 v[64:67], a[92:95], v[196:199], 0
    ds_read_b128 v[148:151], v31 offset:8192
    ds_read_b128 v[152:155], v31 offset:9216
    v_mfma_f32_16x16x32_bf16 v[68:71], a[92:95], v[216:219], 0
    ds_read_b128 v[156:159], v31 offset:10240
    ds_read_b128 v[160:163], v31 offset:11264
    s_waitcnt lgkmcnt(4)
    v_mfma_f32_16x16x32_bf16 v[40:43], a[96:99], v[180:183], v[40:43]
    s_lshl_b32 s57, s84, 6
    s_add_u32 s57, s57, s97
    s_lshl_b32 s58, s50, 2
    s_add_u32 s57, s57, s58
    v_lshrrev_b32 v18, 4, v0
    v_add_u32 v18, s57, v18
    v_mul_u32_u24 v18, 1280, v18
    s_mul_i32 s57, s83, 160
    v_add_u32 v18, s57, v18
    v_and_b32 v36, 15, v0
    v_lshl_add_u32 v38, v36, 1, v18
    v_lshl_add_u32 v18, v36, 2, v18
    s_mov_b32 s74, 0
    s_mov_b32 s75, 1310720
    s_mov_b32 s76, 40960
    s_mov_b32 s77, 1351680
    s_waitcnt vmcnt(8)
    ds_read_b64_tr_b16 a[80:81], v22 offset:8192
    ds_read_b64_tr_b16 a[82:83], v22 offset:8704
    v_mfma_f32_16x16x32_bf16 v[44:47], a[96:99], v[200:203], v[44:47]
    buffer_load_dword v236, v18, s[4:7], s74 offen offset:0
    buffer_load_dword v240, v18, s[4:7], s74 offen offset:64
    buffer_load_ushort v244, v38, s[4:7], s74 offen offset:128
    v_mfma_f32_16x16x32_bf16 v[48:51], a[96:99], v[220:223], v[48:51]
    ds_read_b128 v[164:167], v31 offset:12288
    ds_read_b128 v[168:171], v31 offset:13312
    v_mfma_f32_16x16x32_bf16 v[52:55], a[100:103], v[180:183], v[52:55]
    ds_read_b64_tr_b16 a[84:85], v23 offset:8192
    ds_read_b64_tr_b16 a[86:87], v23 offset:8704
    v_mfma_f32_16x16x32_bf16 v[56:59], a[100:103], v[200:203], v[56:59]
    buffer_load_dword v237, v18, s[4:7], s75 offen offset:0
    buffer_load_dword v241, v18, s[4:7], s75 offen offset:64
    buffer_load_ushort v245, v38, s[4:7], s75 offen offset:128
    v_mfma_f32_16x16x32_bf16 v[60:63], a[100:103], v[220:223], v[60:63]
    ds_read_b128 v[172:175], v31 offset:14336
    v_mul_f32 v4, 0xbfb8aa3b, v4
    v_mfma_f32_16x16x32_bf16 v[80:83], a[104:107], v[180:183], v[80:83]
    ds_read_b64_tr_b16 a[88:89], v24 offset:8192
    ds_read_b64_tr_b16 a[90:91], v24 offset:8704
    v_mfma_f32_16x16x32_bf16 v[84:87], a[104:107], v[200:203], v[84:87]
    buffer_load_dword v238, v18, s[4:7], s76 offen offset:0
    buffer_load_dword v242, v18, s[4:7], s76 offen offset:64
    buffer_load_ushort v246, v38, s[4:7], s76 offen offset:128
    v_mfma_f32_16x16x32_bf16 v[88:91], a[104:107], v[220:223], v[88:91]
    v_mul_f32 v5, 0xbfb8aa3b, v5
    v_mul_f32 v6, 0xbfb8aa3b, v6
    v_mfma_f32_16x16x32_bf16 v[92:95], a[108:111], v[180:183], v[92:95]
    ds_read_b64_tr_b16 a[92:93], v25 offset:8192
    ds_read_b64_tr_b16 a[94:95], v25 offset:8704
    v_mfma_f32_16x16x32_bf16 v[64:67], a[108:111], v[200:203], v[64:67]
    buffer_load_dword v239, v18, s[4:7], s77 offen offset:0
    buffer_load_dword v243, v18, s[4:7], s77 offen offset:64
    buffer_load_ushort v247, v38, s[4:7], s77 offen offset:128
    v_mfma_f32_16x16x32_bf16 v[68:71], a[108:111], v[220:223], v[68:71]
    v_mul_f32 v7, 0xbfb8aa3b, v7
    s_waitcnt lgkmcnt(0)
    v_mfma_f32_16x16x32_bf16 v[40:43], a[80:83], v[184:187], v[40:43]
    s_waitcnt vmcnt(16)
    ds_read_b64_tr_b16 a[96:97], v22 offset:12288
    ds_read_b64_tr_b16 a[98:99], v22 offset:12800
    v_mfma_f32_16x16x32_bf16 v[44:47], a[80:83], v[204:207], v[44:47]
    v_add_f32 v96, v96, v116
    v_add_f32 v97, v97, v117
    v_mfma_f32_16x16x32_bf16 v[48:51], a[80:83], v[224:227], v[48:51]
    v_add_f32 v98, v98, v118
    v_add_f32 v99, v99, v119
    v_mfma_f32_16x16x32_bf16 v[52:55], a[84:87], v[184:187], v[52:55]
    ds_read_b64_tr_b16 a[100:101], v23 offset:12288
    ds_read_b64_tr_b16 a[102:103], v23 offset:12800
    v_mfma_f32_16x16x32_bf16 v[56:59], a[84:87], v[204:207], v[56:59]
    v_add_f32 v100, v100, v120
    v_add_f32 v101, v101, v121
    v_mfma_f32_16x16x32_bf16 v[60:63], a[84:87], v[224:227], v[60:63]
    v_add_f32 v102, v102, v122
    v_add_f32 v103, v103, v123
    v_mfma_f32_16x16x32_bf16 v[80:83], a[88:91], v[184:187], v[80:83]
    ds_read_b64_tr_b16 a[104:105], v24 offset:12288
    ds_read_b64_tr_b16 a[106:107], v24 offset:12800
    v_mfma_f32_16x16x32_bf16 v[84:87], a[88:91], v[204:207], v[84:87]
    v_add_f32 v104, v104, v124
    v_add_f32 v105, v105, v125
    v_mfma_f32_16x16x32_bf16 v[88:91], a[88:91], v[224:227], v[88:91]
    v_add_f32 v106, v106, v126
    v_add_f32 v107, v107, v127
    v_mfma_f32_16x16x32_bf16 v[92:95], a[92:95], v[184:187], v[92:95]
    ds_read_b64_tr_b16 a[108:109], v25 offset:12288
    ds_read_b64_tr_b16 a[110:111], v25 offset:12800
    v_mfma_f32_16x16x32_bf16 v[64:67], a[92:95], v[204:207], v[64:67]
    v_add_f32 v108, v108, v128
    v_add_f32 v109, v109, v129
    v_mfma_f32_16x16x32_bf16 v[68:71], a[92:95], v[224:227], v[68:71]
    v_add_f32 v110, v110, v130
    v_add_f32 v111, v111, v131
    s_waitcnt lgkmcnt(0)
    v_mfma_f32_16x16x32_bf16 v[40:43], a[96:99], v[188:191], v[40:43]
    s_waitcnt vmcnt(12)
    ds_read_b64_tr_b16 a[80:81], v22 offset:16384
    ds_read_b64_tr_b16 a[82:83], v22 offset:16896
    v_mfma_f32_16x16x32_bf16 v[44:47], a[96:99], v[208:211], v[44:47]
    v_add_f32 v112, v112, v132
    v_add_f32 v113, v113, v133
    v_mfma_f32_16x16x32_bf16 v[48:51], a[96:99], v[228:231], v[48:51]
    v_add_f32 v114, v114, v134
    v_add_f32 v115, v115, v135
    v_mfma_f32_16x16x32_bf16 v[52:55], a[100:103], v[188:191], v[52:55]
    ds_read_b64_tr_b16 a[84:85], v23 offset:16384
    ds_read_b64_tr_b16 a[86:87], v23 offset:16896
    v_mfma_f32_16x16x32_bf16 v[56:59], a[100:103], v[208:211], v[56:59]
    v_add_f32 v96, v96, v136
    v_mfma_f32_16x16x32_bf16 v[60:63], a[100:103], v[228:231], v[60:63]
    v_add_f32 v97, v97, v137
    v_add_f32 v98, v98, v138
    v_mfma_f32_16x16x32_bf16 v[80:83], a[104:107], v[188:191], v[80:83]
    ds_read_b64_tr_b16 a[88:89], v24 offset:16384
    ds_read_b64_tr_b16 a[90:91], v24 offset:16896
    v_mfma_f32_16x16x32_bf16 v[84:87], a[104:107], v[208:211], v[84:87]
    v_add_f32 v99, v99, v139
    v_add_f32 v100, v100, v140
    v_mfma_f32_16x16x32_bf16 v[88:91], a[104:107], v[228:231], v[88:91]
    v_add_f32 v101, v101, v141
    v_add_f32 v102, v102, v142
    v_mfma_f32_16x16x32_bf16 v[92:95], a[108:111], v[188:191], v[92:95]
    ds_read_b64_tr_b16 a[92:93], v25 offset:16384
    ds_read_b64_tr_b16 a[94:95], v25 offset:16896
    v_mfma_f32_16x16x32_bf16 v[64:67], a[108:111], v[208:211], v[64:67]
    v_add_f32 v103, v103, v143
    v_add_f32 v104, v104, v144
    v_mfma_f32_16x16x32_bf16 v[68:71], a[108:111], v[228:231], v[68:71]
    v_add_f32 v105, v105, v145
    v_add_f32 v106, v106, v146
    s_waitcnt lgkmcnt(0)
    v_mfma_f32_16x16x32_bf16 v[52:55], a[84:87], v[192:195], v[52:55]
    v_add_f32 v107, v107, v147
    v_add_f32 v108, v108, v148
    v_mfma_f32_16x16x32_bf16 v[56:59], a[84:87], v[212:215], v[56:59]
    v_add_f32 v109, v109, v149
    v_add_f32 v110, v110, v150
    v_mfma_f32_16x16x32_bf16 v[60:63], a[84:87], v[232:235], v[60:63]
    v_add_f32 v111, v111, v151
    v_add_f32 v112, v112, v152
    v_mfma_f32_16x16x32_bf16 v[80:83], a[88:91], v[192:195], v[80:83]
    v_add_f32 v113, v113, v153
    v_add_f32 v114, v114, v154
    v_mfma_f32_16x16x32_bf16 v[84:87], a[88:91], v[212:215], v[84:87]
    v_add_f32 v115, v115, v155
    v_mfma_f32_16x16x32_bf16 v[88:91], a[88:91], v[232:235], v[88:91]
    v_add_f32 v96, v96, v156
    v_add_f32 v97, v97, v157
    v_mfma_f32_16x16x32_bf16 v[92:95], a[92:95], v[192:195], v[92:95]
    v_add_f32 v98, v98, v158
    v_add_f32 v99, v99, v159
    v_mfma_f32_16x16x32_bf16 v[64:67], a[92:95], v[212:215], v[64:67]
    v_add_f32 v100, v100, v160
    v_add_f32 v101, v101, v161
    v_mfma_f32_16x16x32_bf16 v[68:71], a[92:95], v[232:235], v[68:71]
    v_add_f32 v102, v102, v162
    v_add_f32 v103, v103, v163
    v_mfma_f32_16x16x32_bf16 v[40:43], a[80:83], v[192:195], v[40:43]
    v_add_f32 v104, v104, v164
    v_add_f32 v105, v105, v165
    v_mfma_f32_16x16x32_bf16 v[44:47], a[80:83], v[212:215], v[44:47]
    v_add_f32 v106, v106, v166
    v_add_f32 v107, v107, v167
    v_mfma_f32_16x16x32_bf16 v[48:51], a[80:83], v[232:235], v[48:51]
    v_add_f32 v108, v108, v168
    v_add_f32 v109, v109, v169
    v_add_f32 v110, v110, v170
    v_add_f32 v111, v111, v171
    v_add_f32 v112, v112, v172
    v_add_f32 v113, v113, v173
    v_add_f32 v114, v114, v174
    v_add_f32 v115, v115, v175
    ds_write_b128 v32, v[52:55] offset:0
    v_pk_mul_f32 v[96:97], v[96:97], v[4:5]
    v_pk_mul_f32 v[98:99], v[98:99], v[6:7]
    v_pk_mul_f32 v[100:101], v[100:101], v[4:5]
    v_pk_mul_f32 v[102:103], v[102:103], v[6:7]
    v_pk_mul_f32 v[104:105], v[104:105], v[4:5]
    ds_write_b128 v32, v[56:59] offset:1024
    v_pk_mul_f32 v[106:107], v[106:107], v[6:7]
    v_pk_mul_f32 v[108:109], v[108:109], v[4:5]
    v_pk_mul_f32 v[110:111], v[110:111], v[6:7]
    v_pk_mul_f32 v[112:113], v[112:113], v[4:5]
    v_pk_mul_f32 v[114:115], v[114:115], v[6:7]
    ds_write_b128 v32, v[60:63] offset:2048
    v_exp_f32 v136, v96
    v_exp_f32 v137, v97
    v_exp_f32 v138, v98
    v_exp_f32 v139, v99
    v_exp_f32 v140, v100
    ds_write_b128 v32, v[80:83] offset:3072
    v_exp_f32 v141, v101
    v_exp_f32 v142, v102
    v_exp_f32 v143, v103
    v_exp_f32 v144, v104
    v_exp_f32 v145, v105
    ds_write_b128 v32, v[84:87] offset:4096
    v_exp_f32 v146, v106
    v_exp_f32 v147, v107
    v_exp_f32 v148, v108
    v_exp_f32 v149, v109
    v_exp_f32 v150, v110
    ds_write_b128 v32, v[88:91] offset:5120
    v_exp_f32 v151, v111
    v_exp_f32 v152, v112
    v_exp_f32 v153, v113
    v_exp_f32 v154, v114
    v_exp_f32 v155, v115
    ds_write_b128 v32, v[92:95] offset:6144
    v_pk_add_f32 v[136:137], v[136:137], 1.0 op_sel_hi:[1,0]
    v_pk_add_f32 v[138:139], v[138:139], 1.0 op_sel_hi:[1,0]
    v_pk_add_f32 v[140:141], v[140:141], 1.0 op_sel_hi:[1,0]
    v_pk_add_f32 v[142:143], v[142:143], 1.0 op_sel_hi:[1,0]
    v_pk_add_f32 v[144:145], v[144:145], 1.0 op_sel_hi:[1,0]
    ds_write_b128 v32, v[64:67] offset:7168
    v_pk_add_f32 v[146:147], v[146:147], 1.0 op_sel_hi:[1,0]
    v_pk_add_f32 v[148:149], v[148:149], 1.0 op_sel_hi:[1,0]
    v_pk_add_f32 v[150:151], v[150:151], 1.0 op_sel_hi:[1,0]
    v_pk_add_f32 v[152:153], v[152:153], 1.0 op_sel_hi:[1,0]
    v_pk_add_f32 v[154:155], v[154:155], 1.0 op_sel_hi:[1,0]
    ds_write_b128 v32, v[68:71] offset:8192
    v_rcp_f32 v136, v136
    v_rcp_f32 v137, v137
    v_rcp_f32 v138, v138
    v_rcp_f32 v139, v139
    v_rcp_f32 v140, v140
    s_waitcnt lgkmcnt(0)
    s_barrier
    ds_read_b128 v[52:55], v33 offset:0
    ds_read_b128 v[56:59], v33 offset:1024
    ds_read_b128 v[60:63], v33 offset:2048
    ds_read_b128 v[80:83], v34 offset:0
    ds_read_b128 v[84:87], v34 offset:1024
    ds_read_b128 v[88:91], v34 offset:2048
    ds_read_b128 v[92:95], v35 offset:0
    ds_read_b128 v[64:67], v35 offset:1024
    ds_read_b128 v[68:71], v35 offset:2048
    v_rcp_f32 v141, v141
    v_rcp_f32 v142, v142
    v_rcp_f32 v143, v143
    v_rcp_f32 v144, v144
    v_rcp_f32 v145, v145
    v_rcp_f32 v146, v146
    v_rcp_f32 v147, v147
    v_rcp_f32 v148, v148
    v_rcp_f32 v149, v149
    v_rcp_f32 v150, v150
    v_rcp_f32 v151, v151
    v_rcp_f32 v152, v152
    v_rcp_f32 v153, v153
    v_rcp_f32 v154, v154
    v_rcp_f32 v155, v155
    v_pk_mul_f32 v[96:97], v[96:97], v[136:137]
    v_pk_mul_f32 v[98:99], v[98:99], v[138:139]
    v_pk_mul_f32 v[100:101], v[100:101], v[140:141]
    v_pk_mul_f32 v[102:103], v[102:103], v[142:143]
    v_pk_mul_f32 v[104:105], v[104:105], v[144:145]
    v_pk_mul_f32 v[106:107], v[106:107], v[146:147]
    v_pk_mul_f32 v[108:109], v[108:109], v[148:149]
    v_pk_mul_f32 v[110:111], v[110:111], v[150:151]
    v_pk_mul_f32 v[112:113], v[112:113], v[152:153]
    v_pk_mul_f32 v[114:115], v[114:115], v[154:155]
    s_waitcnt vmcnt(0)
    v_lshlrev_b32 v116, 16, v236
    v_and_b32 v120, 0xffff0000, v236
    v_lshlrev_b32 v117, 16, v237
    v_and_b32 v121, 0xffff0000, v237
    v_lshlrev_b32 v118, 16, v238
    v_and_b32 v122, 0xffff0000, v238
    v_lshlrev_b32 v119, 16, v239
    v_and_b32 v123, 0xffff0000, v239
    v_lshlrev_b32 v124, 16, v240
    v_and_b32 v128, 0xffff0000, v240
    v_lshlrev_b32 v125, 16, v241
    v_and_b32 v129, 0xffff0000, v241
    v_lshlrev_b32 v126, 16, v242
    v_and_b32 v130, 0xffff0000, v242
    v_lshlrev_b32 v127, 16, v243
    v_and_b32 v131, 0xffff0000, v243
    v_lshlrev_b32 v132, 16, v244
    v_lshlrev_b32 v133, 16, v245
    v_lshlrev_b32 v134, 16, v246
    v_lshlrev_b32 v135, 16, v247
    s_cmp_ge_u32 s50, 2
    s_cselect_b64 s[88:89], -1, 0
    s_waitcnt lgkmcnt(0)
    v_pk_add_f32 v[40:41], v[40:41], v[52:53]
    v_pk_add_f32 v[80:81], v[80:81], v[92:93]
    v_pk_add_f32 v[42:43], v[42:43], v[54:55]
    v_pk_add_f32 v[82:83], v[82:83], v[94:95]
    v_pk_add_f32 v[44:45], v[44:45], v[56:57]
    v_pk_add_f32 v[84:85], v[84:85], v[64:65]
    v_pk_add_f32 v[46:47], v[46:47], v[58:59]
    v_pk_add_f32 v[86:87], v[86:87], v[66:67]
    v_pk_add_f32 v[48:49], v[48:49], v[60:61]
    v_pk_add_f32 v[88:89], v[88:89], v[68:69]
    v_pk_add_f32 v[50:51], v[50:51], v[62:63]
    v_pk_add_f32 v[90:91], v[90:91], v[70:71]
    v_pk_add_f32 v[48:49], v[48:49], v[88:89]
    v_pk_add_f32 v[50:51], v[50:51], v[90:91]
    s_mov_b64 exec, s[88:89]
    v_swap_b32 v40, v80
    v_swap_b32 v41, v81
    v_swap_b32 v42, v82
    v_swap_b32 v43, v83
    v_swap_b32 v44, v84
    v_swap_b32 v45, v85
    v_swap_b32 v46, v86
    v_swap_b32 v47, v87
    s_mov_b64 exec, -1
    v_pk_fma_f32 v[116:117], v[40:41], v[96:97], v[116:117]
    v_pk_fma_f32 v[120:121], v[80:81], v[100:101], v[120:121]
    v_pk_fma_f32 v[118:119], v[42:43], v[98:99], v[118:119]
    v_pk_fma_f32 v[122:123], v[82:83], v[102:103], v[122:123]
    v_cvt_pk_bf16_f32 v160, v116, v120
    v_cvt_pk_bf16_f32 v161, v117, v121
    v_cvt_pk_bf16_f32 v162, v118, v122
    v_cvt_pk_bf16_f32 v163, v119, v123
    buffer_store_dword v160, v18, s[28:31], s74 offen offset:0
    buffer_store_dword v161, v18, s[28:31], s75 offen offset:0
    buffer_store_dword v162, v18, s[28:31], s76 offen offset:0
    buffer_store_dword v163, v18, s[28:31], s77 offen offset:0
    v_pk_fma_f32 v[124:125], v[44:45], v[104:105], v[124:125]
    v_pk_fma_f32 v[128:129], v[84:85], v[108:109], v[128:129]
    v_pk_fma_f32 v[126:127], v[46:47], v[106:107], v[126:127]
    v_pk_fma_f32 v[130:131], v[86:87], v[110:111], v[130:131]
    v_cvt_pk_bf16_f32 v164, v124, v128
    v_cvt_pk_bf16_f32 v165, v125, v129
    v_cvt_pk_bf16_f32 v166, v126, v130
    v_cvt_pk_bf16_f32 v167, v127, v131
    buffer_store_dword v164, v18, s[28:31], s74 offen offset:64
    buffer_store_dword v165, v18, s[28:31], s75 offen offset:64
    buffer_store_dword v166, v18, s[28:31], s76 offen offset:64
    buffer_store_dword v167, v18, s[28:31], s77 offen offset:64
    v_pk_fma_f32 v[132:133], v[48:49], v[112:113], v[132:133]
    v_pk_fma_f32 v[134:135], v[50:51], v[114:115], v[134:135]
    v_cvt_pk_bf16_f32 v168, v132, v132
    v_cvt_pk_bf16_f32 v169, v133, v133
    v_cvt_pk_bf16_f32 v170, v134, v134
    v_cvt_pk_bf16_f32 v171, v135, v135
    buffer_store_short v168, v38, s[28:31], s74 offen offset:128
    buffer_store_short v169, v38, s[28:31], s75 offen offset:128
    buffer_store_short v170, v38, s[28:31], s76 offen offset:128
    buffer_store_short v171, v38, s[28:31], s77 offen offset:128
    s_endpgm
L_again_28:
    s_mov_b32 s98, 0
L_loop_29:
    s_sleep 6
    buffer_load_dwordx2 v[10:11], v1, s[8:11], s42 offen sc1
    s_add_u32 s98, s98, 1
    s_waitcnt vmcnt(0)
    v_cmp_ne_u32 vcc, s55, v10
    v_cmp_ne_u32 s[88:89], s55, v11
    s_nop 0
    s_or_b64 vcc, vcc, s[88:89]
    s_cmp_lt_u32 s98, 0x40000
    s_cselect_b64 vcc, vcc, 0
    s_cbranch_vccnz L_loop_29
    s_nop 4
    s_branch L_ok_27
L_again_31:
    s_mov_b32 s98, 0
L_loop_32:
    s_sleep 6
    buffer_load_dword v10, v1, s[8:11], s43 offen sc1
    s_add_u32 s98, s98, 1
    s_waitcnt vmcnt(0)
    v_cmp_ne_u32 vcc, s55, v10
    s_cmp_lt_u32 s98, 0x40000
    s_cselect_b64 vcc, vcc, 0
    s_cbranch_vccnz L_loop_32
    s_nop 4
    s_branch L_ok_30
L_again_34:
    s_mov_b32 s98, 0
L_loop_35:
    s_sleep 6
    buffer_load_dword v27, v26, s[8:11], s43 offen sc1
    s_add_u32 s98, s98, 1
    s_waitcnt vmcnt(0)
    v_cmp_ne_u32 vcc, s55, v27
    s_cmp_lt_u32 s98, 0x40000
    s_cselect_b64 vcc, vcc, 0
    s_cbranch_vccnz L_loop_35
    s_nop 4
    s_branch L_ok_33
L_again_37:
    s_mov_b32 s98, 0
L_loop_38:
    s_sleep 6
    buffer_load_dword v15, v37, s[8:11], s43 offen sc1
    s_add_u32 s98, s98, 1
    s_waitcnt vmcnt(0)
    v_cmp_ne_u32 vcc, s55, v15
    s_cmp_lt_u32 s98, 0x40000
    s_cselect_b64 vcc, vcc, 0
    s_cbranch_vccnz L_loop_38
    s_nop 4
    s_branch L_ok_36
L_again_40:
    s_mov_b32 s98, 0
L_loop_41:
    s_sleep 6
    buffer_load_dwordx4 v[252:255], v19, s[8:11], s42 offen sc1
    s_add_u32 s98, s98, 1
    s_waitcnt vmcnt(0)
    v_cmp_ne_u32 vcc, s55, v252
    v_cmp_ne_u32 s[88:89], s55, v253
    s_nop 0
    s_or_b64 vcc, vcc, s[88:89]
    v_cmp_ne_u32 s[88:89], s55, v254
    s_nop 0
    s_or_b64 vcc, vcc, s[88:89]
    v_cmp_ne_u32 s[88:89], s55, v255
    s_nop 0
    s_or_b64 vcc, vcc, s[88:89]
    s_cmp_lt_u32 s98, 0x40000
    s_cselect_b64 vcc, vcc, 0
    s_cbranch_vccnz L_loop_41
    s_nop 4
    s_branch L_ok_39
L_exit:
    s_endpgm
.p2align 8
.type L_tab,@object
L_tab:
.long 0x3f80,0x3f80,0x3f80,0x3f80,0x3f80,0x3e483f7b,0x3ec43f6d,0x3f0e3f55,0x3f80,0x3ec43f6d,0x3f353f35,0x3f6d3ec4,0x3f80,0x3f0e3f55,0x3f6d3ec4,0x3f7bbe48
.long 0x3f80,0x3f353f35,0x3f80248d,0x3f35bf35,0x3f80,0x3f553f0e,0x3f6dbec4,0x3e48bf7b,0x3f80,0x3f6d3ec4,0x3f35bf35,0xbec4bf6d,0x3f80,0x3f7b3e48,0x3ec4bf6d,0xbf55bf0e
.long 0x3f80,0x3f80248d,0x250dbf80,0xbf80a554,0x3f80,0x3f7bbe48,0xbec4bf6d,0xbf553f0e,0x3f80,0x3f6dbec4,0xbf35bf35,0xbec43f6d,0x3f80,0x3f55bf0e,0xbf6dbec4,0x3e483f7b
.long 0x3f80,0x3f35bf35,0xbf80a554,0x3f353f35,0x3f80,0x3f0ebf55,0xbf6d3ec4,0x3f7b3e48,0x3f80,0x3ec4bf6d,0xbf353f35,0x3f6dbec4,0x3f80,0x3e48bf7b,0xbec43f6d,0x3f0ebf55
.long 0x3f80,0x250dbf80,0x3f80,0x250dbf80,0x3f80,0xbe48bf7b,0x3ec43f6d,0xbf0ebf55,0x3f80,0xbec4bf6d,0x3f353f35,0xbf6dbec4,0x3f80,0xbf0ebf55,0x3f6d3ec4,0xbf7b3e48
.long 0x3f80,0xbf35bf35,0x3f80248d,0xbf353f35,0x3f80,0xbf55bf0e,0x3f6dbec4,0xbe483f7b,0x3f80,0xbf6dbec4,0x3f35bf35,0x3ec43f6d,0x3f80,0xbf7bbe48,0x3ec4bf6d,0x3f553f0e
.long 0x3f80,0xbf80a554,0x250dbf80,0x3f80248d,0x3f80,0xbf7b3e48,0xbec4bf6d,0x3f55bf0e,0x3f80,0xbf6d3ec4,0xbf35bf35,0x3ec4bf6d,0x3f80,0xbf553f0e,0xbf6dbec4,0xbe48bf7b
.long 0x3f80,0xbf353f35,0xbf80a554,0xbf35bf35,0x3f80,0xbf0e3f55,0xbf6d3ec4,0xbf7bbe48,0x3f80,0xbec43f6d,0xbf353f35,0xbf6d3ec4,0x3f80,0xbe483f7b,0xbec43f6d,0xbf0e3f55
.long 0x3f80,0x3f80,0x3f80,0x3f80,0x3f353f35,0x3f553f0e,0x3f6d3ec4,0x3f7b3e48,0x3f80248d,0x3f6dbec4,0x3f35bf35,0x3ec4bf6d,0x3f35bf35,0x3e48bf7b,0xbec4bf6d,0xbf55bf0e
.long 0x250dbf80,0xbf35bf35,0xbf80a554,0xbf353f35,0xbf35bf35,0xbf7b3e48,0xbec43f6d,0x3f0e3f55,0xbf80a554,0xbec43f6d,0x3f353f35,0x3f6dbec4,0xbf353f35,0x3f0e3f55,0x3f6dbec4,0xbe48bf7b
.long 0x3f80,0x3f80248d,0x250dbf80,0xbf80a554,0x3f353f35,0x3f0ebf55,0xbf6dbec4,0xbe483f7b,0x3f80248d,0xbec4bf6d,0xbf353f35,0x3f6d3ec4,0x3f35bf35,0xbf7bbe48,0x3ec43f6d,0x3f0ebf55
.long 0x250dbf80,0xbf353f35,0x3f80248d,0xbf35bf35,0xbf35bf35,0x3e483f7b,0x3ec4bf6d,0xbf553f0e,0xbf80a554,0x3f6d3ec4,0xbf35bf35,0x3ec43f6d,0xbf353f35,0x3f55bf0e,0xbf6d3ec4,0x3f7bbe48
.long 0x3f80,0x250dbf80,0x3f80,0x250dbf80,0x3f353f35,0xbf55bf0e,0x3f6d3ec4,0xbf7bbe48,0x3f80248d,0xbf6d3ec4,0x3f35bf35,0xbec43f6d,0x3f35bf35,0xbe483f7b,0xbec4bf6d,0x3f553f0e
.long 0x250dbf80,0x3f353f35,0xbf80a554,0x3f35bf35,0xbf35bf35,0x3f7bbe48,0xbec43f6d,0xbf0ebf55,0xbf80a554,0x3ec4bf6d,0x3f353f35,0xbf6d3ec4,0xbf353f35,0xbf0ebf55,0x3f6dbec4,0x3e483f7b
.long 0x3f80,0xbf80a554,0x250dbf80,0x3f80248d,0x3f353f35,0xbf0e3f55,0xbf6dbec4,0x3e48bf7b,0x3f80248d,0x3ec43f6d,0xbf353f35,0xbf6dbec4,0x3f35bf35,0x3f7b3e48,0x3ec43f6d,0xbf0e3f55
.long 0x250dbf80,0x3f35bf35,0x3f80248d,0x3f353f35,0xbf35bf35,0xbe48bf7b,0x3ec4bf6d,0x3f55bf0e,0xbf80a554,0xbf6dbec4,0xbf35bf35,0xbec4bf6d,0xbf353f35,0xbf553f0e,0xbf6d3ec4,0xbf7b3e48
.long 0x3f80,0x3f80,0x3f80,0x3f80,0x3f80248d,0x3f7bbe48,0x3f6dbec4,0x3f55bf0e,0x250dbf80,0xbec4bf6d,0xbf35bf35,0xbf6dbec4,0xbf80a554,0xbf553f0e,0xbec43f6d,0x3e483f7b
.long 0x3f80,0x3f353f35,0x3f80248d,0x3f35bf35,0x3f80248d,0x3f0ebf55,0xbec4bf6d,0xbf7bbe48,0x250dbf80,0xbf6dbec4,0xbf353f35,0x3ec43f6d,0xbf80a554,0xbe483f7b,0x3f6d3ec4,0x3f0ebf55
.long 0x3f80,0x3f80248d,0x250dbf80,0xbf80a554,0x3f80248d,0xbe48bf7b,0xbf6d3ec4,0x3f0e3f55,0x250dbf80,0xbf6d3ec4,0x3f353f35,0x3ec4bf6d,0xbf80a554,0x3f0e3f55,0x3ec4bf6d,0xbf7b3e48
.long 0x3f80,0x3f35bf35,0xbf80a554,0x3f353f35,0x3f80248d,0xbf55bf0e,0x3ec43f6d,0x3e48bf7b,0x250dbf80,0xbec43f6d,0x3f35bf35,0xbf6d3ec4,0xbf80a554,0x3f7b3e48,0xbf6dbec4,0x3f553f0e
.long 0x3f80,0x250dbf80,0x3f80,0x250dbf80,0x3f80248d,0xbf7b3e48,0x3f6dbec4,0xbf553f0e,0x250dbf80,0x3ec43f6d,0xbf35bf35,0x3f6d3ec4,0xbf80a554,0x3f55bf0e,0xbec43f6d,0xbe48bf7b
.long 0x3f80,0xbf35bf35,0x3f80248d,0xbf353f35,0x3f80248d,0xbf0e3f55,0xbec4bf6d,0x3f7b3e48,0x250dbf80,0x3f6d3ec4,0xbf353f35,0xbec4bf6d,0xbf80a554,0x3e48bf7b,0x3f6d3ec4,0xbf0e3f55
.long 0x3f80,0xbf80a554,0x250dbf80,0x3f80248d,0x3f80248d,0x3e483f7b,0xbf6d3ec4,0xbf0ebf55,0x250dbf80,0x3f6dbec4,0x3f353f35,0xbec43f6d,0xbf80a554,0xbf0ebf55,0x3ec4bf6d,0x3f7bbe48
.long 0x3f80,0xbf353f35,0xbf80a554,0xbf35bf35,0x3f80248d,0x3f553f0e,0x3ec43f6d,0xbe483f7b,0x250dbf80,0x3ec4bf6d,0x3f35bf35,0x3f6dbec4,0xbf80a554,0xbf7bbe48,0xbf6dbec4,0xbf55bf0e
.long 0x3f80,0x3f80,0x3f80,0x3f80,0x3f35bf35,0x3f0ebf55,0x3ec4bf6d,0x3e48bf7b,0xbf80a554,0xbf6d3ec4,0xbf353f35,0xbec43f6d,0x3f353f35,0x3f7b3e48,0x3f6dbec4,0x3f0ebf55
.long 0x250dbf80,0xbf35bf35,0xbf80a554,0xbf353f35,0xbf353f35,0x3e483f7b,0x3f6d3ec4,0x3f55bf0e,0x3f80248d,0x3ec4bf6d,0xbf35bf35,0xbf6d3ec4,0xbf35bf35,0xbf553f0e,0x3ec43f6d,0x3f7bbe48
.long 0x3f80,0x3f80248d,0x250dbf80,0xbf80a554,0x3f35bf35,0xbf55bf0e,0xbec43f6d,0x3f7b3e48,0xbf80a554,0x3ec43f6d,0x3f35bf35,0xbf6dbec4,0x3f353f35,0x3e48bf7b,0xbf6d3ec4,0x3f553f0e
.long 0x250dbf80,0xbf353f35,0x3f80248d,0xbf35bf35,0xbf353f35,0x3f7bbe48,0xbf6dbec4,0x3f0e3f55,0x3f80248d,0xbf6dbec4,0x3f353f35,0xbec4bf6d,0xbf35bf35,0x3f0e3f55,0xbec4bf6d,0x3e483f7b
.long 0x3f80,0x250dbf80,0x3f80,0x250dbf80,0x3f35bf35,0xbf0e3f55,0x3ec4bf6d,0xbe483f7b,0xbf80a554,0x3f6dbec4,0xbf353f35,0x3ec4bf6d,0x3f353f35,0xbf7bbe48,0x3f6dbec4,0xbf0e3f55
.long 0x250dbf80,0x3f353f35,0xbf80a554,0x3f35bf35,0xbf353f35,0xbe48bf7b,0x3f6d3ec4,0xbf553f0e,0x3f80248d,0xbec43f6d,0xbf35bf35,0x3f6dbec4,0xbf35bf35,0x3f55bf0e,0x3ec43f6d,0xbf7b3e48
.long 0x3f80,0xbf80a554,0x250dbf80,0x3f80248d,0x3f35bf35,0x3f553f0e,0xbec43f6d,0xbf7bbe48,0xbf80a554,0xbec4bf6d,0x3f35bf35,0x3f6d3ec4,0x3f353f35,0xbe483f7b,0xbf6d3ec4,0xbf55bf0e
.long 0x250dbf80,0x3f35bf35,0x3f80248d,0x3f353f35,0xbf353f35,0xbf7b3e48,0xbf6dbec4,0xbf0ebf55,0x3f80248d,0x3f6d3ec4,0x3f353f35,0x3ec43f6d,0xbf35bf35,0xbf0ebf55,0xbec4bf6d,0xbe48bf7b
.long 0x3f80,0x3f80,0x3f80,0x3f80,0x250dbf80,0xbe48bf7b,0xbec4bf6d,0xbf0ebf55,0x3f80,0x3ec43f6d,0x3f353f35,0x3f6d3ec4,0x250dbf80,0xbf0ebf55,0xbf6dbec4,0xbf7b3e48
.long 0x3f80,0x3f353f35,0x3f80248d,0x3f35bf35,0x250dbf80,0xbf55bf0e,0xbf6d3ec4,0xbe483f7b,0x3f80,0x3f6d3ec4,0x3f35bf35,0xbec4bf6d,0x250dbf80,0xbf7bbe48,0xbec43f6d,0x3f553f0e
.long 0x3f80,0x3f80248d,0x250dbf80,0xbf80a554,0x250dbf80,0xbf7b3e48,0x3ec43f6d,0x3f55bf0e,0x3f80,0x3f6dbec4,0xbf35bf35,0xbec43f6d,0x250dbf80,0xbf553f0e,0x3f6d3ec4,0xbe48bf7b
.long 0x3f80,0x3f35bf35,0xbf80a554,0x3f353f35,0x250dbf80,0xbf0e3f55,0x3f6dbec4,0xbf7bbe48,0x3f80,0x3ec4bf6d,0xbf353f35,0x3f6dbec4,0x250dbf80,0xbe483f7b,0x3ec4bf6d,0xbf0e3f55
.long 0x3f80,0x250dbf80,0x3f80,0x250dbf80,0x250dbf80,0x3e483f7b,0xbec4bf6d,0x3f0e3f55,0x3f80,0xbec4bf6d,0x3f353f35,0xbf6dbec4,0x250dbf80,0x3f0e3f55,0xbf6dbec4,0x3f7bbe48
.long 0x3f80,0xbf35bf35,0x3f80248d,0xbf353f35,0x250dbf80,0x3f553f0e,0xbf6d3ec4,0x3e48bf7b,0x3f80,0xbf6dbec4,0x3f35bf35,0x3ec43f6d,0x250dbf80,0x3f7b3e48,0xbec43f6d,0xbf55bf0e
.long 0x3f80,0xbf80a554,0x250dbf80,0x3f80248d,0x250dbf80,0x3f7bbe48,0x3ec43f6d,0xbf553f0e,0x3f80,0xbf6d3ec4,0xbf35bf35,0x3ec4bf6d,0x250dbf80,0x3f55bf0e,0x3f6d3ec4,0x3e483f7b
.long 0x3f80,0xbf353f35,0xbf80a554,0xbf35bf35,0x250dbf80,0x3f0ebf55,0x3f6dbec4,0x3f7b3e48,0x3f80,0xbec43f6d,0xbf353f35,0xbf6d3ec4,0x250dbf80,0x3e48bf7b,0x3ec4bf6d,0x3f0ebf55
.long 0x3f80,0x3f80,0x3f80,0x3f80,0xbf35bf35,0xbf55bf0e,0xbf6dbec4,0xbf7bbe48,0x3f80248d,0x3f6dbec4,0x3f35bf35,0x3ec4bf6d,0xbf353f35,0xbe483f7b,0x3ec43f6d,0x3f553f0e
.long 0x250dbf80,0xbf35bf35,0xbf80a554,0xbf353f35,0x3f353f35,0x3f7bbe48,0x3ec4bf6d,0xbf0ebf55,0xbf80a554,0xbec43f6d,0x3f353f35,0x3f6dbec4,0x3f35bf35,0xbf0ebf55,0xbf6d3ec4,0x3e483f7b
.long 0x3f80,0x3f80248d,0x250dbf80,0xbf80a554,0xbf35bf35,0xbf0e3f55,0x3f6d3ec4,0x3e48bf7b,0x3f80248d,0xbec4bf6d,0xbf353f35,0x3f6d3ec4,0xbf353f35,0x3f7b3e48,0xbec4bf6d,0xbf0e3f55
.long 0x250dbf80,0xbf353f35,0x3f80248d,0xbf35bf35,0x3f353f35,0xbe48bf7b,0xbec43f6d,0x3f55bf0e,0xbf80a554,0x3f6d3ec4,0xbf35bf35,0x3ec43f6d,0x3f35bf35,0xbf553f0e,0x3f6dbec4,0xbf7b3e48
.long 0x3f80,0x250dbf80,0x3f80,0x250dbf80,0xbf35bf35,0x3f553f0e,0xbf6dbec4,0x3f7b3e48,0x3f80248d,0xbf6d3ec4,0x3f35bf35,0xbec43f6d,0xbf353f35,0x3e48bf7b,0x3ec43f6d,0xbf55bf0e
.long 0x250dbf80,0x3f353f35,0xbf80a554,0x3f35bf35,0x3f353f35,0xbf7b3e48,0x3ec4bf6d,0x3f0e3f55,0xbf80a554,0x3ec4bf6d,0x3f353f35,0xbf6d3ec4,0x3f35bf35,0x3f0e3f55,0xbf6d3ec4,0xbe48bf7b
.long 0x3f80,0xbf80a554,0x250dbf80,0x3f80248d,0xbf35bf35,0x3f0ebf55,0x3f6d3ec4,0xbe483f7b,0x3f80248d,0x3ec43f6d,0xbf353f35,0xbf6dbec4,0xbf353f35,0xbf7bbe48,0xbec4bf6d,0x3f0ebf55
.long 0x250dbf80,0x3f35bf35,0x3f80248d,0x3f353f35,0x3f353f35,0x3e483f7b,0xbec43f6d,0xbf553f0e,0xbf80a554,0xbf6dbec4,0xbf35bf35,0xbec4bf6d,0x3f35bf35,0x3f55bf0e,0x3f6dbec4,0x3f7bbe48
.long 0x3f80,0x3f80,0x3f80,0x3f80,0xbf80a554,0xbf7b3e48,0xbf6d3ec4,0xbf553f0e,0x250dbf80,0xbec4bf6d,0xbf35bf35,0xbf6dbec4,0x3f80248d,0x3f55bf0e,0x3ec4bf6d,0xbe48bf7b
.long 0x3f80,0x3f353f35,0x3f80248d,0x3f35bf35,0xbf80a554,0xbf0e3f55,0x3ec43f6d,0x3f7b3e48,0x250dbf80,0xbf6dbec4,0xbf353f35,0x3ec43f6d,0x3f80248d,0x3e48bf7b,0xbf6dbec4,0xbf0e3f55
.long 0x3f80,0x3f80248d,0x250dbf80,0xbf80a554,0xbf80a554,0x3e483f7b,0x3f6dbec4,0xbf0ebf55,0x250dbf80,0xbf6d3ec4,0x3f353f35,0x3ec4bf6d,0x3f80248d,0xbf0ebf55,0xbec43f6d,0x3f7bbe48
.long 0x3f80,0x3f35bf35,0xbf80a554,0x3f353f35,0xbf80a554,0x3f553f0e,0xbec4bf6d,0xbe483f7b,0x250dbf80,0xbec43f6d,0x3f35bf35,0xbf6d3ec4,0x3f80248d,0xbf7bbe48,0x3f6d3ec4,0xbf55bf0e
.long 0x3f80,0x250dbf80,0x3f80,0x250dbf80,0xbf80a554,0x3f7bbe48,0xbf6d3ec4,0x3f55bf0e,0x250dbf80,0x3ec43f6d,0xbf35bf35,0x3f6d3ec4,0x3f80248d,0xbf553f0e,0x3ec4bf6d,0x3e483f7b
.long 0x3f80,0xbf35bf35,0x3f80248d,0xbf353f35,0xbf80a554,0x3f0ebf55,0x3ec43f6d,0xbf7bbe48,0x250dbf80,0x3f6d3ec4,0xbf353f35,0xbec4bf6d,0x3f80248d,0xbe483f7b,0xbf6dbec4,0x3f0ebf55
.long 0x3f80,0xbf80a554,0x250dbf80,0x3f80248d,0xbf80a554,0xbe48bf7b,0x3f6dbec4,0x3f0e3f55,0x250dbf80,0x3f6dbec4,0x3f353f35,0xbec43f6d,0x3f80248d,0x3f0e3f55,0xbec43f6d,0xbf7b3e48
.long 0x3f80,0xbf353f35,0xbf80a554,0xbf35bf35,0xbf80a554,0xbf55bf0e,0xbec4bf6d,0x3e48bf7b,0x250dbf80,0x3ec4bf6d,0x3f35bf35,0x3f6dbec4,0x3f80248d,0x3f7b3e48,0x3f6d3ec4,0x3f553f0e
.long 0x3f80,0x3f80,0x3f80,0x3f80,0xbf353f35,0xbf0e3f55,0xbec43f6d,0xbe483f7b,0xbf80a554,0xbf6d3ec4,0xbf353f35,0xbec43f6d,0xbf35bf35,0xbf7bbe48,0xbf6d3ec4,0xbf0e3f55
.long 0x250dbf80,0xbf35bf35,0xbf80a554,0xbf353f35,0x3f35bf35,0xbe48bf7b,0xbf6dbec4,0xbf553f0e,0x3f80248d,0x3ec4bf6d,0xbf35bf35,0xbf6d3ec4,0x3f353f35,0x3f55bf0e,0xbec4bf6d,0xbf7b3e48
.long 0x3f80,0x3f80248d,0x250dbf80,0xbf80a554,0xbf353f35,0x3f553f0e,0x3ec4bf6d,0xbf7bbe48,0xbf80a554,0x3ec43f6d,0x3f35bf35,0xbf6dbec4,0xbf35bf35,0xbe483f7b,0x3f6dbec4,0xbf55bf0e
.long 0x250dbf80,0xbf353f35,0x3f80248d,0xbf35bf35,0x3f35bf35,0xbf7b3e48,0x3f6d3ec4,0xbf0ebf55,0x3f80248d,0xbf6dbec4,0x3f353f35,0xbec4bf6d,0x3f353f35,0xbf0ebf55,0x3ec43f6d,0xbe48bf7b
.long 0x3f80,0x250dbf80,0x3f80,0x250dbf80,0xbf353f35,0x3f0ebf55,0xbec43f6d,0x3e48bf7b,0xbf80a554,0x3f6dbec4,0xbf353f35,0x3ec4bf6d,0xbf35bf35,0x3f7b3e48,0xbf6d3ec4,0x3f0ebf55
.long 0x250dbf80,0x3f353f35,0xbf80a554,0x3f35bf35,0x3f35bf35,0x3e483f7b,0xbf6dbec4,0x3f55bf0e,0x3f80248d,0xbec43f6d,0xbf35bf35,0x3f6dbec4,0x3f353f35,0xbf553f0e,0xbec4bf6d,0x3f7bbe48
.long 0x3f80,0xbf80a554,0x250dbf80,0x3f80248d,0xbf353f35,0xbf55bf0e,0x3ec4bf6d,0x3f7b3e48,0xbf80a554,0xbec4bf6d,0x3f35bf35,0x3f6d3ec4,0xbf35bf35,0x3e48bf7b,0x3f6dbec4,0x3f553f0e
.long 0x250dbf80,0x3f35bf35,0x3f80248d,0x3f353f35,0x3f35bf35,0x3f7bbe48,0x3f6d3ec4,0x3f0e3f55,0x3f80248d,0x3f6d3ec4,0x3f353f35,0x3ec43f6d,0x3f353f35,0x3f0e3f55,0x3ec43f6d,0x3e483f7b
.long 0x3f808000,0x3f808000,0x3f808000,0x3f808000,0x3f808000,0x3f7bbe48,0x3f6dbec4,0x3f55bf0e,0x3f808000,0x3f6dbec4,0x3f35bf35,0x3ec4bf6d,0x3f808000,0x3f55bf0e,0x3ec4bf6d,0xbe48bf7b
.long 0x3f808000,0x3f35bf35,0x248dbf80,0xbf35bf35,0x3f808000,0x3f0ebf55,0xbec4bf6d,0xbf7bbe48,0x3f808000,0x3ec4bf6d,0xbf35bf35,0xbf6d3ec4,0x3f808000,0x3e48bf7b,0xbf6dbec4,0xbf0e3f55
.long 0x3f808000,0x248dbf80,0xbf80a50d,0xa5543f80,0x3f808000,0xbe48bf7b,0xbf6d3ec4,0x3f0e3f55,0x3f808000,0xbec4bf6d,0xbf353f35,0x3f6d3ec4,0x3f808000,0xbf0ebf55,0xbec43f6d,0x3f7bbe48
.long 0x3f808000,0xbf35bf35,0xa5543f80,0x3f35bf35,0x3f808000,0xbf55bf0e,0x3ec43f6d,0x3e48bf7b,0x3f808000,0xbf6dbec4,0x3f353f35,0xbec4bf6d,0x3f808000,0xbf7bbe48,0x3f6d3ec4,0xbf55bf0e
.long 0x3f808000,0xbf80a50d,0x3f808000,0xbf80a50d,0x3f808000,0xbf7b3e48,0x3f6dbec4,0xbf553f0e,0x3f808000,0xbf6d3ec4,0x3f35bf35,0xbec43f6d,0x3f808000,0xbf553f0e,0x3ec4bf6d,0x3e483f7b
.long 0x3f808000,0xbf353f35,0x248dbf80,0x3f353f35,0x3f808000,0xbf0e3f55,0xbec4bf6d,0x3f7b3e48,0x3f808000,0xbec43f6d,0xbf35bf35,0x3f6dbec4,0x3f808000,0xbe483f7b,0xbf6dbec4,0x3f0ebf55
.long 0x3f808000,0xa5543f80,0xbf80a50d,0x248dbf80,0x3f808000,0x3e483f7b,0xbf6d3ec4,0xbf0ebf55,0x3f808000,0x3ec43f6d,0xbf353f35,0xbf6dbec4,0x3f808000,0x3f0e3f55,0xbec43f6d,0xbf7b3e48
.long 0x3f808000,0x3f353f35,0xa5543f80,0xbf353f35,0x3f808000,0x3f553f0e,0x3ec43f6d,0xbe483f7b,0x3f808000,0x3f6d3ec4,0x3f353f35,0x3ec43f6d,0x3f808000,0x3f7b3e48,0x3f6d3ec4,0x3f553f0e
.long 0x3f808000,0x3f808000,0x3f808000,0x3f808000,0x3f35bf35,0x3f0ebf55,0x3ec4bf6d,0x3e48bf7b,0x248dbf80,0xbec4bf6d,0xbf35bf35,0xbf6dbec4,0xbf35bf35,0xbf7bbe48,0xbf6d3ec4,0xbf0e3f55
.long 0xbf80a50d,0xbf353f35,0xa5543f80,0x3f353f35,0xbf353f35,0x3e483f7b,0x3f6d3ec4,0x3f55bf0e,0xa5543f80,0x3f6d3ec4,0x3f35bf35,0xbec4bf6d,0x3f353f35,0x3f55bf0e,0xbec4bf6d,0xbf7b3e48
.long 0x3f808000,0x248dbf80,0xbf80a50d,0xa5543f80,0x3f35bf35,0xbf55bf0e,0xbec43f6d,0x3f7b3e48,0x248dbf80,0xbf6d3ec4,0x3f353f35,0x3ec4bf6d,0xbf35bf35,0xbe483f7b,0x3f6dbec4,0xbf55bf0e
.long 0xbf80a50d,0x3f353f35,0x248dbf80,0xbf353f35,0xbf353f35,0x3f7bbe48,0xbf6dbec4,0x3f0e3f55,0xa5543f80,0x3ec4bf6d,0xbf353f35,0x3f6dbec4,0x3f353f35,0xbf0ebf55,0x3ec43f6d,0xbe48bf7b
.long 0x3f808000,0xbf80a50d,0x3f808000,0xbf80a50d,0x3f35bf35,0xbf0e3f55,0x3ec4bf6d,0xbe483f7b,0x248dbf80,0x3ec43f6d,0xbf35bf35,0x3f6d3ec4,0xbf35bf35,0x3f7b3e48,0xbf6d3ec4,0x3f0ebf55
.long 0xbf80a50d,0x3f35bf35,0xa5543f80,0xbf35bf35,0xbf353f35,0xbe48bf7b,0x3f6d3ec4,0xbf553f0e,0xa5543f80,0xbf6dbec4,0x3f35bf35,0x3ec43f6d,0x3f353f35,0xbf553f0e,0xbec4bf6d,0x3f7bbe48
.long 0x3f808000,0xa5543f80,0xbf80a50d,0x248dbf80,0x3f35bf35,0x3f553f0e,0xbec43f6d,0xbf7bbe48,0x248dbf80,0x3f6dbec4,0x3f353f35,0xbec43f6d,0xbf35bf35,0x3e48bf7b,0x3f6dbec4,0x3f553f0e
.long 0xbf80a50d,0xbf35bf35,0x248dbf80,0x3f35bf35,0xbf353f35,0xbf7b3e48,0xbf6dbec4,0xbf0ebf55,0xa5543f80,0xbec43f6d,0xbf353f35,0xbf6d3ec4,0x3f353f35,0x3f0e3f55,0x3ec43f6d,0x3e483f7b
.long 0x3f808000,0x3f808000,0x3f808000,0x3f808000,0x248dbf80,0xbe48bf7b,0xbec4bf6d,0xbf0ebf55,0xbf80a50d,0xbf6d3ec4,0xbf353f35,0xbec43f6d,0xa5543f80,0x3f0e3f55,0x3f6d3ec4,0x3f7bbe48
.long 0x3f808000,0x3f35bf35,0x248dbf80,0xbf35bf35,0x248dbf80,0xbf55bf0e,0xbf6d3ec4,0xbe483f7b,0xbf80a50d,0xbec43f6d,0x3f353f35,0x3f6dbec4,0xa5543f80,0x3f7b3e48,0x3ec4bf6d,0xbf55bf0e
.long 0x3f808000,0x248dbf80,0xbf80a50d,0xa5543f80,0x248dbf80,0xbf7b3e48,0x3ec43f6d,0x3f55bf0e,0xbf80a50d,0x3ec43f6d,0x3f35bf35,0xbf6dbec4,0xa5543f80,0x3f55bf0e,0xbf6dbec4,0x3e483f7b
.long 0x3f808000,0xbf35bf35,0xa5543f80,0x3f35bf35,0x248dbf80,0xbf0e3f55,0x3f6dbec4,0xbf7bbe48,0xbf80a50d,0x3f6d3ec4,0xbf35bf35,0x3ec43f6d,0xa5543f80,0x3e48bf7b,0xbec43f6d,0x3f0ebf55
.long 0x3f808000,0xbf80a50d,0x3f808000,0xbf80a50d,0x248dbf80,0x3e483f7b,0xbec4bf6d,0x3f0e3f55,0xbf80a50d,0x3f6dbec4,0xbf353f35,0x3ec4bf6d,0xa5543f80,0xbf0ebf55,0x3f6d3ec4,0xbf7b3e48
.long 0x3f808000,0xbf353f35,0x248dbf80,0x3f353f35,0x248dbf80,0x3f553f0e,0xbf6d3ec4,0x3e48bf7b,0xbf80a50d,0x3ec4bf6d,0x3f353f35,0xbf6d3ec4,0xa5543f80,0xbf7bbe48,0x3ec4bf6d,0x3f553f0e
.long 0x3f808000,0xa5543f80,0xbf80a50d,0x248dbf80,0x248dbf80,0x3f7bbe48,0x3ec43f6d,0xbf553f0e,0xbf80a50d,0xbec4bf6d,0x3f35bf35,0x3f6d3ec4,0xa5543f80,0xbf553f0e,0xbf6dbec4,0xbe48bf7b
.long 0x3f808000,0x3f353f35,0xa5543f80,0xbf353f35,0x248dbf80,0x3f0ebf55,0x3f6dbec4,0x3f7b3e48,0xbf80a50d,0xbf6dbec4,0xbf35bf35,0xbec4bf6d,0xa5543f80,0xbe483f7b,0xbec43f6d,0xbf0e3f55
.long 0x3f808000,0x3f808000,0x3f808000,0x3f808000,0xbf35bf35,0xbf55bf0e,0xbf6dbec4,0xbf7bbe48,0xa5543f80,0x3ec43f6d,0x3f353f35,0x3f6d3ec4,0x3f35bf35,0x3e48bf7b,0xbec4bf6d,0xbf55bf0e
.long 0xbf80a50d,0xbf353f35,0xa5543f80,0x3f353f35,0x3f353f35,0x3f7bbe48,0x3ec4bf6d,0xbf0ebf55,0x248dbf80,0xbf6dbec4,0xbf353f35,0x3ec43f6d,0xbf353f35,0x3f0e3f55,0x3f6dbec4,0xbe48bf7b
.long 0x3f808000,0x248dbf80,0xbf80a50d,0xa5543f80,0xbf35bf35,0xbf0e3f55,0x3f6d3ec4,0x3e48bf7b,0xa5543f80,0x3f6dbec4,0xbf35bf35,0xbec43f6d,0x3f35bf35,0xbf7bbe48,0x3ec43f6d,0x3f0ebf55
.long 0xbf80a50d,0x3f353f35,0x248dbf80,0xbf353f35,0x3f353f35,0xbe48bf7b,0xbec43f6d,0x3f55bf0e,0x248dbf80,0xbec43f6d,0x3f35bf35,0xbf6d3ec4,0xbf353f35,0x3f55bf0e,0xbf6d3ec4,0x3f7bbe48
.long 0x3f808000,0xbf80a50d,0x3f808000,0xbf80a50d,0xbf35bf35,0x3f553f0e,0xbf6dbec4,0x3f7b3e48,0xa5543f80,0xbec4bf6d,0x3f353f35,0xbf6dbec4,0x3f35bf35,0xbe483f7b,0xbec4bf6d,0x3f553f0e
.long 0xbf80a50d,0x3f35bf35,0xa5543f80,0xbf35bf35,0x3f353f35,0xbf7b3e48,0x3ec4bf6d,0x3f0e3f55,0x248dbf80,0x3f6d3ec4,0xbf353f35,0xbec4bf6d,0xbf353f35,0xbf0ebf55,0x3f6dbec4,0x3e483f7b
.long 0x3f808000,0xa5543f80,0xbf80a50d,0x248dbf80,0xbf35bf35,0x3f0ebf55,0x3f6d3ec4,0xbe483f7b,0xa5543f80,0xbf6d3ec4,0xbf35bf35,0x3ec4bf6d,0x3f35bf35,0x3f7b3e48,0x3ec43f6d,0xbf0e3f55
.long 0xbf80a50d,0xbf35bf35,0x248dbf80,0x3f35bf35,0x3f353f35,0x3e483f7b,0xbec43f6d,0xbf553f0e,0x248dbf80,0x3ec4bf6d,0x3f35bf35,0x3f6dbec4,0xbf353f35,0xbf553f0e,0xbf6d3ec4,0xbf7b3e48
.long 0x3f808000,0x3f808000,0x3f808000,0x3f808000,0xbf80a50d,0xbf7b3e48,0xbf6d3ec4,0xbf553f0e,0x3f808000,0x3f6dbec4,0x3f35bf35,0x3ec4bf6d,0xbf80a50d,0xbf553f0e,0xbec43f6d,0x3e483f7b
.long 0x3f808000,0x3f35bf35,0x248dbf80,0xbf35bf35,0xbf80a50d,0xbf0e3f55,0x3ec43f6d,0x3f7b3e48,0x3f808000,0x3ec4bf6d,0xbf35bf35,0xbf6d3ec4,0xbf80a50d,0xbe483f7b,0x3f6d3ec4,0x3f0ebf55
.long 0x3f808000,0x248dbf80,0xbf80a50d,0xa5543f80,0xbf80a50d,0x3e483f7b,0x3f6dbec4,0xbf0ebf55,0x3f808000,0xbec4bf6d,0xbf353f35,0x3f6d3ec4,0xbf80a50d,0x3f0e3f55,0x3ec4bf6d,0xbf7b3e48
.long 0x3f808000,0xbf35bf35,0xa5543f80,0x3f35bf35,0xbf80a50d,0x3f553f0e,0xbec4bf6d,0xbe483f7b,0x3f808000,0xbf6dbec4,0x3f353f35,0xbec4bf6d,0xbf80a50d,0x3f7b3e48,0xbf6dbec4,0x3f553f0e
.long 0x3f808000,0xbf80a50d,0x3f808000,0xbf80a50d,0xbf80a50d,0x3f7bbe48,0xbf6d3ec4,0x3f55bf0e,0x3f808000,0xbf6d3ec4,0x3f35bf35,0xbec43f6d,0xbf80a50d,0x3f55bf0e,0xbec43f6d,0xbe48bf7b
.long 0x3f808000,0xbf353f35,0x248dbf80,0x3f353f35,0xbf80a50d,0x3f0ebf55,0x3ec43f6d,0xbf7bbe48,0x3f808000,0xbec43f6d,0xbf35bf35,0x3f6dbec4,0xbf80a50d,0x3e48bf7b,0x3f6d3ec4,0xbf0e3f55
.long 0x3f808000,0xa5543f80,0xbf80a50d,0x248dbf80,0xbf80a50d,0xbe48bf7b,0x3f6dbec4,0x3f0e3f55,0x3f808000,0x3ec43f6d,0xbf353f35,0xbf6dbec4,0xbf80a50d,0xbf0ebf55,0x3ec4bf6d,0x3f7bbe48
.long 0x3f808000,0x3f353f35,0xa5543f80,0xbf353f35,0xbf80a50d,0xbf55bf0e,0xbec4bf6d,0x3e48bf7b,0x3f808000,0x3f6d3ec4,0x3f353f35,0x3ec43f6d,0xbf80a50d,0xbf7bbe48,0xbf6dbec4,0xbf55bf0e
.long 0x3f808000,0x3f808000,0x3f808000,0x3f808000,0xbf353f35,0xbf0e3f55,0xbec43f6d,0xbe483f7b,0x248dbf80,0xbec4bf6d,0xbf35bf35,0xbf6dbec4,0x3f353f35,0x3f7b3e48,0x3f6dbec4,0x3f0ebf55
.long 0xbf80a50d,0xbf353f35,0xa5543f80,0x3f353f35,0x3f35bf35,0xbe48bf7b,0xbf6dbec4,0xbf553f0e,0xa5543f80,0x3f6d3ec4,0x3f35bf35,0xbec4bf6d,0xbf35bf35,0xbf553f0e,0x3ec43f6d,0x3f7bbe48
.long 0x3f808000,0x248dbf80,0xbf80a50d,0xa5543f80,0xbf353f35,0x3f553f0e,0x3ec4bf6d,0xbf7bbe48,0x248dbf80,0xbf6d3ec4,0x3f353f35,0x3ec4bf6d,0x3f353f35,0x3e48bf7b,0xbf6d3ec4,0x3f553f0e
.long 0xbf80a50d,0x3f353f35,0x248dbf80,0xbf353f35,0x3f35bf35,0xbf7b3e48,0x3f6d3ec4,0xbf0ebf55,0xa5543f80,0x3ec4bf6d,0xbf353f35,0x3f6dbec4,0xbf35bf35,0x3f0e3f55,0xbec4bf6d,0x3e483f7b
.long 0x3f808000,0xbf80a50d,0x3f808000,0xbf80a50d,0xbf353f35,0x3f0ebf55,0xbec43f6d,0x3e48bf7b,0x248dbf80,0x3ec43f6d,0xbf35bf35,0x3f6d3ec4,0x3f353f35,0xbf7bbe48,0x3f6dbec4,0xbf0e3f55
.long 0xbf80a50d,0x3f35bf35,0xa5543f80,0xbf35bf35,0x3f35bf35,0x3e483f7b,0xbf6dbec4,0x3f55bf0e,0xa5543f80,0xbf6dbec4,0x3f35bf35,0x3ec43f6d,0xbf35bf35,0x3f55bf0e,0x3ec43f6d,0xbf7b3e48
.long 0x3f808000,0xa5543f80,0xbf80a50d,0x248dbf80,0xbf353f35,0xbf55bf0e,0x3ec4bf6d,0x3f7b3e48,0x248dbf80,0x3f6dbec4,0x3f353f35,0xbec43f6d,0x3f353f35,0xbe483f7b,0xbf6d3ec4,0xbf55bf0e
.long 0xbf80a50d,0xbf35bf35,0x248dbf80,0x3f35bf35,0x3f35bf35,0x3f7bbe48,0x3f6d3ec4,0x3f0e3f55,0xa5543f80,0xbec43f6d,0xbf353f35,0xbf6d3ec4,0xbf35bf35,0xbf0ebf55,0xbec4bf6d,0xbe48bf7b
.long 0x3f808000,0x3f808000,0x3f808000,0x3f808000,0xa5543f80,0x3e483f7b,0x3ec43f6d,0x3f0e3f55,0xbf80a50d,0xbf6d3ec4,0xbf353f35,0xbec43f6d,0x248dbf80,0xbf0ebf55,0xbf6dbec4,0xbf7b3e48
.long 0x3f808000,0x3f35bf35,0x248dbf80,0xbf35bf35,0xa5543f80,0x3f553f0e,0x3f6dbec4,0x3e48bf7b,0xbf80a50d,0xbec43f6d,0x3f353f35,0x3f6dbec4,0x248dbf80,0xbf7bbe48,0xbec43f6d,0x3f553f0e
.long 0x3f808000,0x248dbf80,0xbf80a50d,0xa5543f80,0xa5543f80,0x3f7bbe48,0xbec4bf6d,0xbf553f0e,0xbf80a50d,0x3ec43f6d,0x3f35bf35,0xbf6dbec4,0x248dbf80,0xbf553f0e,0x3f6d3ec4,0xbe48bf7b
.long 0x3f808000,0xbf35bf35,0xa5543f80,0x3f35bf35,0xa5543f80,0x3f0ebf55,0xbf6d3ec4,0x3f7b3e48,0xbf80a50d,0x3f6d3ec4,0xbf35bf35,0x3ec43f6d,0x248dbf80,0xbe483f7b,0x3ec4bf6d,0xbf0e3f55
.long 0x3f808000,0xbf80a50d,0x3f808000,0xbf80a50d,0xa5543f80,0xbe48bf7b,0x3ec43f6d,0xbf0ebf55,0xbf80a50d,0x3f6dbec4,0xbf353f35,0x3ec4bf6d,0x248dbf80,0x3f0e3f55,0xbf6dbec4,0x3f7bbe48
.long 0x3f808000,0xbf353f35,0x248dbf80,0x3f353f35,0xa5543f80,0xbf55bf0e,0x3f6dbec4,0xbe483f7b,0xbf80a50d,0x3ec4bf6d,0x3f353f35,0xbf6d3ec4,0x248dbf80,0x3f7b3e48,0xbec43f6d,0xbf55bf0e
.long 0x3f808000,0xa5543f80,0xbf80a50d,0x248dbf80,0xa5543f80,0xbf7b3e48,0xbec4bf6d,0x3f55bf0e,0xbf80a50d,0xbec4bf6d,0x3f35bf35,0x3f6d3ec4,0x248dbf80,0x3f55bf0e,0x3f6d3ec4,0x3e483f7b
.long 0x3f808000,0x3f353f35,0xa5543f80,0xbf353f35,0xa5543f80,0xbf0e3f55,0xbf6d3ec4,0xbf7bbe48,0xbf80a50d,0xbf6dbec4,0xbf35bf35,0xbec4bf6d,0x248dbf80,0x3e48bf7b,0x3ec4bf6d,0x3f0ebf55
.long 0x3f808000,0x3f808000,0x3f808000,0x3f808000,0x3f353f35,0x3f553f0e,0x3f6d3ec4,0x3f7b3e48,0xa5543f80,0x3ec43f6d,0x3f353f35,0x3f6d3ec4,0xbf353f35,0xbe483f7b,0x3ec43f6d,0x3f553f0e
.long 0xbf80a50d,0xbf353f35,0xa5543f80,0x3f353f35,0xbf35bf35,0xbf7b3e48,0xbec43f6d,0x3f0e3f55,0x248dbf80,0xbf6dbec4,0xbf353f35,0x3ec43f6d,0x3f35bf35,0xbf0ebf55,0xbf6d3ec4,0x3e483f7b
.long 0x3f808000,0x248dbf80,0xbf80a50d,0xa5543f80,0x3f353f35,0x3f0ebf55,0xbf6dbec4,0xbe483f7b,0xa5543f80,0x3f6dbec4,0xbf35bf35,0xbec43f6d,0xbf353f35,0x3f7b3e48,0xbec4bf6d,0xbf0e3f55
.long 0xbf80a50d,0x3f353f35,0x248dbf80,0xbf353f35,0xbf35bf35,0x3e483f7b,0x3ec4bf6d,0xbf553f0e,0x248dbf80,0xbec43f6d,0x3f35bf35,0xbf6d3ec4,0x3f35bf35,0xbf553f0e,0x3f6dbec4,0xbf7b3e48
.long 0x3f808000,0xbf80a50d,0x3f808000,0xbf80a50d,0x3f353f35,0xbf55bf0e,0x3f6d3ec4,0xbf7bbe48,0xa5543f80,0xbec4bf6d,0x3f353f35,0xbf6dbec4,0xbf353f35,0x3e48bf7b,0x3ec43f6d,0xbf55bf0e
.long 0xbf80a50d,0x3f35bf35,0xa5543f80,0xbf35bf35,0xbf35bf35,0x3f7bbe48,0xbec43f6d,0xbf0ebf55,0x248dbf80,0x3f6d3ec4,0xbf353f35,0xbec4bf6d,0x3f35bf35,0x3f0e3f55,0xbf6d3ec4,0xbe48bf7b
.long 0x3f808000,0xa5543f80,0xbf80a50d,0x248dbf80,0x3f353f35,0xbf0e3f55,0xbf6dbec4,0x3e48bf7b,0xa5543f80,0xbf6d3ec4,0xbf35bf35,0x3ec4bf6d,0xbf353f35,0xbf7bbe48,0xbec4bf6d,0x3f0ebf55
.long 0xbf80a50d,0xbf35bf35,0x248dbf80,0x3f35bf35,0xbf35bf35,0xbe48bf7b,0x3ec4bf6d,0x3f55bf0e,0x248dbf80,0x3ec4bf6d,0x3f35bf35,0x3f6dbec4,0x3f35bf35,0x3f55bf0e,0x3f6dbec4,0x3f7bbe48
.long 0x3f800000,0x3f800000,0x3f800000,0x3f800000,0x3f800000,0x3f7ffec4,0x3f7ffb11,0x3f7ff4e6,0x3f800000,0x3f7ffb11,0x3f7fec43,0x3f7fd397,0x3f800000,0x3f7ff4e6,0x3f7fd397,0x3f7f9c18
.long 0x3f800000,0x3f7fec43,0x3f7fb10f,0x3f7f4e6d,0x3f800000,0x3f7fe129,0x3f7f84ab,0x3f7eea9d,0x3f800000,0x3f7fd397,0x3f7f4e6d,0x3f7e70b0,0x3f800000,0x3f7fc38f,0x3f7f0e58,0x3f7de0b1
.long 0x3f800000,0x3f7fb10f,0x3f7ec46d,0x3f7d3aac,0x3f800000,0x3f7f9c18,0x3f7e70b0,0x3f7c7eb0,0x3f800000,0x3f7f84ab,0x3f7e1324,0x3f7baccd,0x3f800000,0x3f7f6ac7,0x3f7dabcc,0x3f7ac516
.long 0x3f800000,0x3f7f4e6d,0x3f7d3aac,0x3f79c79d,0x3f800000,0x3f7f2f9d,0x3f7cbfc9,0x3f78b47b,0x3f800000,0x3f7f0e58,0x3f7c3b28,0x3f778bc5,0x3f800000,0x3f7eea9d,0x3f7baccd,0x3f764d97
.long 0x3f800000,0x3f7ec46d,0x3f7b14be,0x3f74fa0b,0x3f800000,0x3f7e9bc9,0x3f7a7302,0x3f73913f,0x3f800000,0x3f7e70b0,0x3f79c79d,0x3f721352,0x3f800000,0x3f7e4323,0x3f791298,0x3f708066
.long 0x3f800000,0x3f7e1324,0x3f7853f8,0x3f6ed89e,0x3f800000,0x3f7de0b1,0x3f778bc5,0x3f6d1c1d,0x3f800000,0x3f7dabcc,0x3f76ba07,0x3f6b4b0c,0x3f800000,0x3f7d7474,0x3f75dec6,0x3f696591
.long 0x3f800000,0x3f7d3aac,0x3f74fa0b,0x3f676bd8,0x3f800000,0x3f7cfe73,0x3f740bdd,0x3f655e0b,0x3f800000,0x3f7cbfc9,0x3f731447,0x3f633c5a,0x3f800000,0x3f7c7eb0,0x3f721352,0x3f6106f2
.long 0x3f800000,0x3f7c3b28,0x3f710908,0x3f5ebe05,0x3f800000,0x3f7bf531,0x3f6ff573,0x3f5c61c7,0x3f800000,0x3f7baccd,0x3f6ed89e,0x3f59f26a,0x3f800000,0x3f7b61fc,0x3f6db293,0x3f577026
.long 0x3f800000,0x3f800000,0x3f800000,0x3f800000,0x3f7fec43,0x3f7fe129,0x3f7fd397,0x3f7fc38f,0x3f7fb10f,0x3f7f84ab,0x3f7f4e6d,0x3f7f0e58,0x3f7f4e6d,0x3f7eea9d,0x3f7e70b0,0x3f7de0b1
.long 0x3f7ec46d,0x3f7e1324,0x3f7d3aac,0x3f7c3b28,0x3f7e1324,0x3f7cfe73,0x3f7baccd,0x3f7a1e84,0x3f7d3aac,0x3f7baccd,0x3f79c79d,0x3f778bc5,0x3f7c3b28,0x3f7a1e84,0x3f778bc5,0x3f748422
.long 0x3f7b14be,0x3f7853f8,0x3f74fa0b,0x3f710908,0x3f79c79d,0x3f764d97,0x3f721352,0x3f6d1c1d,0x3f7853f8,0x3f740bdd,0x3f6ed89e,0x3f68bf3c,0x3f76ba07,0x3f718f57,0x3f6b4b0c,0x3f63f473
.long 0x3f74fa0b,0x3f6ed89e,0x3f676bd8,0x3f5ebe05,0x3f731447,0x3f6be858,0x3f633c5a,0x3f591e6a,0x3f710908,0x3f68bf3c,0x3f5ebe05,0x3f531849,0x3f6ed89e,0x3f655e0b,0x3f59f26a,0x3f4cae79
.long 0x3f6c835e,0x3f61c598,0x3f54db31,0x3f45e403,0x3f6a09a7,0x3f5df6be,0x3f4f7a1f,0x3f3ebc1b,0x3f676bd8,0x3f59f26a,0x3f49d112,0x3f373a23,0x3f64aa59,0x3f55b993,0x3f43e200,0x3f2f61a5
.long 0x3f61c598,0x3f514d3d,0x3f3daef9,0x3f273656,0x3f5ebe05,0x3f4cae79,0x3f373a23,0x3f1ebc12,0x3f5b941a,0x3f47de65,0x3f3085bb,0x3f15f6d9,0x3f584853,0x3f42de29,0x3f299415,0x3f0cead0
.long 0x3f54db31,0x3f3daef9,0x3f226799,0x3f039c3d,0x3f514d3d,0x3f385216,0x3f1b02c6,0x3ef41f07,0x3f4d9f02,0x3f32c8c9,0x3f13682a,0x3ee0924f,0x3f49d112,0x3f2d1469,0x3f0b9a6b,0x3ecc9b8b
.long 0x3f45e403,0x3f273656,0x3f039c3d,0x3eb8442a,0x3f41d870,0x3f212ff9,0x3ef6e0cb,0x3ea395c5,0x3f3daef9,0x3f1b02c6,0x3ee63375,0x3e8e9a22,0x3f396842,0x3f14b039,0x3ed53641,0x3e72b651
.long 0x3f800000,0x3f800000,0x3f800000,0x3f800000,0x3f7fb10f,0x3f7f9c18,0x3f7f84ab,0x3f7f6ac7,0x3f7ec46d,0x3f7e70b0,0x3f7e1324,0x3f7dabcc,0x3f7d3aac,0x3f7c7eb0,0x3f7baccd,0x3f7ac516
.long 0x3f7b14be,0x3f79c79d,0x3f7853f8,0x3f76ba07,0x3f7853f8,0x3f764d97,0x3f740bdd,0x3f718f57,0x3f74fa0b,0x3f721352,0x3f6ed89e,0x3f6b4b0c,0x3f710908,0x3f6d1c1d,0x3f68bf3c,0x3f63f473
.long 0x3f6c835e,0x3f676bd8,0x3f61c598,0x3f5b941a,0x3f676bd8,0x3f6106f2,0x3f59f26a,0x3f5233c6,0x3f61c598,0x3f59f26a,0x3f514d3d,0x3f47de65,0x3f5b941a,0x3f5233c6,0x3f47de65,0x3f3ca003
.long 0x3f54db31,0x3f49d112,0x3f3daef9,0x3f3085bb,0x3f4d9f02,0x3f40d0da,0x3f32c8c9,0x3f239da9,0x3f45e403,0x3f373a23,0x3f273656,0x3f15f6d9,0x3f3daef9,0x3f2d1469,0x3f1b02c6,0x3f07a136
.long 0x3f3504f3,0x3f226799,0x3f0e39da,0x3ef15aea,0x3f2beb4a,0x3f173c07,0x3f00e7e4,0x3ed25a09,0x3f226799,0x3f0b9a6b,0x3ee63375,0x3eb263ef,0x3f187fc0,0x3eff17b2,0x3ec9b953,0x3e919ddd
.long 0x3f0e39da,0x3ee63375,0x3eac7cd4,0x3e605c13,0x3f039c3d,0x3ecc9b8b,0x3e8e9a22,0x3e1c76de,0x3ef15aea,0x3eb263ef,0x3e605c13,0x3dafb680,0x3edae880,0x3e97a117,0x3e22abb6,0x3c96c9b6
.long 0x3ec3ef15,0x3e78cfcc,0x3dc8bd36,0xbd48fb30,0x3eac7cd4,0x3e419b37,0x3d16c32c,0xbdee3876,0x3e94a031,0x3e09cf86,0xbcc90ab0,0xbe3b6ecf,0x3e78cfcc,0x3da3308c,0xbdafb680,0xbe7ee6e1
.long 0x3e47c5c2,0x3cc90ab0,0xbe164083,0xbea09ae5,0x3e164083,0xbcfb49ba,0xbe541501,0xbec1071e,0x3dc8bd36,0xbdafb680,0xbe888e93,0xbee0924f,0x3d48fb30,0xbe1008b7,0xbea68f12,0xbeff17b2
.long 0x3f800000,0x3f800000,0x3f800000,0x3f800000,0x3f7f4e6d,0x3f7f2f9d,0x3f7f0e58,0x3f7eea9d,0x3f7d3aac,0x3f7cbfc9,0x3f7c3b28,0x3f7baccd,0x3f79c79d,0x3f78b47b,0x3f778bc5,0x3f764d97
.long 0x3f74fa0b,0x3f731447,0x3f710908,0x3f6ed89e,0x3f6ed89e,0x3f6be858,0x3f68bf3c,0x3f655e0b,0x3f676bd8,0x3f633c5a,0x3f5ebe05,0x3f59f26a,0x3f5ebe05,0x3f591e6a,0x3f531849,0x3f4cae79
.long 0x3f54db31,0x3f4d9f02,0x3f45e403,0x3f3daef9,0x3f49d112,0x3f40d0da,0x3f373a23,0x3f2d1469,0x3f3daef9,0x3f32c8c9,0x3f273656,0x3f1b02c6,0x3f3085bb,0x3f239da9,0x3f15f6d9,0x3f07a136
.long 0x3f226799,0x3f13682a,0x3f039c3d,0x3ee63375,0x3f13682a,0x3f0242b1,0x3ee0924f,0x3ebb31a0,0x3f039c3d,0x3ee0924f,0x3eb8442a,0x3e8e9a22,0x3ee63375,0x3ebb31a0,0x3e8e9a22,0x3e419b37
.long 0x3ec3ef15,0x3e94a031,0x3e47c5c2,0x3dc8bd36,0x3ea09ae5,0x3e5a3997,0x3de1bc2e,0x3bc90f88,0x3e78cfcc,0x3e09cf86,0x3cc90ab0,0xbdafb680,0x3e2f10a2,0x3d621469,0xbd7b2b74,0xbe354098
.long 0x3dc8bd36,0xbcc90ab0,0xbe164083,0xbe888e93,0x3cc90ab0,0xbdd53db9,0xbe6c9a7f,0xbeb554ec,0xbd48fb30,0xbe3b6ecf,0xbea09ae5,0xbee0924f,0xbdfab273,0xbe8586ce,0xbec9b953,0xbf04f484
.long 0xbe47c5c2,0xbeac7cd4,0xbef15aea,0xbf187fc0,0xbe888e93,0xbed25a09,0xbf0b9a6b,0xbf2ac082,0xbeac7cd4,0xbef6e0cb,0xbf1d7fd1,0xbf3b8f3b,0xbecf7bca,0xbf0cead0,0xbf2e3bde,0xbf4ac77f
.long 0xbef15aea,0xbf1d7fd1,0xbf3daef9,0xbf584853,0xbf08f59b,0xbf2d1469,0xbf4bbbf8,0xbf63f473,0xbf187fc0,0xbf3b8f3b,0xbf584853,0xbf6db293,0xbf273656,0xbf48d8b3,0xbf633c5a,0xbf756d97
.long 0x3f800000,0x3f800000,0x3f800000,0x3f800000,0x3f7ec46d,0x3f7e9bc9,0x3f7e70b0,0x3f7e4323,0x3f7b14be,0x3f7a7302,0x3f79c79d,0x3f791298,0x3f74fa0b,0x3f73913f,0x3f721352,0x3f708066
.long 0x3f6c835e,0x3f6a09a7,0x3f676bd8,0x3f64aa59,0x3f61c598,0x3f5df6be,0x3f59f26a,0x3f55b993,0x3f54db31,0x3f4f7a1f,0x3f49d112,0x3f43e200,0x3f45e403,0x3f3ebc1b,0x3f373a23,0x3f2f61a5
.long 0x3f3504f3,0x3f2beb4a,0x3f226799,0x3f187fc0,0x3f226799,0x3f173c07,0x3f0b9a6b,0x3eff17b2,0x3f0e39da,0x3f00e7e4,0x3ee63375,0x3ec9b953,0x3ef15aea,0x3ed25a09,0x3eb263ef,0x3e919ddd
.long 0x3ec3ef15,0x3ea09ae5,0x3e78cfcc,0x3e2f10a2,0x3e94a031,0x3e5a3997,0x3e09cf86,0x3d621469,0x3e47c5c2,0x3de1bc2e,0x3cc90ab0,0xbd7b2b74,0x3dc8bd36,0x3bc90f88,0xbdafb680,0xbe354098
.long 0x248d3132,0xbdc8bd36,0xbe47c5c2,0xbe94a031,0xbdc8bd36,0xbe4dee60,0xbe9aa086,0xbecc9b8b,0xbe47c5c2,0xbe9aa086,0xbecf7bca,0xbf00e7e4,0xbe94a031,0xbecc9b8b,0xbf00e7e4,0xbf19c200
.long 0xbec3ef15,0xbefc5d27,0xbf187fc0,0xbf3085bb,0xbef15aea,0xbf14b039,0xbf2e3bde,0xbf44e3f5,0xbf0e39da,0xbf299415,0xbf41d870,0xbf5695e5,0xbf226799,0xbf3ca003,0xbf531849,0xbf655e0b
.long 0xbf3504f3,0xbf4d9f02,0xbf61c598,0xbf710908,0xbf45e403,0xbf5c61c7,0xbf6db293,0xbf796e4e,0xbf54db31,0xbf68bf3c,0xbf76ba07,0xbf7e70b0,0xbf61c598,0xbf7294f8,0xbf7cbfc9,0xbf7ffec4
.long 0xbf6c835e,0xbf79c79d,0xbf7fb10f,0xbf7e1324,0xbf74fa0b,0xbf7e4323,0xbf7f84ab,0xbf78b47b,0xbf7b14be,0xbf7ffb11,0xbf7c3b28,0xbf6ff573,0xbf7ec46d,0xbf7eea9d,0xbf75dec6,0xbf63f473
.long 0x3f800000,0x3f800000,0x3f800000,0x3f800000,0x3f7e1324,0x3f7de0b1,0x3f7dabcc,0x3f7d7474,0x3f7853f8,0x3f778bc5,0x3f76ba07,0x3f75dec6,0x3f6ed89e,0x3f6d1c1d,0x3f6b4b0c,0x3f696591
.long 0x3f61c598,0x3f5ebe05,0x3f5b941a,0x3f584853,0x3f514d3d,0x3f4cae79,0x3f47de65,0x3f42de29,0x3f3daef9,0x3f373a23,0x3f3085bb,0x3f299415,0x3f273656,0x3f1ebc12,0x3f15f6d9,0x3f0cead0
.long 0x3f0e39da,0x3f039c3d,0x3ef15aea,0x3edae880,0x3ee63375,0x3ecc9b8b,0x3eb263ef,0x3e97a117,0x3eac7cd4,0x3e8e9a22,0x3e605c13,0x3e22abb6,0x3e605c13,0x3e1c76de,0x3dafb680,0x3c96c9b6
.long 0x3dc8bd36,0x3cc90ab0,0xbd48fb30,0xbdfab273,0xbcc90ab0,0xbdd53db9,0xbe3b6ecf,0xbe8586ce,0xbe164083,0xbe6c9a7f,0xbea09ae5,0xbec9b953,0xbe888e93,0xbeb554ec,0xbee0924f,0xbf04f484
.long 0xbec3ef15,0xbef15aea,0xbf0e39da,0xbf226799,0xbefc5d27,0xbf14b039,0xbf299415,0xbf3ca003,0xbf187fc0,0xbf2e3bde,0xbf41d870,0xbf531849,0xbf3085bb,0xbf44e3f5,0xbf5695e5,0xbf655e0b
.long 0xbf45e403,0xbf584853,0xbf676bd8,0xbf731447,0xbf584853,0xbf6816a8,0xbf740bdd,0xbf7bf531,0xbf676bd8,0xbf740bdd,0xbf7c3b28,0xbf7fd397,0xbf731447,0xbf7bf531,0xbf7fd397,0xbf7e9bc9
.long 0xbf7b14be,0xbf7fb10f,0xbf7ec46d,0xbf7853f8,0xbf7f4e6d,0xbf7f2f9d,0xbf791298,0xbf6d1c1d,0xbf7fb10f,0xbf7a7302,0xbf6ed89e,0xbf5d2d53,0xbf7c3b28,0xbf718f57,0xbf604621,0xbf48d8b3
.long 0xbf74fa0b,0xbf64aa59,0xbf4d9f02,0xbf3085bb,0xbf6a09a7,0xbf53fac3,0xbf373a23,0xbf14b039,0xbf5b941a,0xbf3fc767,0xbf1d7fd1,0xbeebcbbb,0xbf49d112,0xbf286605,0xbf00e7e4,0xbea986c4
.long 0x3f800000,0x3f800000,0x3f800000,0x3f800000,0x3f7d3aac,0x3f7cfe73,0x3f7cbfc9,0x3f7c7eb0,0x3f74fa0b,0x3f740bdd,0x3f731447,0x3f721352,0x3f676bd8,0x3f655e0b,0x3f633c5a,0x3f6106f2
.long 0x3f54db31,0x3f514d3d,0x3f4d9f02,0x3f49d112,0x3f3daef9,0x3f385216,0x3f32c8c9,0x3f2d1469,0x3f226799,0x3f1b02c6,0x3f13682a,0x3f0b9a6b,0x3f039c3d,0x3ef41f07,0x3ee0924f,0x3ecc9b8b
.long 0x3ec3ef15,0x3eac7cd4,0x3e94a031,0x3e78cfcc,0x3e78cfcc,0x3e419b37,0x3e09cf86,0x3da3308c,0x3dc8bd36,0x3d16c32c,0xbcc90ab0,0xbdafb680,0xbd48fb30,0xbdee3876,0xbe3b6ecf,0xbe7ee6e1
.long 0xbe47c5c2,0xbe888e93,0xbeac7cd4,0xbecf7bca,0xbeac7cd4,0xbed25a09,0xbef6e0cb,0xbf0cead0,0xbef15aea,0xbf0b9a6b,0xbf1d7fd1,0xbf2e3bde,0xbf187fc0,0xbf2ac082,0xbf3b8f3b,0xbf4ac77f
.long 0xbf3504f3,0xbf45e403,0xbf54db31,0xbf61c598,0xbf4d9f02,0xbf5c61c7,0xbf68bf3c,0xbf7294f8,0xbf61c598,0xbf6db293,0xbf76ba07,0xbf7cbfc9,0xbf710908,0xbf796e4e,0xbf7e70b0,0xbf7ffec4
.long 0xbf7b14be,0xbf7f4e6d,0xbf7fb10f,0xbf7c3b28,0xbf7fb10f,0xbf7f2f9d,0xbf7a7302,0xbf718f57,0xbf7ec46d,0xbf791298,0xbf6ed89e,0xbf604621,0xbf7853f8,0xbf6d1c1d,0xbf5d2d53,0xbf48d8b3
.long 0xbf6c835e,0xbf5b941a,0xbf45e403,0xbf2beb4a,0xbf5b941a,0xbf44e3f5,0xbf299415,0xbf0a48ad,0xbf45e403,0xbf299415,0xbf08f59b,0xbec9b953,0xbf2beb4a,0xbf0a48ad,0xbec9b953,0xbe72b651
.long 0xbf0e39da,0xbecf7bca,0xbe78cfcc,0xbd96a905,0xbedae880,0xbe8586ce,0xbdafb680,0x3dbc3ac3,0xbe94a031,0xbde1bc2e,0x3d96a905,0x3e827dc0,0xbe164083,0x3d2fe007,0x3e6c9a7f,0x3ed25a09
.long 0x3f800000,0x3f800000,0x3f800000,0x3f800000,0x3f7c3b28,0x3f7bf531,0x3f7baccd,0x3f7b61fc,0x3f710908,0x3f6ff573,0x3f6ed89e,0x3f6db293,0x3f5ebe05,0x3f5c61c7,0x3f59f26a,0x3f577026
.long 0x3f45e403,0x3f41d870,0x3f3daef9,0x3f396842,0x3f273656,0x3f212ff9,0x3f1b02c6,0x3f14b039,0x3f039c3d,0x3ef6e0cb,0x3ee63375,0x3ed53641,0x3eb8442a,0x3ea395c5,0x3e8e9a22,0x3e72b651
.long 0x3e47c5c2,0x3e164083,0x3dc8bd36,0x3d48fb30,0x3cc90ab0,0xbcfb49ba,0xbdafb680,0xbe1008b7,0xbe164083,0xbe541501,0xbe888e93,0xbea68f12,0xbea09ae5,0xbec1071e,0xbee0924f,0xbeff17b2
.long 0xbef15aea,0xbf08f59b,0xbf187fc0,0xbf273656,0xbf1d7fd1,0xbf2d1469,0xbf3b8f3b,0xbf48d8b3,0xbf3daef9,0xbf4bbbf8,0xbf584853,0xbf633c5a,0xbf584853,0xbf63f473,0xbf6db293,0xbf756d97
.long 0xbf6c835e,0xbf74fa0b,0xbf7b14be,0xbf7ec46d,0xbf79c79d,0xbf7e4323,0xbf7ffb11,0xbf7eea9d,0xbf7fb10f,0xbf7f84ab,0xbf7c3b28,0xbf75dec6,0xbf7e1324,0xbf78b47b,0xbf6ff573,0xbf63f473
.long 0xbf74fa0b,0xbf6a09a7,0xbf5b941a,0xbf49d112,0xbf64aa59,0xbf53fac3,0xbf3fc767,0xbf286605,0xbf4d9f02,0xbf373a23,0xbf1d7fd1,0xbf00e7e4,0xbf3085bb,0xbf14b039,0xbeebcbbb,0xbea986c4
.long 0xbf0e39da,0xbedae880,0xbe94a031,0xbe164083,0xbecf7bca,0xbe8586ce,0xbde1bc2e,0x3d2fe007,0xbe78cfcc,0xbdafb680,0x3d96a905,0x3e6c9a7f,0xbd96a905,0x3dbc3ac3,0x3e827dc0,0x3ed25a09
.long 0x3dc8bd36,0x3e888e93,0x3edae880,0x3f13682a,0x3e888e93,0x3eddbe79,0x3f15f6d9,0x3f385216,0x3edae880,0x3f15f6d9,0x3f396842,0x3f5695e5,0x3f13682a,0x3f385216,0x3f5695e5,0x3f6d1c1d
.long 0x0,0x0,0x0,0x0,0x0,0x3bc90f88,0x3c490e90,0x3c96c9b6,0x0,0x3c490e90,0x3cc90ab0,0x3d16c32c,0x0,0x3c96c9b6,0x3d16c32c,0x3d621469
.long 0x0,0x3cc90ab0,0x3d48fb30,0x3d96a905,0x0,0x3cfb49ba,0x3d7b2b74,0x3dbc3ac3,0x0,0x3d16c32c,0x3d96a905,0x3de1bc2e,0x0,0x3d2fe007,0x3dafb680,0x3e039502
.long 0x0,0x3d48fb30,0x3dc8bd36,0x3e164083,0x0,0x3d621469,0x3de1bc2e,0x3e28defc,0x0,0x3d7b2b74,0x3dfab273,0x3e3b6ecf,0x0,0x3d8a200a,0x3e09cf86,0x3e4dee60
.long 0x0,0x3d96a905,0x3e164083,0x3e605c13,0x0,0x3da3308c,0x3e22abb6,0x3e72b651,0x0,0x3dafb680,0x3e2f10a2,0x3e827dc0,0x0,0x3dbc3ac3,0x3e3b6ecf,0x3e8b9507
.long 0x0,0x3dc8bd36,0x3e47c5c2,0x3e94a031,0x0,0x3dd53db9,0x3e541501,0x3e9d9e78,0x0,0x3de1bc2e,0x3e605c13,0x3ea68f12,0x0,0x3dee3876,0x3e6c9a7f,0x3eaf713a
.long 0x0,0x3dfab273,0x3e78cfcc,0x3eb8442a,0x0,0x3e039502,0x3e827dc0,0x3ec1071e,0x0,0x3e09cf86,0x3e888e93,0x3ec9b953,0x0,0x3e1008b7,0x3e8e9a22,0x3ed25a09
.long 0x0,0x3e164083,0x3e94a031,0x3edae880,0x0,0x3e1c76de,0x3e9aa086,0x3ee363fa,0x0,0x3e22abb6,0x3ea09ae5,0x3eebcbbb,0x0,0x3e28defc,0x3ea68f12,0x3ef41f07
.long 0x0,0x3e2f10a2,0x3eac7cd4,0x3efc5d27,0x0,0x3e354098,0x3eb263ef,0x3f0242b1,0x0,0x3e3b6ecf,0x3eb8442a,0x3f064b82,0x0,0x3e419b37,0x3ebe1d4a,0x3f0a48ad
.long 0x0,0x0,0x0,0x0,0x3cc90ab0,0x3cfb49ba,0x3d16c32c,0x3d2fe007,0x3d48fb30,0x3d7b2b74,0x3d96a905,0x3dafb680,0x3d96a905,0x3dbc3ac3,0x3de1bc2e,0x3e039502
.long 0x3dc8bd36,0x3dfab273,0x3e164083,0x3e2f10a2,0x3dfab273,0x3e1c76de,0x3e3b6ecf,0x3e5a3997,0x3e164083,0x3e3b6ecf,0x3e605c13,0x3e827dc0,0x3e2f10a2,0x3e5a3997,0x3e827dc0,0x3e97a117
.long 0x3e47c5c2,0x3e78cfcc,0x3e94a031,0x3eac7cd4,0x3e605c13,0x3e8b9507,0x3ea68f12,0x3ec1071e,0x3e78cfcc,0x3e9aa086,0x3eb8442a,0x3ed53641,0x3e888e93,0x3ea986c4,0x3ec9b953,0x3ee900b7
.long 0x3e94a031,0x3eb8442a,0x3edae880,0x3efc5d27,0x3ea09ae5,0x3ec6d529,0x3eebcbbb,0x3f07a136,0x3eac7cd4,0x3ed53641,0x3efc5d27,0x3f10d3cd,0x3eb8442a,0x3ee363fa,0x3f064b82,0x3f19c200
.long 0x3ec3ef15,0x3ef15aea,0x3f0e39da,0x3f226799,0x3ecf7bca,0x3eff17b2,0x3f15f6d9,0x3f2ac082,0x3edae880,0x3f064b82,0x3f1d7fd1,0x3f32c8c9,0x3ee63375,0x3f0cead0,0x3f24d225,0x3f3a7ca4
.long 0x3ef15aea,0x3f13682a,0x3f2beb4a,0x3f41d870,0x3efc5d27,0x3f19c200,0x3f32c8c9,0x3f48d8b3,0x3f039c3d,0x3f1ff6cb,0x3f396842,0x3f4f7a1f,0x3f08f59b,0x3f26050a,0x3f3fc767,0x3f55b993
.long 0x3f0e39da,0x3f2beb4a,0x3f45e403,0x3f5b941a,0x3f13682a,0x3f31a81d,0x3f4bbbf8,0x3f6106f2,0x3f187fc0,0x3f373a23,0x3f514d3d,0x3f660f88,0x3f1d7fd1,0x3f3ca003,0x3f5695e5,0x3f6aab7b
.long 0x3f226799,0x3f41d870,0x3f5b941a,0x3f6ed89e,0x3f273656,0x3f46e22a,0x3f604621,0x3f7294f8,0x3f2beb4a,0x3f4bbbf8,0x3f64aa59,0x3f75dec6,0x3f3085bb,0x3f5064af,0x3f68bf3c,0x3f78b47b
.long 0x0,0x0,0x0,0x0,0x3d48fb30,0x3d621469,0x3d7b2b74,0x3d8a200a,0x3dc8bd36,0x3de1bc2e,0x3dfab273,0x3e09cf86,0x3e164083,0x3e28defc,0x3e3b6ecf,0x3e4dee60
.long 0x3e47c5c2,0x3e605c13,0x3e78cfcc,0x3e888e93,0x3e78cfcc,0x3e8b9507,0x3e9aa086,0x3ea986c4,0x3e94a031,0x3ea68f12,0x3eb8442a,0x3ec9b953,0x3eac7cd4,0x3ec1071e,0x3ed53641,0x3ee900b7
.long 0x3ec3ef15,0x3edae880,0x3ef15aea,0x3f039c3d,0x3edae880,0x3ef41f07,0x3f064b82,0x3f121eb0,0x3ef15aea,0x3f064b82,0x3f13682a,0x3f1ff6cb,0x3f039c3d,0x3f121eb0,0x3f1ff6cb,0x3f2d1469
.long 0x3f0e39da,0x3f1d7fd1,0x3f2beb4a,0x3f396842,0x3f187fc0,0x3f286605,0x3f373a23,0x3f44e3f5,0x3f226799,0x3f32c8c9,0x3f41d870,0x3f4f7a1f,0x3f2beb4a,0x3f3ca003,0x3f4bbbf8,0x3f591e6a
.long 0x3f3504f3,0x3f45e403,0x3f54db31,0x3f61c598,0x3f3daef9,0x3f4e8d90,0x3f5d2d53,0x3f696591,0x3f45e403,0x3f5695e5,0x3f64aa59,0x3f6ff573,0x3f4d9f02,0x3f5df6be,0x3f6b4b0c,0x3f756d97
.long 0x3f54db31,0x3f64aa59,0x3f710908,0x3f79c79d,0x3f5b941a,0x3f6aab7b,0x3f75dec6,0x3f7cfe73,0x3f61c598,0x3f6ff573,0x3f79c79d,0x3f7f0e58,0x3f676bd8,0x3f748422,0x3f7cbfc9,0x3f7ff4e6
.long 0x3f6c835e,0x3f7853f8,0x3f7ec46d,0x3f7fb10f,0x3f710908,0x3f7b61fc,0x3f7fd397,0x3f7e4323,0x3f74fa0b,0x3f7dabcc,0x3f7fec43,0x3f7baccd,0x3f7853f8,0x3f7f2f9d,0x3f7f0e58,0x3f77f110
.long 0x3f7b14be,0x3f7fec43,0x3f7d3aac,0x3f731447,0x3f7d3aac,0x3f7fe129,0x3f7a7302,0x3f6d1c1d,0x3f7ec46d,0x3f7f0e58,0x3f76ba07,0x3f660f88,0x3f7fb10f,0x3f7d7474,0x3f721352,0x3f5df6be
.long 0x0,0x0,0x0,0x0,0x3d96a905,0x3da3308c,0x3dafb680,0x3dbc3ac3,0x3e164083,0x3e22abb6,0x3e2f10a2,0x3e3b6ecf,0x3e605c13,0x3e72b651,0x3e827dc0,0x3e8b9507
.long 0x3e94a031,0x3ea09ae5,0x3eac7cd4,0x3eb8442a,0x3eb8442a,0x3ec6d529,0x3ed53641,0x3ee363fa,0x3edae880,0x3eebcbbb,0x3efc5d27,0x3f064b82,0x3efc5d27,0x3f07a136,0x3f10d3cd,0x3f19c200
.long 0x3f0e39da,0x3f187fc0,0x3f226799,0x3f2beb4a,0x3f1d7fd1,0x3f286605,0x3f32c8c9,0x3f3ca003,0x3f2beb4a,0x3f373a23,0x3f41d870,0x3f4bbbf8,0x3f396842,0x3f44e3f5,0x3f4f7a1f,0x3f591e6a
.long 0x3f45e403,0x3f514d3d,0x3f5b941a,0x3f64aa59,0x3f514d3d,0x3f5c61c7,0x3f660f88,0x3f6e46be,0x3f5b941a,0x3f660f88,0x3f6ed89e,0x3f75dec6,0x3f64aa59,0x3f6e46be,0x3f75dec6,0x3f7b61fc
.long 0x3f6c835e,0x3f74fa0b,0x3f7b14be,0x3f7ec46d,0x3f731447,0x3f7a1e84,0x3f7e70b0,0x3f7ffec4,0x3f7853f8,0x3f7dabcc,0x3f7fec43,0x3f7f0e58,0x3f7c3b28,0x3f7f9c18,0x3f7f84ab,0x3f7bf531
.long 0x3f7ec46d,0x3f7fec43,0x3f7d3aac,0x3f76ba07,0x3f7fec43,0x3f7e9bc9,0x3f791298,0x3f6f6830,0x3f7fb10f,0x3f7baccd,0x3f731447,0x3f660f88,0x3f7e1324,0x3f772417,0x3f6b4b0c,0x3f5ac450
.long 0x3f7b14be,0x3f710908,0x3f61c598,0x3f4d9f02,0x3f76ba07,0x3f696591,0x3f5695e5,0x3f3ebc1b,0x3f710908,0x3f604621,0x3f49d112,0x3f2e3bde,0x3f6a09a7,0x3f55b993,0x3f3b8f3b,0x3f1c420c
.long 0x3f61c598,0x3f49d112,0x3f2beb4a,0x3f08f59b,0x3f584853,0x3f3ca003,0x3f1b02c6,0x3ee900b7,0x3f4d9f02,0x3f2e3bde,0x3f08f59b,0x3ebe1d4a,0x3f41d870,0x3f1ebc12,0x3eebcbbb,0x3e919ddd
.long 0x0,0x0,0x0,0x0,0x3dc8bd36,0x3dd53db9,0x3de1bc2e,0x3dee3876,0x3e47c5c2,0x3e541501,0x3e605c13,0x3e6c9a7f,0x3e94a031,0x3e9d9e78,0x3ea68f12,0x3eaf713a
.long 0x3ec3ef15,0x3ecf7bca,0x3edae880,0x3ee63375,0x3ef15aea,0x3eff17b2,0x3f064b82,0x3f0cead0,0x3f0e39da,0x3f15f6d9,0x3f1d7fd1,0x3f24d225,0x3f226799,0x3f2ac082,0x3f32c8c9,0x3f3a7ca4
.long 0x3f3504f3,0x3f3daef9,0x3f45e403,0x3f4d9f02,0x3f45e403,0x3f4e8d90,0x3f5695e5,0x3f5df6be,0x3f54db31,0x3f5d2d53,0x3f64aa59,0x3f6b4b0c,0x3f61c598,0x3f696591,0x3f6ff573,0x3f756d97
.long 0x3f6c835e,0x3f731447,0x3f7853f8,0x3f7c3b28,0x3f74fa0b,0x3f7a1e84,0x3f7dabcc,0x3f7f9c18,0x3f7b14be,0x3f7e70b0,0x3f7fec43,0x3f7f84ab,0x3f7ec46d,0x3f7ffec4,0x3f7f0e58,0x3f7bf531
.long 0x3f800000,0x3f7ec46d,0x3f7b14be,0x3f74fa0b,0x3f7ec46d,0x3f7ac516,0x3f740bdd,0x3f6aab7b,0x3f7b14be,0x3f740bdd,0x3f6a09a7,0x3f5d2d53,0x3f74fa0b,0x3f6aab7b,0x3f5d2d53,0x3f4cae79
.long 0x3f6c835e,0x3f5ebe05,0x3f4d9f02,0x3f396842,0x3f61c598,0x3f5064af,0x3f3b8f3b,0x3f239da9,0x3f54db31,0x3f3fc767,0x3f273656,0x3f0b9a6b,0x3f45e403,0x3f2d1469,0x3f10d3cd,0x3ee363fa
.long 0x3f3504f3,0x3f187fc0,0x3ef15aea,0x3eac7cd4,0x3f226799,0x3f0242b1,0x3ebe1d4a,0x3e667c66,0x3f0e39da,0x3ed53641,0x3e888e93,0x3de1bc2e,0x3ef15aea,0x3ea395c5,0x3e22abb6,0xbbc90f88
.long 0x3ec3ef15,0x3e605c13,0x3d48fb30,0xbdfab273,0x3e94a031,0x3dee3876,0xbd7b2b74,0xbe72b651,0x3e47c5c2,0x3c490e90,0xbe2f10a2,0xbeb263ef,0x3dc8bd36,0xbdbc3ac3,0xbe8e9a22,0xbee900b7
.long 0x0,0x0,0x0,0x0,0x3dfab273,0x3e039502,0x3e09cf86,0x3e1008b7,0x3e78cfcc,0x3e827dc0,0x3e888e93,0x3e8e9a22,0x3eb8442a,0x3ec1071e,0x3ec9b953,0x3ed25a09
.long 0x3ef15aea,0x3efc5d27,0x3f039c3d,0x3f08f59b,0x3f13682a,0x3f19c200,0x3f1ff6cb,0x3f26050a,0x3f2beb4a,0x3f32c8c9,0x3f396842,0x3f3fc767,0x3f41d870,0x3f48d8b3,0x3f4f7a1f,0x3f55b993
.long 0x3f54db31,0x3f5b941a,0x3f61c598,0x3f676bd8,0x3f64aa59,0x3f6aab7b,0x3f6ff573,0x3f748422,0x3f710908,0x3f75dec6,0x3f79c79d,0x3f7cbfc9,0x3f79c79d,0x3f7cfe73,0x3f7f0e58,0x3f7ff4e6
.long 0x3f7ec46d,0x3f7fec43,0x3f7fb10f,0x3f7e1324,0x3f7fec43,0x3f7e9bc9,0x3f7baccd,0x3f772417,0x3f7d3aac,0x3f791298,0x3f731447,0x3f6b4b0c,0x3f76ba07,0x3f6f6830,0x3f660f88,0x3f5ac450
.long 0x3f6c835e,0x3f61c598,0x3f54db31,0x3f45e403,0x3f5ebe05,0x3f5064af,0x3f3fc767,0x3f2d1469,0x3f4d9f02,0x3f3b8f3b,0x3f273656,0x3f10d3cd,0x3f396842,0x3f239da9,0x3f0b9a6b,0x3ee363fa
.long 0x3f226799,0x3f08f59b,0x3edae880,0x3ea09ae5,0x3f08f59b,0x3ed8106b,0x3e9aa086,0x3e354098,0x3edae880,0x3e9aa086,0x3e2f10a2,0x3d16c32c,0x3ea09ae5,0x3e354098,0x3d16c32c,0xbdd53db9
.long 0x3e47c5c2,0x3d48fb30,0xbdc8bd36,0xbe78cfcc,0x3d96a905,0xbda3308c,0xbe6c9a7f,0xbec1071e,0xbd48fb30,0xbe541501,0xbeb8442a,0xbf00e7e4,0xbe2f10a2,0xbea986c4,0xbef6e0cb,0xbf1ebc12
.long 0xbe94a031,0xbee63375,0xbf187fc0,0xbf396842,0xbecf7bca,0xbf0f8784,0xbf32c8c9,0xbf5064af,0xbf039c3d,0xbf299415,0xbf49d112,0xbf633c5a,0xbf1d7fd1,0xbf40d0da,0xbf5d2d53,0xbf718f57
.long 0x0,0x0,0x0,0x0,0x3e164083,0x3e1c76de,0x3e22abb6,0x3e28defc,0x3e94a031,0x3e9aa086,0x3ea09ae5,0x3ea68f12,0x3edae880,0x3ee363fa,0x3eebcbbb,0x3ef41f07
.long 0x3f0e39da,0x3f13682a,0x3f187fc0,0x3f1d7fd1,0x3f2beb4a,0x3f31a81d,0x3f373a23,0x3f3ca003,0x3f45e403,0x3f4bbbf8,0x3f514d3d,0x3f5695e5,0x3f5b941a,0x3f6106f2,0x3f660f88,0x3f6aab7b
.long 0x3f6c835e,0x3f710908,0x3f74fa0b,0x3f7853f8,0x3f7853f8,0x3f7b61fc,0x3f7dabcc,0x3f7f2f9d,0x3f7ec46d,0x3f7fd397,0x3f7fec43,0x3f7f0e58,0x3f7fb10f,0x3f7e4323,0x3f7baccd,0x3f77f110
.long 0x3f7b14be,0x3f76ba07,0x3f710908,0x3f6a09a7,0x3f710908,0x3f696591,0x3f604621,0x3f55b993,0x3f61c598,0x3f5695e5,0x3f49d112,0x3f3b8f3b,0x3f4d9f02,0x3f3ebc1b,0x3f2e3bde,0x3f1c420c
.long 0x3f3504f3,0x3f226799,0x3f0e39da,0x3ef15aea,0x3f187fc0,0x3f0242b1,0x3ed53641,0x3ea395c5,0x3ef15aea,0x3ebe1d4a,0x3e888e93,0x3e22abb6,0x3eac7cd4,0x3e667c66,0x3de1bc2e,0xbbc90f88
.long 0x3e47c5c2,0x3d96a905,0xbd48fb30,0xbe2f10a2,0x3d48fb30,0xbda3308c,0xbe541501,0xbea986c4,0xbdc8bd36,0xbe6c9a7f,0xbeb8442a,0xbef6e0cb,0xbe78cfcc,0xbec1071e,0xbf00e7e4,0xbf1ebc12
.long 0xbec3ef15,0xbf039c3d,0xbf226799,0xbf3daef9,0xbf039c3d,0xbf239da9,0xbf3fc767,0xbf577026,0xbf226799,0xbf3fc767,0xbf584853,0xbf6b4b0c,0xbf3daef9,0xbf577026,0xbf6b4b0c,0xbf78b47b
.long 0xbf54db31,0xbf6a09a7,0xbf7853f8,0xbf7f4e6d,0xbf676bd8,0xbf772417,0xbf7f0e58,0xbf7eea9d,0xbf74fa0b,0xbf7e70b0,0xbf7f4e6d,0xbf778bc5,0xbf7d3aac,0xbf7fc38f,0xbf791298,0xbf696591
.long 0x0,0x0,0x0,0x0,0x3e2f10a2,0x3e354098,0x3e3b6ecf,0x3e419b37,0x3eac7cd4,0x3eb263ef,0x3eb8442a,0x3ebe1d4a,0x3efc5d27,0x3f0242b1,0x3f064b82,0x3f0a48ad
.long 0x3f226799,0x3f273656,0x3f2beb4a,0x3f3085bb,0x3f41d870,0x3f46e22a,0x3f4bbbf8,0x3f5064af,0x3f5b941a,0x3f604621,0x3f64aa59,0x3f68bf3c,0x3f6ed89e,0x3f7294f8,0x3f75dec6,0x3f78b47b
.long 0x3f7b14be,0x3f7d3aac,0x3f7ec46d,0x3f7fb10f,0x3f7fec43,0x3f7fe129,0x3f7f0e58,0x3f7d7474,0x3f7d3aac,0x3f7a7302,0x3f76ba07,0x3f721352,0x3f731447,0x3f6d1c1d,0x3f660f88,0x3f5df6be
.long 0x3f61c598,0x3f584853,0x3f4d9f02,0x3f41d870,0x3f49d112,0x3f3ca003,0x3f2e3bde,0x3f1ebc12,0x3f2beb4a,0x3f1b02c6,0x3f08f59b,0x3eebcbbb,0x3f08f59b,0x3ee900b7,0x3ebe1d4a,0x3e919ddd
.long 0x3ec3ef15,0x3e94a031,0x3e47c5c2,0x3dc8bd36,0x3e605c13,0x3dee3876,0x3c490e90,0xbdbc3ac3,0x3d48fb30,0xbd7b2b74,0xbe2f10a2,0xbe8e9a22,0xbdfab273,0xbe72b651,0xbeb263ef,0xbee900b7
.long 0xbe94a031,0xbecf7bca,0xbf039c3d,0xbf1d7fd1,0xbee63375,0xbf0f8784,0xbf299415,0xbf40d0da,0xbf187fc0,0xbf32c8c9,0xbf49d112,0xbf5d2d53,0xbf396842,0xbf5064af,0xbf633c5a,0xbf718f57
.long 0xbf54db31,0xbf676bd8,0xbf74fa0b,0xbf7d3aac,0xbf6a09a7,0xbf772417,0xbf7e70b0,0xbf7fc38f,0xbf7853f8,0xbf7f0e58,0xbf7f4e6d,0xbf791298,0xbf7f4e6d,0xbf7eea9d,0xbf778bc5,0xbf696591
.long 0xbf7ec46d,0xbf76ba07,0xbf676bd8,0xbf514d3d,0xbf76ba07,0xbf66becc,0xbf4f7a1f,0xbf31a81d,0xbf676bd8,0xbf4f7a1f,0xbf3085bb,0xbf0b9a6b,0xbf514d3d,0xbf31a81d,0xbf0b9a6b,0xbec1071e
.long 0x3f800000,0x3f7ec46d,0x3f7b14be,0x3f74fa0b,0x3f7fffb1,0x3f7eb069,0x3f7aed37,0x3f74bf62,0x3f7ffec4,0x3f7e9bc9,0x3f7ac516,0x3f748422,0x3f7ffd39,0x3f7e868b,0x3f7a9c59,0x3f74484b
.long 0x3f7ffb11,0x3f7e70b0,0x3f7a7302,0x3f740bdd,0x3f7ff84a,0x3f7e5a38,0x3f7a4910,0x3f73ced9,0x3f7ff4e6,0x3f7e4323,0x3f7a1e84,0x3f73913f,0x3f7ff0e3,0x3f7e2b72,0x3f79f35e,0x3f73530e
.long 0x3f7fec43,0x3f7e1324,0x3f79c79d,0x3f731447,0x3f7fe705,0x3f7dfa38,0x3f799b43,0x3f72d4eb,0x3f7fe129,0x3f7de0b1,0x3f796e4e,0x3f7294f8,0x3f7fdaaf,0x3f7dc68c,0x3f7940c0,0x3f725470
.long 0x3f7fd397,0x3f7dabcc,0x3f791298,0x3f721352,0x3f7fcbe2,0x3f7d906e,0x3f78e3d6,0x3f71d19f,0x3f7fc38f,0x3f7d7474,0x3f78b47b,0x3f718f57,0x3f7fba9e,0x3f7d57de,0x3f788486,0x3f714c7a
.long 0x3f7fb10f,0x3f7d3aac,0x3f7853f8,0x3f710908,0x3f7fa6e3,0x3f7d1cdd,0x3f7822d1,0x3f70c501,0x3f7f9c18,0x3f7cfe73,0x3f77f110,0x3f708066,0x3f7f90b1,0x3f7cdf6c,0x3f77beb7,0x3f703b37
.long 0x3f7f84ab,0x3f7cbfc9,0x3f778bc5,0x3f6ff573,0x3f7f7808,0x3f7c9f8a,0x3f77583a,0x3f6faf1b,0x3f7f6ac7,0x3f7c7eb0,0x3f772417,0x3f6f6830,0x3f7f5ce9,0x3f7c5d3a,0x3f76ef5b,0x3f6f20b0
.long 0x3f7f4e6d,0x3f7c3b28,0x3f76ba07,0x3f6ed89e,0x3f7f3f54,0x3f7c187a,0x3f76841b,0x3f6e8ff8,0x3f7f2f9d,0x3f7bf531,0x3f764d97,0x3f6e46be,0x3f7f1f49,0x3f7bd14d,0x3f76167a,0x3f6dfcf2
.long 0x3f7f0e58,0x3f7baccd,0x3f75dec6,0x3f6db293,0x3f7efcc9,0x3f7b87b2,0x3f75a67b,0x3f6d67a1,0x3f7eea9d,0x3f7b61fc,0x3f756d97,0x3f6d1c1d,0x3f7ed7d4,0x3f7b3bab,0x3f75341d,0x3f6cd007
.long 0x3f6c835e,0x3f61c598,0x3f54db31,0x3f45e403,0x3f6c3624,0x3f61668a,0x3f546b3b,0x3f456439,0x3f6be858,0x3f6106f2,0x3f53fac3,0x3f44e3f5,0x3f6b99fb,0x3f60a6cf,0x3f5389c7,0x3f446337
.long 0x3f6b4b0c,0x3f604621,0x3f531849,0x3f43e200,0x3f6afb8c,0x3f5fe4e9,0x3f52a649,0x3f436051,0x3f6aab7b,0x3f5f8327,0x3f5233c6,0x3f42de29,0x3f6a5ad9,0x3f5f20db,0x3f51c0c2,0x3f425b89
.long 0x3f6a09a7,0x3f5ebe05,0x3f514d3d,0x3f41d870,0x3f69b7e4,0x3f5e5aa6,0x3f50d937,0x3f4154e1,0x3f696591,0x3f5df6be,0x3f5064af,0x3f40d0da,0x3f6912ae,0x3f5d924d,0x3f4fefa8,0x3f404c5c
.long 0x3f68bf3c,0x3f5d2d53,0x3f4f7a1f,0x3f3fc767,0x3f686b39,0x3f5cc7d1,0x3f4f0417,0x3f3f41fc,0x3f6816a8,0x3f5c61c7,0x3f4e8d90,0x3f3ebc1b,0x3f67c187,0x3f5bfb34,0x3f4e1689,0x3f3e35c5
.long 0x3f676bd8,0x3f5b941a,0x3f4d9f02,0x3f3daef9,0x3f671599,0x3f5b2c79,0x3f4d26fd,0x3f3d27b8,0x3f66becc,0x3f5ac450,0x3f4cae79,0x3f3ca003,0x3f666771,0x3f5a5ba0,0x3f4c3578,0x3f3c17d9
.long 0x3f660f88,0x3f59f26a,0x3f4bbbf8,0x3f3b8f3b,0x3f65b710,0x3f5988ad,0x3f4b41fa,0x3f3b0629,0x3f655e0b,0x3f591e6a,0x3f4ac77f,0x3f3a7ca4,0x3f650479,0x3f58b3a1,0x3f4a4c87,0x3f39f2ac
.long 0x3f64aa59,0x3f584853,0x3f49d112,0x3f396842,0x3f644fac,0x3f57dc7f,0x3f495521,0x3f38dd65,0x3f63f473,0x3f577026,0x3f48d8b3,0x3f385216,0x3f6398ac,0x3f570348,0x3f485bca,0x3f37c655
.long 0x3f633c5a,0x3f5695e5,0x3f47de65,0x3f373a23,0x3f62df7b,0x3f5627fe,0x3f476085,0x3f36ad7f,0x3f628210,0x3f55b993,0x3f46e22a,0x3f36206c,0x3f62241a,0x3f554aa4,0x3f466354,0x3f3592e7
.long 0x3f3504f3,0x3f226799,0x3f0e39da,0x3ef15aea,0x3f34768f,0x3f21cbfb,0x3f0d9281,0x3eeff7fb,0x3f33e7bc,0x3f212ff9,0x3f0cead0,0x3eee9479,0x3f33587a,0x3f209393,0x3f0c42c9,0x3eed3063
.long 0x3f32c8c9,0x3f1ff6cb,0x3f0b9a6b,0x3eebcbbb,0x3f3238aa,0x3f1f599f,0x3f0af1b7,0x3eea6681,0x3f31a81d,0x3f1ebc12,0x3f0a48ad,0x3ee900b7,0x3f311722,0x3f1e1e22,0x3f099f4e,0x3ee79a5d
.long 0x3f3085bb,0x3f1d7fd1,0x3f08f59b,0x3ee63375,0x3f2ff3e6,0x3f1ce11f,0x3f084b92,0x3ee4cbfe,0x3f2f61a5,0x3f1c420c,0x3f07a136,0x3ee363fa,0x3f2ecef7,0x3f1ba299,0x3f06f686,0x3ee1fb6a
.long 0x3f2e3bde,0x3f1b02c6,0x3f064b82,0x3ee0924f,0x3f2da859,0x3f1a6293,0x3f05a02c,0x3edf28a9,0x3f2d1469,0x3f19c200,0x3f04f484,0x3eddbe79,0x3f2c800f,0x3f19210f,0x3f044889,0x3edc53c1
.long 0x3f2beb4a,0x3f187fc0,0x3f039c3d,0x3edae880,0x3f2b561b,0x3f17de12,0x3f02ef9f,0x3ed97cb9,0x3f2ac082,0x3f173c07,0x3f0242b1,0x3ed8106b,0x3f2a2a80,0x3f16999f,0x3f019573,0x3ed6a399
.long 0x3f299415,0x3f15f6d9,0x3f00e7e4,0x3ed53641,0x3f28fd41,0x3f1553b7,0x3f003a06,0x3ed3c867,0x3f286605,0x3f14b039,0x3eff17b2,0x3ed25a09,0x3f27ce61,0x3f140c5f,0x3efdbabb,0x3ed0eb2a
.long 0x3f273656,0x3f13682a,0x3efc5d27,0x3ecf7bca,0x3f269de3,0x3f12c39a,0x3efafef7,0x3ece0bea,0x3f26050a,0x3f121eb0,0x3ef9a02d,0x3ecc9b8b,0x3f256bcb,0x3f11796b,0x3ef840c8,0x3ecb2aae
.long 0x3f24d225,0x3f10d3cd,0x3ef6e0cb,0x3ec9b953,0x3f24381a,0x3f102dd5,0x3ef58035,0x3ec8477c,0x3f239da9,0x3f0f8784,0x3ef41f07,0x3ec6d529,0x3f2302d3,0x3f0ee0db,0x3ef2bd43,0x3ec5625c
.long 0x3ec3ef15,0x3e94a031,0x3e47c5c2,0x3dc8bd36,0x3ec27b55,0x3e931f35,0x3e44b0b9,0x3dc27c39,0x3ec1071e,0x3e919ddd,0x3e419b37,0x3dbc3ac3,0x3ebf926f,0x3e901c2c,0x3e3e853e,0x3db5f8da
.long 0x3ebe1d4a,0x3e8e9a22,0x3e3b6ecf,0x3dafb680,0x3ebca7af,0x3e8d17c0,0x3e3857ec,0x3da973ba,0x3ebb31a0,0x3e8b9507,0x3e354098,0x3da3308c,0x3eb9bb1e,0x3e8a11f7,0x3e3228d4,0x3d9cecf9
.long 0x3eb8442a,0x3e888e93,0x3e2f10a2,0x3d96a905,0x3eb6ccc3,0x3e870ada,0x3e2bf804,0x3d9064b4,0x3eb554ec,0x3e8586ce,0x3e28defc,0x3d8a200a,0x3eb3dca5,0x3e840270,0x3e25c58c,0x3d83db0a
.long 0x3eb263ef,0x3e827dc0,0x3e22abb6,0x3d7b2b74,0x3eb0eacb,0x3e80f8c0,0x3e1f917b,0x3d6ea038,0x3eaf713a,0x3e7ee6e1,0x3e1c76de,0x3d621469,0x3eadf73c,0x3e7bdba4,0x3e195be0,0x3d55880e
.long 0x3eac7cd4,0x3e78cfcc,0x3e164083,0x3d48fb30,0x3eab0201,0x3e75c35a,0x3e1324ca,0x3d3c6dd5,0x3ea986c4,0x3e72b651,0x3e1008b7,0x3d2fe007,0x3ea80b1f,0x3e6fa8b2,0x3e0cec4a,0x3d2351cb
.long 0x3ea68f12,0x3e6c9a7f,0x3e09cf86,0x3d16c32c,0x3ea5129f,0x3e698bba,0x3e06b26e,0x3d0a342f,0x3ea395c5,0x3e667c66,0x3e039502,0x3cfb49ba,0x3ea21887,0x3e636c83,0x3e007745,0x3ce22a7a
.long 0x3ea09ae5,0x3e605c13,0x3dfab273,0x3cc90ab0,0x3e9f1cdf,0x3e5d4b1a,0x3df475c0,0x3cafea69,0x3e9d9e78,0x3e5a3997,0x3dee3876,0x3c96c9b6,0x3e9c1faf,0x3e57278f,0x3de7fa9a,0x3c7b514b
.long 0x3e9aa086,0x3e541501,0x3de1bc2e,0x3c490e90,0x3e9920fe,0x3e5101f1,0x3ddb7d37,0x3c16cb58,0x3e97a117,0x3e4dee60,0x3dd53db9,0x3bc90f88,0x3e9620d2,0x3e4ada4f,0x3dcefdb7,0x3b490fc6
.long 0x248d3132,0xbdc8bd36,0xbe47c5c2,0xbe94a031,0xbb490fc6,0xbdcefdb7,0xbe4ada4f,0xbe9620d2,0xbbc90f88,0xbdd53db9,0xbe4dee60,0xbe97a117,0xbc16cb58,0xbddb7d37,0xbe5101f1,0xbe9920fe
.long 0xbc490e90,0xbde1bc2e,0xbe541501,0xbe9aa086,0xbc7b514b,0xbde7fa9a,0xbe57278f,0xbe9c1faf,0xbc96c9b6,0xbdee3876,0xbe5a3997,0xbe9d9e78,0xbcafea69,0xbdf475c0,0xbe5d4b1a,0xbe9f1cdf
.long 0xbcc90ab0,0xbdfab273,0xbe605c13,0xbea09ae5,0xbce22a7a,0xbe007745,0xbe636c83,0xbea21887,0xbcfb49ba,0xbe039502,0xbe667c66,0xbea395c5,0xbd0a342f,0xbe06b26e,0xbe698bba,0xbea5129f
.long 0xbd16c32c,0xbe09cf86,0xbe6c9a7f,0xbea68f12,0xbd2351cb,0xbe0cec4a,0xbe6fa8b2,0xbea80b1f,0xbd2fe007,0xbe1008b7,0xbe72b651,0xbea986c4,0xbd3c6dd5,0xbe1324ca,0xbe75c35a,0xbeab0201
.long 0xbd48fb30,0xbe164083,0xbe78cfcc,0xbeac7cd4,0xbd55880e,0xbe195be0,0xbe7bdba4,0xbeadf73c,0xbd621469,0xbe1c76de,0xbe7ee6e1,0xbeaf713a,0xbd6ea038,0xbe1f917b,0xbe80f8c0,0xbeb0eacb
.long 0xbd7b2b74,0xbe22abb6,0xbe827dc0,0xbeb263ef,0xbd83db0a,0xbe25c58c,0xbe840270,0xbeb3dca5,0xbd8a200a,0xbe28defc,0xbe8586ce,0xbeb554ec,0xbd9064b4,0xbe2bf804,0xbe870ada,0xbeb6ccc3
.long 0xbd96a905,0xbe2f10a2,0xbe888e93,0xbeb8442a,0xbd9cecf9,0xbe3228d4,0xbe8a11f7,0xbeb9bb1e,0xbda3308c,0xbe354098,0xbe8b9507,0xbebb31a0,0xbda973ba,0xbe3857ec,0xbe8d17c0,0xbebca7af
.long 0xbdafb680,0xbe3b6ecf,0xbe8e9a22,0xbebe1d4a,0xbdb5f8da,0xbe3e853e,0xbe901c2c,0xbebf926f,0xbdbc3ac3,0xbe419b37,0xbe919ddd,0xbec1071e,0xbdc27c39,0xbe44b0b9,0xbe931f35,0xbec27b55
.long 0xbec3ef15,0xbef15aea,0xbf0e39da,0xbf226799,0xbec5625c,0xbef2bd43,0xbf0ee0db,0xbf2302d3,0xbec6d529,0xbef41f07,0xbf0f8784,0xbf239da9,0xbec8477c,0xbef58035,0xbf102dd5,0xbf24381a
.long 0xbec9b953,0xbef6e0cb,0xbf10d3cd,0xbf24d225,0xbecb2aae,0xbef840c8,0xbf11796b,0xbf256bcb,0xbecc9b8b,0xbef9a02d,0xbf121eb0,0xbf26050a,0xbece0bea,0xbefafef7,0xbf12c39a,0xbf269de3
.long 0xbecf7bca,0xbefc5d27,0xbf13682a,0xbf273656,0xbed0eb2a,0xbefdbabb,0xbf140c5f,0xbf27ce61,0xbed25a09,0xbeff17b2,0xbf14b039,0xbf286605,0xbed3c867,0xbf003a06,0xbf1553b7,0xbf28fd41
.long 0xbed53641,0xbf00e7e4,0xbf15f6d9,0xbf299415,0xbed6a399,0xbf019573,0xbf16999f,0xbf2a2a80,0xbed8106b,0xbf0242b1,0xbf173c07,0xbf2ac082,0xbed97cb9,0xbf02ef9f,0xbf17de12,0xbf2b561b
.long 0xbedae880,0xbf039c3d,0xbf187fc0,0xbf2beb4a,0xbedc53c1,0xbf044889,0xbf19210f,0xbf2c800f,0xbeddbe79,0xbf04f484,0xbf19c200,0xbf2d1469,0xbedf28a9,0xbf05a02c,0xbf1a6293,0xbf2da859
.long 0xbee0924f,0xbf064b82,0xbf1b02c6,0xbf2e3bde,0xbee1fb6a,0xbf06f686,0xbf1ba299,0xbf2ecef7,0xbee363fa,0xbf07a136,0xbf1c420c,0xbf2f61a5,0xbee4cbfe,0xbf084b92,0xbf1ce11f,0xbf2ff3e6
.long 0xbee63375,0xbf08f59b,0xbf1d7fd1,0xbf3085bb,0xbee79a5d,0xbf099f4e,0xbf1e1e22,0xbf311722,0xbee900b7,0xbf0a48ad,0xbf1ebc12,0xbf31a81d,0xbeea6681,0xbf0af1b7,0xbf1f599f,0xbf3238aa
.long 0xbeebcbbb,0xbf0b9a6b,0xbf1ff6cb,0xbf32c8c9,0xbeed3063,0xbf0c42c9,0xbf209393,0xbf33587a,0xbeee9479,0xbf0cead0,0xbf212ff9,0xbf33e7bc,0xbeeff7fb,0xbf0d9281,0xbf21cbfb,0xbf34768f
.long 0xbf3504f3,0xbf45e403,0xbf54db31,0xbf61c598,0xbf3592e7,0xbf466354,0xbf554aa4,0xbf62241a,0xbf36206c,0xbf46e22a,0xbf55b993,0xbf628210,0xbf36ad7f,0xbf476085,0xbf5627fe,0xbf62df7b
.long 0xbf373a23,0xbf47de65,0xbf5695e5,0xbf633c5a,0xbf37c655,0xbf485bca,0xbf570348,0xbf6398ac,0xbf385216,0xbf48d8b3,0xbf577026,0xbf63f473,0xbf38dd65,0xbf495521,0xbf57dc7f,0xbf644fac
.long 0xbf396842,0xbf49d112,0xbf584853,0xbf64aa59,0xbf39f2ac,0xbf4a4c87,0xbf58b3a1,0xbf650479,0xbf3a7ca4,0xbf4ac77f,0xbf591e6a,0xbf655e0b,0xbf3b0629,0xbf4b41fa,0xbf5988ad,0xbf65b710
.long 0xbf3b8f3b,0xbf4bbbf8,0xbf59f26a,0xbf660f88,0xbf3c17d9,0xbf4c3578,0xbf5a5ba0,0xbf666771,0xbf3ca003,0xbf4cae79,0xbf5ac450,0xbf66becc,0xbf3d27b8,0xbf4d26fd,0xbf5b2c79,0xbf671599
.long 0xbf3daef9,0xbf4d9f02,0xbf5b941a,0xbf676bd8,0xbf3e35c5,0xbf4e1689,0xbf5bfb34,0xbf67c187,0xbf3ebc1b,0xbf4e8d90,0xbf5c61c7,0xbf6816a8,0xbf3f41fc,0xbf4f0417,0xbf5cc7d1,0xbf686b39
.long 0xbf3fc767,0xbf4f7a1f,0xbf5d2d53,0xbf68bf3c,0xbf404c5c,0xbf4fefa8,0xbf5d924d,0xbf6912ae,0xbf40d0da,0xbf5064af,0xbf5df6be,0xbf696591,0xbf4154e1,0xbf50d937,0xbf5e5aa6,0xbf69b7e4
.long 0xbf41d870,0xbf514d3d,0xbf5ebe05,0xbf6a09a7,0xbf425b89,0xbf51c0c2,0xbf5f20db,0xbf6a5ad9,0xbf42de29,0xbf5233c6,0xbf5f8327,0xbf6aab7b,0xbf436051,0xbf52a649,0xbf5fe4e9,0xbf6afb8c
.long 0xbf43e200,0xbf531849,0xbf604621,0xbf6b4b0c,0xbf446337,0xbf5389c7,0xbf60a6cf,0xbf6b99fb,0xbf44e3f5,0xbf53fac3,0xbf6106f2,0xbf6be858,0xbf456439,0xbf546b3b,0xbf61668a,0xbf6c3624
.long 0xbf6c835e,0xbf74fa0b,0xbf7b14be,0xbf7ec46d,0xbf6cd007,0xbf75341d,0xbf7b3bab,0xbf7ed7d4,0xbf6d1c1d,0xbf756d97,0xbf7b61fc,0xbf7eea9d,0xbf6d67a1,0xbf75a67b,0xbf7b87b2,0xbf7efcc9
.long 0xbf6db293,0xbf75dec6,0xbf7baccd,0xbf7f0e58,0xbf6dfcf2,0xbf76167a,0xbf7bd14d,0xbf7f1f49,0xbf6e46be,0xbf764d97,0xbf7bf531,0xbf7f2f9d,0xbf6e8ff8,0xbf76841b,0xbf7c187a,0xbf7f3f54
.long 0xbf6ed89e,0xbf76ba07,0xbf7c3b28,0xbf7f4e6d,0xbf6f20b0,0xbf76ef5b,0xbf7c5d3a,0xbf7f5ce9,0xbf6f6830,0xbf772417,0xbf7c7eb0,0xbf7f6ac7,0xbf6faf1b,0xbf77583a,0xbf7c9f8a,0xbf7f7808
.long 0xbf6ff573,0xbf778bc5,0xbf7cbfc9,0xbf7f84ab,0xbf703b37,0xbf77beb7,0xbf7cdf6c,0xbf7f90b1,0xbf708066,0xbf77f110,0xbf7cfe73,0xbf7f9c18,0xbf70c501,0xbf7822d1,0xbf7d1cdd,0xbf7fa6e3
.long 0xbf710908,0xbf7853f8,0xbf7d3aac,0xbf7fb10f,0xbf714c7a,0xbf788486,0xbf7d57de,0xbf7fba9e,0xbf718f57,0xbf78b47b,0xbf7d7474,0xbf7fc38f,0xbf71d19f,0xbf78e3d6,0xbf7d906e,0xbf7fcbe2
.long 0xbf721352,0xbf791298,0xbf7dabcc,0xbf7fd397,0xbf725470,0xbf7940c0,0xbf7dc68c,0xbf7fdaaf,0xbf7294f8,0xbf796e4e,0xbf7de0b1,0xbf7fe129,0xbf72d4eb,0xbf799b43,0xbf7dfa38,0xbf7fe705
.long 0xbf731447,0xbf79c79d,0xbf7e1324,0xbf7fec43,0xbf73530e,0xbf79f35e,0xbf7e2b72,0xbf7ff0e3,0xbf73913f,0xbf7a1e84,0xbf7e4323,0xbf7ff4e6,0xbf73ced9,0xbf7a4910,0xbf7e5a38,0xbf7ff84a
.long 0xbf740bdd,0xbf7a7302,0xbf7e70b0,0xbf7ffb11,0xbf74484b,0xbf7a9c59,0xbf7e868b,0xbf7ffd39,0xbf748422,0xbf7ac516,0xbf7e9bc9,0xbf7ffec4,0xbf74bf62,0xbf7aed37,0xbf7eb069,0xbf7fffb1
.long 0x0,0x3dc8bd36,0x3e47c5c2,0x3e94a031,0x3b490fc6,0x3dcefdb7,0x3e4ada4f,0x3e9620d2,0x3bc90f88,0x3dd53db9,0x3e4dee60,0x3e97a117,0x3c16cb58,0x3ddb7d37,0x3e5101f1,0x3e9920fe
.long 0x3c490e90,0x3de1bc2e,0x3e541501,0x3e9aa086,0x3c7b514b,0x3de7fa9a,0x3e57278f,0x3e9c1faf,0x3c96c9b6,0x3dee3876,0x3e5a3997,0x3e9d9e78,0x3cafea69,0x3df475c0,0x3e5d4b1a,0x3e9f1cdf
.long 0x3cc90ab0,0x3dfab273,0x3e605c13,0x3ea09ae5,0x3ce22a7a,0x3e007745,0x3e636c83,0x3ea21887,0x3cfb49ba,0x3e039502,0x3e667c66,0x3ea395c5,0x3d0a342f,0x3e06b26e,0x3e698bba,0x3ea5129f
.long 0x3d16c32c,0x3e09cf86,0x3e6c9a7f,0x3ea68f12,0x3d2351cb,0x3e0cec4a,0x3e6fa8b2,0x3ea80b1f,0x3d2fe007,0x3e1008b7,0x3e72b651,0x3ea986c4,0x3d3c6dd5,0x3e1324ca,0x3e75c35a,0x3eab0201
.long 0x3d48fb30,0x3e164083,0x3e78cfcc,0x3eac7cd4,0x3d55880e,0x3e195be0,0x3e7bdba4,0x3eadf73c,0x3d621469,0x3e1c76de,0x3e7ee6e1,0x3eaf713a,0x3d6ea038,0x3e1f917b,0x3e80f8c0,0x3eb0eacb
.long 0x3d7b2b74,0x3e22abb6,0x3e827dc0,0x3eb263ef,0x3d83db0a,0x3e25c58c,0x3e840270,0x3eb3dca5,0x3d8a200a,0x3e28defc,0x3e8586ce,0x3eb554ec,0x3d9064b4,0x3e2bf804,0x3e870ada,0x3eb6ccc3
.long 0x3d96a905,0x3e2f10a2,0x3e888e93,0x3eb8442a,0x3d9cecf9,0x3e3228d4,0x3e8a11f7,0x3eb9bb1e,0x3da3308c,0x3e354098,0x3e8b9507,0x3ebb31a0,0x3da973ba,0x3e3857ec,0x3e8d17c0,0x3ebca7af
.long 0x3dafb680,0x3e3b6ecf,0x3e8e9a22,0x3ebe1d4a,0x3db5f8da,0x3e3e853e,0x3e901c2c,0x3ebf926f,0x3dbc3ac3,0x3e419b37,0x3e919ddd,0x3ec1071e,0x3dc27c39,0x3e44b0b9,0x3e931f35,0x3ec27b55
.long 0x3ec3ef15,0x3ef15aea,0x3f0e39da,0x3f226799,0x3ec5625c,0x3ef2bd43,0x3f0ee0db,0x3f2302d3,0x3ec6d529,0x3ef41f07,0x3f0f8784,0x3f239da9,0x3ec8477c,0x3ef58035,0x3f102dd5,0x3f24381a
.long 0x3ec9b953,0x3ef6e0cb,0x3f10d3cd,0x3f24d225,0x3ecb2aae,0x3ef840c8,0x3f11796b,0x3f256bcb,0x3ecc9b8b,0x3ef9a02d,0x3f121eb0,0x3f26050a,0x3ece0bea,0x3efafef7,0x3f12c39a,0x3f269de3
.long 0x3ecf7bca,0x3efc5d27,0x3f13682a,0x3f273656,0x3ed0eb2a,0x3efdbabb,0x3f140c5f,0x3f27ce61,0x3ed25a09,0x3eff17b2,0x3f14b039,0x3f286605,0x3ed3c867,0x3f003a06,0x3f1553b7,0x3f28fd41
.long 0x3ed53641,0x3f00e7e4,0x3f15f6d9,0x3f299415,0x3ed6a399,0x3f019573,0x3f16999f,0x3f2a2a80,0x3ed8106b,0x3f0242b1,0x3f173c07,0x3f2ac082,0x3ed97cb9,0x3f02ef9f,0x3f17de12,0x3f2b561b
.long 0x3edae880,0x3f039c3d,0x3f187fc0,0x3f2beb4a,0x3edc53c1,0x3f044889,0x3f19210f,0x3f2c800f,0x3eddbe79,0x3f04f484,0x3f19c200,0x3f2d1469,0x3edf28a9,0x3f05a02c,0x3f1a6293,0x3f2da859
.long 0x3ee0924f,0x3f064b82,0x3f1b02c6,0x3f2e3bde,0x3ee1fb6a,0x3f06f686,0x3f1ba299,0x3f2ecef7,0x3ee363fa,0x3f07a136,0x3f1c420c,0x3f2f61a5,0x3ee4cbfe,0x3f084b92,0x3f1ce11f,0x3f2ff3e6
.long 0x3ee63375,0x3f08f59b,0x3f1d7fd1,0x3f3085bb,0x3ee79a5d,0x3f099f4e,0x3f1e1e22,0x3f311722,0x3ee900b7,0x3f0a48ad,0x3f1ebc12,0x3f31a81d,0x3eea6681,0x3f0af1b7,0x3f1f599f,0x3f3238aa
.long 0x3eebcbbb,0x3f0b9a6b,0x3f1ff6cb,0x3f32c8c9,0x3eed3063,0x3f0c42c9,0x3f209393,0x3f33587a,0x3eee9479,0x3f0cead0,0x3f212ff9,0x3f33e7bc,0x3eeff7fb,0x3f0d9281,0x3f21cbfb,0x3f34768f
.long 0x3f3504f3,0x3f45e403,0x3f54db31,0x3f61c598,0x3f3592e7,0x3f466354,0x3f554aa4,0x3f62241a,0x3f36206c,0x3f46e22a,0x3f55b993,0x3f628210,0x3f36ad7f,0x3f476085,0x3f5627fe,0x3f62df7b
.long 0x3f373a23,0x3f47de65,0x3f5695e5,0x3f633c5a,0x3f37c655,0x3f485bca,0x3f570348,0x3f6398ac,0x3f385216,0x3f48d8b3,0x3f577026,0x3f63f473,0x3f38dd65,0x3f495521,0x3f57dc7f,0x3f644fac
.long 0x3f396842,0x3f49d112,0x3f584853,0x3f64aa59,0x3f39f2ac,0x3f4a4c87,0x3f58b3a1,0x3f650479,0x3f3a7ca4,0x3f4ac77f,0x3f591e6a,0x3f655e0b,0x3f3b0629,0x3f4b41fa,0x3f5988ad,0x3f65b710
.long 0x3f3b8f3b,0x3f4bbbf8,0x3f59f26a,0x3f660f88,0x3f3c17d9,0x3f4c3578,0x3f5a5ba0,0x3f666771,0x3f3ca003,0x3f4cae79,0x3f5ac450,0x3f66becc,0x3f3d27b8,0x3f4d26fd,0x3f5b2c79,0x3f671599
.long 0x3f3daef9,0x3f4d9f02,0x3f5b941a,0x3f676bd8,0x3f3e35c5,0x3f4e1689,0x3f5bfb34,0x3f67c187,0x3f3ebc1b,0x3f4e8d90,0x3f5c61c7,0x3f6816a8,0x3f3f41fc,0x3f4f0417,0x3f5cc7d1,0x3f686b39
.long 0x3f3fc767,0x3f4f7a1f,0x3f5d2d53,0x3f68bf3c,0x3f404c5c,0x3f4fefa8,0x3f5d924d,0x3f6912ae,0x3f40d0da,0x3f5064af,0x3f5df6be,0x3f696591,0x3f4154e1,0x3f50d937,0x3f5e5aa6,0x3f69b7e4
.long 0x3f41d870,0x3f514d3d,0x3f5ebe05,0x3f6a09a7,0x3f425b89,0x3f51c0c2,0x3f5f20db,0x3f6a5ad9,0x3f42de29,0x3f5233c6,0x3f5f8327,0x3f6aab7b,0x3f436051,0x3f52a649,0x3f5fe4e9,0x3f6afb8c
.long 0x3f43e200,0x3f531849,0x3f604621,0x3f6b4b0c,0x3f446337,0x3f5389c7,0x3f60a6cf,0x3f6b99fb,0x3f44e3f5,0x3f53fac3,0x3f6106f2,0x3f6be858,0x3f456439,0x3f546b3b,0x3f61668a,0x3f6c3624
.long 0x3f6c835e,0x3f74fa0b,0x3f7b14be,0x3f7ec46d,0x3f6cd007,0x3f75341d,0x3f7b3bab,0x3f7ed7d4,0x3f6d1c1d,0x3f756d97,0x3f7b61fc,0x3f7eea9d,0x3f6d67a1,0x3f75a67b,0x3f7b87b2,0x3f7efcc9
.long 0x3f6db293,0x3f75dec6,0x3f7baccd,0x3f7f0e58,0x3f6dfcf2,0x3f76167a,0x3f7bd14d,0x3f7f1f49,0x3f6e46be,0x3f764d97,0x3f7bf531,0x3f7f2f9d,0x3f6e8ff8,0x3f76841b,0x3f7c187a,0x3f7f3f54
.long 0x3f6ed89e,0x3f76ba07,0x3f7c3b28,0x3f7f4e6d,0x3f6f20b0,0x3f76ef5b,0x3f7c5d3a,0x3f7f5ce9,0x3f6f6830,0x3f772417,0x3f7c7eb0,0x3f7f6ac7,0x3f6faf1b,0x3f77583a,0x3f7c9f8a,0x3f7f7808
.long 0x3f6ff573,0x3f778bc5,0x3f7cbfc9,0x3f7f84ab,0x3f703b37,0x3f77beb7,0x3f7cdf6c,0x3f7f90b1,0x3f708066,0x3f77f110,0x3f7cfe73,0x3f7f9c18,0x3f70c501,0x3f7822d1,0x3f7d1cdd,0x3f7fa6e3
.long 0x3f710908,0x3f7853f8,0x3f7d3aac,0x3f7fb10f,0x3f714c7a,0x3f788486,0x3f7d57de,0x3f7fba9e,0x3f718f57,0x3f78b47b,0x3f7d7474,0x3f7fc38f,0x3f71d19f,0x3f78e3d6,0x3f7d906e,0x3f7fcbe2
.long 0x3f721352,0x3f791298,0x3f7dabcc,0x3f7fd397,0x3f725470,0x3f7940c0,0x3f7dc68c,0x3f7fdaaf,0x3f7294f8,0x3f796e4e,0x3f7de0b1,0x3f7fe129,0x3f72d4eb,0x3f799b43,0x3f7dfa38,0x3f7fe705
.long 0x3f731447,0x3f79c79d,0x3f7e1324,0x3f7fec43,0x3f73530e,0x3f79f35e,0x3f7e2b72,0x3f7ff0e3,0x3f73913f,0x3f7a1e84,0x3f7e4323,0x3f7ff4e6,0x3f73ced9,0x3f7a4910,0x3f7e5a38,0x3f7ff84a
.long 0x3f740bdd,0x3f7a7302,0x3f7e70b0,0x3f7ffb11,0x3f74484b,0x3f7a9c59,0x3f7e868b,0x3f7ffd39,0x3f748422,0x3f7ac516,0x3f7e9bc9,0x3f7ffec4,0x3f74bf62,0x3f7aed37,0x3f7eb069,0x3f7fffb1
.long 0x3f800000,0x3f7ec46d,0x3f7b14be,0x3f74fa0b,0x3f7fffb1,0x3f7eb069,0x3f7aed37,0x3f74bf62,0x3f7ffec4,0x3f7e9bc9,0x3f7ac516,0x3f748422,0x3f7ffd39,0x3f7e868b,0x3f7a9c59,0x3f74484b
.long 0x3f7ffb11,0x3f7e70b0,0x3f7a7302,0x3f740bdd,0x3f7ff84a,0x3f7e5a38,0x3f7a4910,0x3f73ced9,0x3f7ff4e6,0x3f7e4323,0x3f7a1e84,0x3f73913f,0x3f7ff0e3,0x3f7e2b72,0x3f79f35e,0x3f73530e
.long 0x3f7fec43,0x3f7e1324,0x3f79c79d,0x3f731447,0x3f7fe705,0x3f7dfa38,0x3f799b43,0x3f72d4eb,0x3f7fe129,0x3f7de0b1,0x3f796e4e,0x3f7294f8,0x3f7fdaaf,0x3f7dc68c,0x3f7940c0,0x3f725470
.long 0x3f7fd397,0x3f7dabcc,0x3f791298,0x3f721352,0x3f7fcbe2,0x3f7d906e,0x3f78e3d6,0x3f71d19f,0x3f7fc38f,0x3f7d7474,0x3f78b47b,0x3f718f57,0x3f7fba9e,0x3f7d57de,0x3f788486,0x3f714c7a
.long 0x3f7fb10f,0x3f7d3aac,0x3f7853f8,0x3f710908,0x3f7fa6e3,0x3f7d1cdd,0x3f7822d1,0x3f70c501,0x3f7f9c18,0x3f7cfe73,0x3f77f110,0x3f708066,0x3f7f90b1,0x3f7cdf6c,0x3f77beb7,0x3f703b37
.long 0x3f7f84ab,0x3f7cbfc9,0x3f778bc5,0x3f6ff573,0x3f7f7808,0x3f7c9f8a,0x3f77583a,0x3f6faf1b,0x3f7f6ac7,0x3f7c7eb0,0x3f772417,0x3f6f6830,0x3f7f5ce9,0x3f7c5d3a,0x3f76ef5b,0x3f6f20b0
.long 0x3f7f4e6d,0x3f7c3b28,0x3f76ba07,0x3f6ed89e,0x3f7f3f54,0x3f7c187a,0x3f76841b,0x3f6e8ff8,0x3f7f2f9d,0x3f7bf531,0x3f764d97,0x3f6e46be,0x3f7f1f49,0x3f7bd14d,0x3f76167a,0x3f6dfcf2
.long 0x3f7f0e58,0x3f7baccd,0x3f75dec6,0x3f6db293,0x3f7efcc9,0x3f7b87b2,0x3f75a67b,0x3f6d67a1,0x3f7eea9d,0x3f7b61fc,0x3f756d97,0x3f6d1c1d,0x3f7ed7d4,0x3f7b3bab,0x3f75341d,0x3f6cd007
.long 0x3f6c835e,0x3f61c598,0x3f54db31,0x3f45e403,0x3f6c3624,0x3f61668a,0x3f546b3b,0x3f456439,0x3f6be858,0x3f6106f2,0x3f53fac3,0x3f44e3f5,0x3f6b99fb,0x3f60a6cf,0x3f5389c7,0x3f446337
.long 0x3f6b4b0c,0x3f604621,0x3f531849,0x3f43e200,0x3f6afb8c,0x3f5fe4e9,0x3f52a649,0x3f436051,0x3f6aab7b,0x3f5f8327,0x3f5233c6,0x3f42de29,0x3f6a5ad9,0x3f5f20db,0x3f51c0c2,0x3f425b89
.long 0x3f6a09a7,0x3f5ebe05,0x3f514d3d,0x3f41d870,0x3f69b7e4,0x3f5e5aa6,0x3f50d937,0x3f4154e1,0x3f696591,0x3f5df6be,0x3f5064af,0x3f40d0da,0x3f6912ae,0x3f5d924d,0x3f4fefa8,0x3f404c5c
.long 0x3f68bf3c,0x3f5d2d53,0x3f4f7a1f,0x3f3fc767,0x3f686b39,0x3f5cc7d1,0x3f4f0417,0x3f3f41fc,0x3f6816a8,0x3f5c61c7,0x3f4e8d90,0x3f3ebc1b,0x3f67c187,0x3f5bfb34,0x3f4e1689,0x3f3e35c5
.long 0x3f676bd8,0x3f5b941a,0x3f4d9f02,0x3f3daef9,0x3f671599,0x3f5b2c79,0x3f4d26fd,0x3f3d27b8,0x3f66becc,0x3f5ac450,0x3f4cae79,0x3f3ca003,0x3f666771,0x3f5a5ba0,0x3f4c3578,0x3f3c17d9
.long 0x3f660f88,0x3f59f26a,0x3f4bbbf8,0x3f3b8f3b,0x3f65b710,0x3f5988ad,0x3f4b41fa,0x3f3b0629,0x3f655e0b,0x3f591e6a,0x3f4ac77f,0x3f3a7ca4,0x3f650479,0x3f58b3a1,0x3f4a4c87,0x3f39f2ac
.long 0x3f64aa59,0x3f584853,0x3f49d112,0x3f396842,0x3f644fac,0x3f57dc7f,0x3f495521,0x3f38dd65,0x3f63f473,0x3f577026,0x3f48d8b3,0x3f385216,0x3f6398ac,0x3f570348,0x3f485bca,0x3f37c655
.long 0x3f633c5a,0x3f5695e5,0x3f47de65,0x3f373a23,0x3f62df7b,0x3f5627fe,0x3f476085,0x3f36ad7f,0x3f628210,0x3f55b993,0x3f46e22a,0x3f36206c,0x3f62241a,0x3f554aa4,0x3f466354,0x3f3592e7
.long 0x3f3504f3,0x3f226799,0x3f0e39da,0x3ef15aea,0x3f34768f,0x3f21cbfb,0x3f0d9281,0x3eeff7fb,0x3f33e7bc,0x3f212ff9,0x3f0cead0,0x3eee9479,0x3f33587a,0x3f209393,0x3f0c42c9,0x3eed3063
.long 0x3f32c8c9,0x3f1ff6cb,0x3f0b9a6b,0x3eebcbbb,0x3f3238aa,0x3f1f599f,0x3f0af1b7,0x3eea6681,0x3f31a81d,0x3f1ebc12,0x3f0a48ad,0x3ee900b7,0x3f311722,0x3f1e1e22,0x3f099f4e,0x3ee79a5d
.long 0x3f3085bb,0x3f1d7fd1,0x3f08f59b,0x3ee63375,0x3f2ff3e6,0x3f1ce11f,0x3f084b92,0x3ee4cbfe,0x3f2f61a5,0x3f1c420c,0x3f07a136,0x3ee363fa,0x3f2ecef7,0x3f1ba299,0x3f06f686,0x3ee1fb6a
.long 0x3f2e3bde,0x3f1b02c6,0x3f064b82,0x3ee0924f,0x3f2da859,0x3f1a6293,0x3f05a02c,0x3edf28a9,0x3f2d1469,0x3f19c200,0x3f04f484,0x3eddbe79,0x3f2c800f,0x3f19210f,0x3f044889,0x3edc53c1
.long 0x3f2beb4a,0x3f187fc0,0x3f039c3d,0x3edae880,0x3f2b561b,0x3f17de12,0x3f02ef9f,0x3ed97cb9,0x3f2ac082,0x3f173c07,0x3f0242b1,0x3ed8106b,0x3f2a2a80,0x3f16999f,0x3f019573,0x3ed6a399
.long 0x3f299415,0x3f15f6d9,0x3f00e7e4,0x3ed53641,0x3f28fd41,0x3f1553b7,0x3f003a06,0x3ed3c867,0x3f286605,0x3f14b039,0x3eff17b2,0x3ed25a09,0x3f27ce61,0x3f140c5f,0x3efdbabb,0x3ed0eb2a
.long 0x3f273656,0x3f13682a,0x3efc5d27,0x3ecf7bca,0x3f269de3,0x3f12c39a,0x3efafef7,0x3ece0bea,0x3f26050a,0x3f121eb0,0x3ef9a02d,0x3ecc9b8b,0x3f256bcb,0x3f11796b,0x3ef840c8,0x3ecb2aae
.long 0x3f24d225,0x3f10d3cd,0x3ef6e0cb,0x3ec9b953,0x3f24381a,0x3f102dd5,0x3ef58035,0x3ec8477c,0x3f239da9,0x3f0f8784,0x3ef41f07,0x3ec6d529,0x3f2302d3,0x3f0ee0db,0x3ef2bd43,0x3ec5625c
.long 0x3ec3ef15,0x3e94a031,0x3e47c5c2,0x3dc8bd36,0x3ec27b55,0x3e931f35,0x3e44b0b9,0x3dc27c39,0x3ec1071e,0x3e919ddd,0x3e419b37,0x3dbc3ac3,0x3ebf926f,0x3e901c2c,0x3e3e853e,0x3db5f8da
.long 0x3ebe1d4a,0x3e8e9a22,0x3e3b6ecf,0x3dafb680,0x3ebca7af,0x3e8d17c0,0x3e3857ec,0x3da973ba,0x3ebb31a0,0x3e8b9507,0x3e354098,0x3da3308c,0x3eb9bb1e,0x3e8a11f7,0x3e3228d4,0x3d9cecf9
.long 0x3eb8442a,0x3e888e93,0x3e2f10a2,0x3d96a905,0x3eb6ccc3,0x3e870ada,0x3e2bf804,0x3d9064b4,0x3eb554ec,0x3e8586ce,0x3e28defc,0x3d8a200a,0x3eb3dca5,0x3e840270,0x3e25c58c,0x3d83db0a
.long 0x3eb263ef,0x3e827dc0,0x3e22abb6,0x3d7b2b74,0x3eb0eacb,0x3e80f8c0,0x3e1f917b,0x3d6ea038,0x3eaf713a,0x3e7ee6e1,0x3e1c76de,0x3d621469,0x3eadf73c,0x3e7bdba4,0x3e195be0,0x3d55880e
.long 0x3eac7cd4,0x3e78cfcc,0x3e164083,0x3d48fb30,0x3eab0201,0x3e75c35a,0x3e1324ca,0x3d3c6dd5,0x3ea986c4,0x3e72b651,0x3e1008b7,0x3d2fe007,0x3ea80b1f,0x3e6fa8b2,0x3e0cec4a,0x3d2351cb
.long 0x3ea68f12,0x3e6c9a7f,0x3e09cf86,0x3d16c32c,0x3ea5129f,0x3e698bba,0x3e06b26e,0x3d0a342f,0x3ea395c5,0x3e667c66,0x3e039502,0x3cfb49ba,0x3ea21887,0x3e636c83,0x3e007745,0x3ce22a7a
.long 0x3ea09ae5,0x3e605c13,0x3dfab273,0x3cc90ab0,0x3e9f1cdf,0x3e5d4b1a,0x3df475c0,0x3cafea69,0x3e9d9e78,0x3e5a3997,0x3dee3876,0x3c96c9b6,0x3e9c1faf,0x3e57278f,0x3de7fa9a,0x3c7b514b
.long 0x3e9aa086,0x3e541501,0x3de1bc2e,0x3c490e90,0x3e9920fe,0x3e5101f1,0x3ddb7d37,0x3c16cb58,0x3e97a117,0x3e4dee60,0x3dd53db9,0x3bc90f88,0x3e9620d2,0x3e4ada4f,0x3dcefdb7,0x3b490fc6
.size L_tab, 24576
.section .rodata,"a"
.p2align 6
.amdhsa_kernel recurrent_scan__spectral_gfnet__dense_activation_relu__prompt_kernel
  .amdhsa_next_free_vgpr 512
  .amdhsa_next_free_sgpr 102
  .amdhsa_accum_offset 256
  .amdhsa_group_segment_fixed_size 0
  .amdhsa_kernarg_size 72
  .amdhsa_user_sgpr_count 2
  .amdhsa_user_sgpr_kernarg_segment_ptr 1
  .amdhsa_system_sgpr_workgroup_id_x 1
.end_amdhsa_kernel
```
